```python
import torch

def _softmax(x, axis=-1):
    return torch.softmax(x, dim=axis)
def _gelu(x):
    return torch.nn.functional.gelu(x, approximate="tanh")
def _silu(x):
    return torch.nn.functional.silu(x)
def _sigmoid(x):
    return torch.sigmoid(x)
def _layernorm(x, axis=-1, eps=1e-5):
    m = x.mean(dim=axis, keepdim=True)
    v = x.var(dim=axis, keepdim=True, unbiased=False)
    return (x - m) / torch.sqrt(v + eps)
def _scatter_add(tgt, idx, src, axis=0):
    return tgt.clone().index_add_(axis, idx, src)
def _segment_sum(src, seg, n):
    out = torch.zeros((n,) + src.shape[1:], dtype=src.dtype)
    return out.index_add_(0, seg, src)
def _pad(x, pw):
    flat = tuple(v for pair in reversed(pw) for v in pair)
    return torch.nn.functional.pad(x, flat)

kernel_name = 'gather_scatter__cheap_equivariant_egnn__graph'

def setup_inputs():

    _w = (lambda a: (lambda t: t.to(torch.bfloat16) if t.is_floating_point() else t)(torch.as_tensor(a)))
    N, deg, D, De = 50000, 16, 64, max(0, 1)
    E = N * deg
    return {
        "h": _w((lambda *s: torch.randn(*s, dtype=torch.bfloat16) * 0.2)(N, D)),
        "pos": _w((lambda *s: torch.randn(*s, dtype=torch.bfloat16) * 0.4)(N, 3)),
        "e_attr": _w((lambda *s: torch.randn(*s, dtype=torch.bfloat16) * 0.4)(E, De)),
        "src": _w((lambda lo, hi, *s: torch.randint(lo, hi, s))(0, N, E).to(torch.int64)),
        "dst": _w((lambda lo, hi, *s: torch.randint(lo, hi, s))(0, N, E).to(torch.int64)),
        "w_e": _w(0.1 * (lambda *s: torch.randn(*s, dtype=torch.bfloat16) * 0.4)(2 * D + 1 + De, D)),
        "w_x": _w(0.1 * (lambda *s: torch.randn(*s, dtype=torch.bfloat16) * 0.2)(D, 1)),
        "w_h": _w(0.1 * (lambda *s: torch.randn(*s, dtype=torch.bfloat16) * 0.2)(2 * D, D)),
    }

def reference(h, pos, e_attr, src, dst, w_e, w_x, w_h):
    N, D = h.shape[0], h.shape[1]
    diff = pos[dst] - pos[src]
    dist2 = torch.sum(diff * diff, axis=-1, keepdims=True)
    e_in = torch.concatenate([h[dst], h[src], dist2, e_attr], axis=-1)
    m_ij = _silu(e_in @ w_e)
    coord_scale = m_ij @ w_x
    pos_new = pos + _segment_sum(diff * coord_scale, dst, N)
    m_i = _segment_sum(m_ij, dst, N)
    h_new = h + _silu(torch.concatenate([h, m_i], axis=-1) @ w_h)
    return h_new, pos_new
```

```asm
; @launch grid=(256,1,1) block=(512,1,1) lds=163840
.amdgcn_target "amdgcn-amd-amdhsa--gfx950"
.text
.globl gather_scatter__cheap_equivariant_egnn__graph_kernel
.p2align 8
.type gather_scatter__cheap_equivariant_egnn__graph_kernel,@function
gather_scatter__cheap_equivariant_egnn__graph_kernel:
  s_cmp_ge_u32 s2, 256
  s_cbranch_scc1 K2_done
  s_load_dwordx8 s[40:47], s[0:1], 8
  s_load_dwordx2 s[6:7], s[0:1], 80
  s_load_dwordx4 s[48:51], s[0:1], 40
  s_load_dwordx2 s[4:5], s[0:1], 0
  s_load_dwordx2 s[52:53], s[0:1], 56
  s_load_dwordx2 s[54:55], s[0:1], 72
  s_load_dwordx2 s[78:79], s[0:1], 64
  s_memrealtime s[76:77]
  s_mov_b32 s91, s2
  v_lshlrev_b32 v230, 5, v0
  v_lshrrev_b32 v243, 6, v0
  v_lshlrev_b32 v239, 4, v0
  v_readfirstlane_b32 s3, v243
  s_mul_i32 s96, s91, 3128
  s_mul_i32 s92, s91, 12512
  s_sub_u32 s96, 800000, s96
  s_mul_i32 s93, s91, 6256
  s_min_u32 s96, s96, 3128
  s_lshl_b32 s94, s96, 2
  s_lshl_b32 s95, s96, 1
  v_mov_b32 v238, v0
  v_and_b32 v0, 63, v0
  s_and_b32 s97, s91, 3
  s_lshl_b32 s97, s97, 6
  v_mov_b32 v210, s97
  s_waitcnt lgkmcnt(0)
  s_mov_b32 s21, s76
  s_mov_b32 s22, s52
  s_mov_b32 s23, s53
  s_mov_b32 s12, s40
  s_and_b32 s13, s41, 0xffff
  s_or_b32 s13, s13, 0x60000
  s_mov_b32 s14, 50000
  s_mov_b32 s15, 0x00020000
  s_cmp_ge_u32 s3, 7
  s_cbranch_scc1 K3_w7tag
  s_add_u32 s56, s46, s92
  s_addc_u32 s57, s47, 0
  s_mov_b32 s58, s94
  s_mov_b32 s59, 0x00020000
  buffer_load_dwordx4 v[68:71], v230, s[56:59], 0 offen
  buffer_load_dwordx4 v[72:75], v230, s[56:59], 0 offen offset:16
  s_branch K3_noedges
K3_w7tag:
  s_mov_b32 s68, s54
  s_mov_b32 s69, s55
  s_mov_b32 s70, 256
  s_mov_b32 s71, 0x00020000
  s_cmp_lg_u32 s91, 0
  s_cbranch_scc1 K3_nopub
  v_lshlrev_b32 v209, 6, v0
  s_or_b32 s76, s76, 1
  v_mov_b32 v208, s76
  s_mov_b64 exec, 0xf
  buffer_store_dword v208, v209, s[68:71], 0 offen sc1
  s_mov_b64 exec, -1
  v_mov_b32 v211, s76
  v_mov_b32 v210, 0x1000
  s_branch K3_noedges
K3_nopub:
  buffer_load_dword v211, v210, s[68:71], 0 offen sc1
K3_noedges:
  s_and_b32 s8, s2, 7
  s_lshl_b32 s8, s8, 5
  s_lshr_b32 s2, s2, 3
  s_add_u32 s2, s2, s8
  s_lshl_b32 s88, s3, 12
  s_add_u32 s88, s88, 98304
  v_mov_b32 v52, 0
  v_mov_b32 v53, 0
  v_mov_b32 v54, 0
  v_mov_b32 v55, 0
  v_cmp_gt_u32 vcc, 192, v238
  s_and_saveexec_b64 s[98:99], vcc
  ds_write_b128 v239, v[52:55] offset:3392
  s_mov_b64 exec, s[98:99]
  s_add_u32 s60, s44, s92
  s_addc_u32 s61, s45, 0
  s_mov_b32 s62, s94
  s_mov_b32 s63, 0x00020000
  s_add_u32 s64, s42, s93
  s_addc_u32 s65, s43, 0
  s_mov_b32 s66, s95
  s_mov_b32 s67, 0x00020000
  s_cmp_ge_u32 s3, 7
  s_cbranch_scc1 K3_w7a
  buffer_load_dwordx4 v[84:87], v239, s[64:67], 0 offen
  s_branch K3_w7b
K3_w7a:
  s_mov_b32 s64, s54
  s_mov_b32 s65, s55
  s_mov_b32 s66, 256
  s_mov_b32 s67, 0x00020000
  s_mov_b32 s32, s48
  s_mov_b32 s33, s49
  s_mov_b32 s34, 16640
  s_mov_b32 s35, 0x00020000
  s_mov_b32 s56, s50
  s_mov_b32 s57, s51
  s_mov_b32 s58, 128
  s_mov_b32 s59, 0x00020000
  v_lshlrev_b32 v233, 4, v0
  v_add_u32 v232, 16384, v233
  s_mov_b32 m0, 97824
  s_mov_b64 exec, 0xffff
  buffer_load_dwordx4 v232, s[32:35], 0 offen lds
  s_mov_b32 m0, 98080
  s_mov_b64 exec, 0xff
  buffer_load_dwordx4 v233, s[56:59], 0 offen lds
  s_mov_b64 exec, -1
  s_mul_i32 s93, s2, 196
  v_add_u32 v124, s93, v0
  v_add_u32 v125, 64, v124
  v_add_u32 v126, 128, v124
  v_add_u32 v127, 192, v124
  buffer_load_dword v100, v124, s[12:15], 0 idxen
  buffer_load_ushort v101, v124, s[12:15], 0 idxen offset:4
  buffer_load_dword v102, v125, s[12:15], 0 idxen
  buffer_load_ushort v103, v125, s[12:15], 0 idxen offset:4
  buffer_load_dword v104, v126, s[12:15], 0 idxen
  buffer_load_ushort v105, v126, s[12:15], 0 idxen offset:4
  s_mov_b64 exec, 0xf
  buffer_load_dword v106, v127, s[12:15], 0 idxen
  buffer_load_ushort v107, v127, s[12:15], 0 idxen offset:4
  s_mov_b64 exec, -1
K3_w7b:
  s_mov_b32 s32, s48
  s_mov_b32 s33, s49
  s_mov_b32 s34, 16640
  s_mov_b32 s35, 0x00020000
  s_mov_b32 s8, s4
  s_mov_b32 s9, s5
  s_mov_b32 s10, 6400000
  s_mov_b32 s11, 0x00020000
  s_mov_b32 s16, s6
  s_mov_b32 s17, s7
  s_mov_b32 s18, 7471104
  s_mov_b32 s19, 0x00020000
  s_mov_b32 s24, s78
  s_mov_b32 s25, s79
  s_mov_b32 s26, 6400000
  s_mov_b32 s27, 0x00020000
  s_add_u32 s28, s78, 6400000
  s_addc_u32 s29, s79, 0
  s_mov_b32 s30, 300000
  s_mov_b32 s31, 0x00020000
  s_lshr_b32 s20, s2, 2
  s_lshl_b32 s20, s20, 4
  s_and_b32 s92, s2, 2
  s_lshl_b32 s92, s92, 9
  s_add_u32 s20, s20, s92
  s_and_b32 s92, s2, 1
  s_lshl_b32 s92, s92, 3
  s_add_u32 s20, s20, s92
  s_mul_i32 s92, s91, 29184
  s_add_u32 s68, s6, s92
  s_addc_u32 s69, s7, 0
  s_mov_b32 s70, 2048
  s_mov_b32 s71, 0x00020000
  s_mov_b32 s46, 0
  v_and_b32 v134, 7, v0
  v_bfe_u32 v135, v0, 4, 1
  v_lshlrev_b32 v135, 2, v135
  v_xor_b32 v134, v134, v135
  v_lshlrev_b32 v134, 4, v134
  v_xor_b32 v57, 0, v134
  v_xor_b32 v59, 16, v134
  v_xor_b32 v61, 32, v134
  v_xor_b32 v63, 48, v134
  s_mul_i32 s93, s2, 196
  s_lshl_b32 s94, s3, 5
  s_add_u32 s93, s93, s94
  s_lshl_b32 s93, s93, 7
  v_lshrrev_b32 v243, 3, v0
  v_lshlrev_b32 v243, 9, v243
  v_add_u32 v243, s93, v243
  v_add_u32 v220, v243, v57
  v_add_u32 v221, v243, v59
  v_add_u32 v221, 128, v221
  v_add_u32 v222, v243, v61
  v_add_u32 v222, 256, v222
  v_add_u32 v223, v243, v63
  v_add_u32 v223, 384, v223
  v_lshrrev_b32 v132, 3, v0
  v_and_b32 v133, 3, v132
  v_lshlrev_b32 v133, 1, v133
  v_and_b32 v134, 7, v0
  v_xor_b32 v133, v133, v134
  v_lshlrev_b32 v133, 4, v133
  v_lshl_add_u32 v228, v132, 7, v133
  v_add_u32 v243, 41408, v239
  ds_write_b128 v243, v[52:55] offset:0
  ds_write_b128 v243, v[52:55] offset:8192
  ds_write_b128 v243, v[52:55] offset:16384
  ds_write_b128 v243, v[52:55] offset:24576
  s_cmp_ge_u32 s3, 7
  s_cbranch_scc1 K3_sl_1
  buffer_load_dwordx4 v[76:79], v230, s[60:63], 0 offen
  buffer_load_dwordx4 v[80:83], v230, s[60:63], 0 offen offset:16
K3_sl_1:
  v_and_b32 v132, 31, v0
  v_lshrrev_b32 v133, 5, v0
  v_and_b32 v134, 3, v132
  v_lshrrev_b32 v135, 2, v132
  v_lshl_add_u32 v135, v134, 3, v135
  v_lshlrev_b32 v135, 7, v135
  v_bfe_u32 v136, v132, 3, 1
  v_lshl_or_b32 v136, v136, 2, v134
  v_xor_b32 v136, v136, v133
  v_lshlrev_b32 v136, 4, v136
  v_add_u32 v135, s88, v135
  v_xor_b32 v137, 0, v136
  v_add_u32 v64, v137, v135
  v_xor_b32 v137, 32, v136
  v_add_u32 v65, v137, v135
  v_xor_b32 v137, 64, v136
  v_add_u32 v66, v137, v135
  v_xor_b32 v137, 96, v136
  v_add_u32 v67, v137, v135
  v_bfe_u32 v134, v0, 4, 1
  v_lshlrev_b32 v134, 5, v134
  v_and_b32 v135, 3, v0
  v_lshl_add_u32 v134, v135, 3, v134
  v_bfe_u32 v135, v0, 2, 2
  s_add_u32 s93, s88, 32768
  v_lshl_add_u32 v136, v133, 2, v135
  v_bfe_u32 v137, v135, 1, 1
  v_lshl_or_b32 v137, v137, 2, v133
  v_lshlrev_b32 v137, 3, v137
  v_xor_b32 v137, v137, v134
  v_lshlrev_b32 v136, 6, v136
  v_add3_u32 v244, v136, v137, s93
  v_bfe_u32 v137, v132, 1, 1
  v_bfe_u32 v136, v132, 2, 1
  v_lshl_or_b32 v137, v137, 2, v136
  v_lshlrev_b32 v137, 3, v137
  v_lshl_add_u32 v136, v132, 6, v137
  v_add_u32 v245, s93, v136
  v_lshlrev_b32 v136, 10, v133
  v_lshl_add_u32 v136, v132, 3, v136
  v_add_u32 v246, 71200, v136
  v_lshlrev_b32 v247, 6, v133
  v_sub_u32 v247, 64, v247
  v_lshlrev_b32 v136, 3, v133
  v_add_u32 v248, 44544, v136
  s_lshl_b32 s94, s3, 10
  s_add_u32 s94, s94, 3392
  v_lshlrev_b32 v136, 3, v0
  v_add_u32 v249, s94, v136
  v_mov_b32 v2, 0
  v_mov_b32 v3, 0
  v_mov_b32 v54, 0x3f003f00
  v_mov_b32 v240, 0
  v_mov_b32 v206, 0
  v_mov_b32 v207, 0
  v_bfe_u32 v253, v0, 2, 3
  v_and_b32 v254, 3, v0
  v_lshlrev_b32 v254, 2, v254
  s_mov_b32 s0, 0xbf80
  s_mov_b32 s1, 0xbf800000
  s_mov_b32 s36, 0xbf317218
  s_mov_b32 s37, 0xbf317218
  s_mov_b32 s38, 1.0
  s_mov_b32 s39, 1.0
  s_movk_i32 s87, 128
  s_movk_i32 s89, 136
  s_mov_b32 s100, 0xffff
  s_mov_b32 s90, 0x80000000
  s_mov_b32 s80, 0
  s_mov_b32 s81, 0
  s_mov_b32 s82, 0
  s_mov_b32 s84, 2
  s_mov_b32 s86, 0
  s_mov_b32 s101, 0
  s_mov_b32 s72, 0x11111111
  s_mov_b32 s73, 0x11111111
  s_mov_b32 s74, -1
  s_mov_b32 s75, 0
  s_mov_b32 s76, 0
  s_mov_b32 s77, -1
  s_mov_b32 s40, 21913099
  s_movk_i32 s41, -196
  s_mov_b32 s42, 0xffff0000
  s_mov_b32 s44, 0xbfb8aa3b
  s_mov_b32 s45, 0xbfb8aa3b
  s_cmp_lg_u32 s3, 0
  s_cbranch_scc1 K2_nolut
  v_subrev_u32 v230, 12, v0
  v_mov_b32 v224, 0
  v_mov_b32 v225, 0
  v_mov_b32 v232, 0x3f80
  v_mov_b32 v233, 0x3f800000
  v_cmp_eq_u32 vcc, 0, v230
  s_nop 1
  v_cndmask_b32 v224, v224, v232, vcc
  v_cmp_eq_u32 vcc, 1, v230
  s_nop 1
  v_cndmask_b32 v224, v224, v233, vcc
  v_cmp_eq_u32 vcc, 2, v230
  s_nop 1
  v_cndmask_b32 v225, v225, v232, vcc
  v_cmp_eq_u32 vcc, 3, v230
  s_nop 1
  v_cndmask_b32 v225, v225, v233, vcc
  v_lshlrev_b32 v230, 3, v0
  v_cmp_gt_u32 vcc, 32, v0
  s_and_saveexec_b64 s[98:99], vcc
  ds_write_b64 v230, v[224:225]
  s_mov_b64 exec, s[98:99]
K2_nolut:
  v_lshlrev_b32 v243, 3, v238
  v_mov_b32 v242, 1
  v_cmp_gt_u32 vcc, s96, v243
  s_mov_b64 s[48:49], vcc
  s_lshl_b32 s92, s3, 11
  s_add_u32 m0, s88, 32768
  s_cmp_ge_u32 s3, 7
  s_cbranch_scc1 K3_w7b0
  s_waitcnt lgkmcnt(0)
  s_barrier
  s_waitcnt vmcnt(3)
  s_mov_b64 exec, s[48:49]
  v_mul_hi_u32 v88, v68, s40
  v_mul_hi_u32 v89, v69, s40
  v_mul_hi_u32 v90, v70, s40
  v_mul_hi_u32 v91, v71, s40
  v_mul_hi_u32 v92, v72, s40
  v_mul_hi_u32 v93, v73, s40
  v_mul_hi_u32 v94, v74, s40
  v_mul_hi_u32 v95, v75, s40
  v_mad_i32_i24 v68, v88, s41, v68
  v_mad_i32_i24 v69, v89, s41, v69
  v_mad_i32_i24 v70, v90, s41, v70
  v_mad_i32_i24 v71, v91, s41, v71
  v_mad_i32_i24 v72, v92, s41, v72
  v_mad_i32_i24 v73, v93, s41, v73
  v_mad_i32_i24 v74, v94, s41, v74
  v_mad_i32_i24 v75, v95, s41, v75
  v_lshlrev_b32 v88, 2, v88
  v_lshlrev_b32 v89, 2, v89
  v_lshlrev_b32 v90, 2, v90
  v_lshlrev_b32 v91, 2, v91
  v_lshlrev_b32 v92, 2, v92
  v_lshlrev_b32 v93, 2, v93
  v_lshlrev_b32 v94, 2, v94
  v_lshlrev_b32 v95, 2, v95
  ds_add_rtn_u32 v100, v88, v242 offset:5440
  ds_add_rtn_u32 v101, v89, v242 offset:5440
  ds_add_rtn_u32 v102, v90, v242 offset:5440
  ds_add_rtn_u32 v103, v91, v242 offset:5440
  ds_add_rtn_u32 v104, v92, v242 offset:5440
  ds_add_rtn_u32 v105, v93, v242 offset:5440
  ds_add_rtn_u32 v106, v94, v242 offset:5440
  ds_add_rtn_u32 v107, v95, v242 offset:5440
  v_lshlrev_b32 v108, 3, v68
  v_lshlrev_b32 v110, 3, v69
  v_lshlrev_b32 v112, 3, v70
  v_lshlrev_b32 v114, 3, v71
  v_lshlrev_b32 v116, 3, v72
  v_lshlrev_b32 v118, 3, v73
  v_lshlrev_b32 v120, 3, v74
  v_lshlrev_b32 v122, 3, v75
  s_mov_b64 exec, -1
  buffer_load_dwordx4 v228, s[32:35], s92 offen lds
  buffer_load_dwordx4 v228, s[32:35], s92 offen offset:1024 lds
  s_waitcnt lgkmcnt(0)
  s_branch K3_nocount
K3_w7b0:
  buffer_load_dwordx4 v228, s[32:35], s92 offen lds
  buffer_load_dwordx4 v228, s[32:35], s92 offen offset:1024 lds
  s_barrier
  s_cmp_eq_u32 s91, 0
  s_cbranch_scc1 K3_w7b2
  s_waitcnt vmcnt(12)
K3_w7b2:
  v_readfirstlane_b32 s43, v211
  s_sub_u32 s46, s21, s43
  s_add_u32 s46, s46, 2000
  s_cmp_lt_u32 s46, 4000
  s_cselect_b32 s46, s43, 0
  buffer_load_dword v211, v210, s[64:67], 0 offen sc1
K3_nocount:
  s_barrier
  v_lshlrev_b32 v241, 4, v0
  ds_read_b128 v[140:143], v241 offset:5440
  s_waitcnt lgkmcnt(0)
  v_add_u32 v160, 1, v140
  v_add_u32 v161, 1, v141
  v_add_u32 v162, 1, v142
  v_add_u32 v163, 1, v143
  v_and_b32 v160, -2, v160
  v_and_b32 v161, -2, v161
  v_and_b32 v162, -2, v162
  v_and_b32 v163, -2, v163
  v_add_u32 v144, v160, v161
  v_add3_u32 v144, v144, v162, v163
  v_mov_b32 v145, v144
  s_nop 1
  v_add_u32_dpp v145, v145, v145 row_shr:1 row_mask:0xf bank_mask:0xf bound_ctrl:0
  s_nop 1
  v_add_u32_dpp v145, v145, v145 row_shr:2 row_mask:0xf bank_mask:0xf bound_ctrl:0
  s_nop 1
  v_add_u32_dpp v145, v145, v145 row_shr:4 row_mask:0xf bank_mask:0xf bound_ctrl:0
  s_nop 1
  v_add_u32_dpp v145, v145, v145 row_shr:8 row_mask:0xf bank_mask:0xf bound_ctrl:0
  s_nop 1
  v_add_u32_dpp v145, v145, v145 row_bcast:15 row_mask:0xa bank_mask:0xf
  s_nop 1
  v_add_u32_dpp v145, v145, v145 row_bcast:31 row_mask:0xc bank_mask:0xf
  v_sub_u32 v148, v145, v144
  v_add_u32 v149, v148, v160
  v_add_u32 v150, v149, v161
  v_add_u32 v151, v150, v162
  v_readlane_b32 s97, v145, 63
  s_cmp_ge_u32 s3, 7
  s_cbranch_scc1 K3_w7c
  ds_write_b128 v241, v[148:151] offset:6464
  s_mov_b64 exec, s[48:49]
  ds_read_b32 v68, v88 offset:6464
  ds_read_b32 v69, v89 offset:6464
  ds_read_b32 v70, v90 offset:6464
  ds_read_b32 v71, v91 offset:6464
  ds_read_b32 v72, v92 offset:6464
  ds_read_b32 v73, v93 offset:6464
  ds_read_b32 v74, v94 offset:6464
  ds_read_b32 v75, v95 offset:6464
  s_waitcnt vmcnt(2)
  v_lshl_or_b32 v109, v84, 16, v76
  v_and_or_b32 v111, v84, s42, v77
  v_lshl_or_b32 v113, v85, 16, v78
  v_and_or_b32 v115, v85, s42, v79
  v_lshl_or_b32 v117, v86, 16, v80
  v_and_or_b32 v119, v86, s42, v81
  v_lshl_or_b32 v121, v87, 16, v82
  v_and_or_b32 v123, v87, s42, v83
  s_waitcnt lgkmcnt(7)
  v_add_lshl_u32 v68, v68, v100, 3
  ds_write_b64 v68, v[108:109] offset:11584
  s_waitcnt lgkmcnt(7)
  v_add_lshl_u32 v69, v69, v101, 3
  ds_write_b64 v69, v[110:111] offset:11584
  s_waitcnt lgkmcnt(7)
  v_add_lshl_u32 v70, v70, v102, 3
  ds_write_b64 v70, v[112:113] offset:11584
  s_waitcnt lgkmcnt(7)
  v_add_lshl_u32 v71, v71, v103, 3
  ds_write_b64 v71, v[114:115] offset:11584
  s_waitcnt lgkmcnt(7)
  v_add_lshl_u32 v72, v72, v104, 3
  ds_write_b64 v72, v[116:117] offset:11584
  s_waitcnt lgkmcnt(7)
  v_add_lshl_u32 v73, v73, v105, 3
  ds_write_b64 v73, v[118:119] offset:11584
  s_waitcnt lgkmcnt(7)
  v_add_lshl_u32 v74, v74, v106, 3
  ds_write_b64 v74, v[120:121] offset:11584
  s_waitcnt lgkmcnt(7)
  v_add_lshl_u32 v75, v75, v107, 3
  ds_write_b64 v75, v[122:123] offset:11584
  s_mov_b64 exec, -1
  s_branch K3_scdone
K3_w7c:
  v_lshl_or_b32 v152, v140, 16, v148
  v_lshl_or_b32 v154, v141, 16, v149
  v_lshl_or_b32 v156, v142, 16, v150
  v_lshl_or_b32 v158, v143, 16, v151
  v_lshlrev_b32 v232, 4, v0
  s_cmp_eq_u32 s46, 0
  s_cbranch_scc1 K3_w7c1
  v_mov_b32 v153, s46
  v_mov_b32 v155, s46
  v_mov_b32 v157, s46
  v_mov_b32 v159, s46
  buffer_store_dwordx4 v[152:155], v232, s[68:71], 0 offen sc1
  buffer_store_dwordx4 v[156:159], v232, s[68:71], 0 offen offset:1024 sc1
  s_waitcnt vmcnt(3)
  v_lshlrev_b32 v137, 3, v0
  v_lshlrev_b32 v108, 16, v100
  v_and_b32 v109, s42, v100
  v_lshlrev_b32 v110, 16, v101
  v_mov_b32 v111, 1.0
  ds_write_b64 v137, v[108:109] offset:256
  ds_write_b64 v137, v[110:111] offset:1824
  v_lshlrev_b32 v112, 16, v102
  v_and_b32 v113, s42, v102
  v_lshlrev_b32 v114, 16, v103
  v_mov_b32 v115, 1.0
  ds_write_b64 v137, v[112:113] offset:768
  ds_write_b64 v137, v[114:115] offset:2336
  v_lshlrev_b32 v116, 16, v104
  v_and_b32 v117, s42, v104
  v_lshlrev_b32 v118, 16, v105
  v_mov_b32 v119, 1.0
  ds_write_b64 v137, v[116:117] offset:1280
  ds_write_b64 v137, v[118:119] offset:2848
  v_lshlrev_b32 v120, 16, v106
  v_and_b32 v121, s42, v106
  v_lshlrev_b32 v122, 16, v107
  v_mov_b32 v123, 1.0
  s_mov_b64 exec, 0xf
  ds_write_b64 v137, v[120:121] offset:1792
  ds_write_b64 v137, v[122:123] offset:3360
  s_mov_b64 exec, -1
  s_branch K3_tagok
K3_w7c1:
  s_waitcnt vmcnt(1)
  v_lshlrev_b32 v137, 3, v0
  v_lshlrev_b32 v108, 16, v100
  v_and_b32 v109, s42, v100
  v_lshlrev_b32 v110, 16, v101
  v_mov_b32 v111, 1.0
  ds_write_b64 v137, v[108:109] offset:256
  ds_write_b64 v137, v[110:111] offset:1824
  v_lshlrev_b32 v112, 16, v102
  v_and_b32 v113, s42, v102
  v_lshlrev_b32 v114, 16, v103
  v_mov_b32 v115, 1.0
  ds_write_b64 v137, v[112:113] offset:768
  ds_write_b64 v137, v[114:115] offset:2336
  v_lshlrev_b32 v116, 16, v104
  v_and_b32 v117, s42, v104
  v_lshlrev_b32 v118, 16, v105
  v_mov_b32 v119, 1.0
  ds_write_b64 v137, v[116:117] offset:1280
  ds_write_b64 v137, v[118:119] offset:2848
  v_lshlrev_b32 v120, 16, v106
  v_and_b32 v121, s42, v106
  v_lshlrev_b32 v122, 16, v107
  v_mov_b32 v123, 1.0
  s_mov_b64 exec, 0xf
  ds_write_b64 v137, v[120:121] offset:1792
  ds_write_b64 v137, v[122:123] offset:3360
  s_mov_b64 exec, -1
  s_mov_b32 s94, 0
  s_waitcnt vmcnt(0)
  v_readfirstlane_b32 s43, v211
  s_sub_u32 s46, s21, s43
  s_add_u32 s46, s46, 2000
  s_cmp_lt_u32 s46, 4000
  s_cselect_b32 s46, s43, 0
  s_cmp_lg_u32 s46, 0
  s_cbranch_scc1 K3_w7c2
K3_tagpoll:
  buffer_load_dword v211, v210, s[64:67], 0 offen sc1
  s_waitcnt vmcnt(0)
  v_readfirstlane_b32 s43, v211
  s_sub_u32 s46, s21, s43
  s_add_u32 s46, s46, 2000
  s_cmp_lt_u32 s46, 4000
  s_cselect_b32 s46, s43, 0
  s_cmp_ge_u32 s94, 256
  s_cselect_b32 s46, s43, s46
  s_cmp_lg_u32 s46, 0
  s_cbranch_scc1 K3_w7c2
  s_add_u32 s94, s94, 1
  s_cmp_lt_u32 s94, 131072
  s_cbranch_scc1 K3_tagpoll
  s_branch K3_tagok
K3_w7c2:
  v_mov_b32 v153, s46
  v_mov_b32 v155, s46
  v_mov_b32 v157, s46
  v_mov_b32 v159, s46
  buffer_store_dwordx4 v[152:155], v232, s[68:71], 0 offen sc1
  buffer_store_dwordx4 v[156:159], v232, s[68:71], 0 offen offset:1024 sc1
K3_tagok:
  v_mov_b32 v210, 232
  v_mov_b32 v211, s46
  ds_write_b32 v210, v211
K3_scdone:
  s_waitcnt lgkmcnt(0)
  s_barrier
  v_mov_b32 v241, 232
  ds_read_b32 v243, v241
  v_and_b32 v234, 31, v0
  s_lshl_b32 s93, s3, 5
  v_add_u32 v234, s93, v234
  v_mul_u32_u24 v234, 29184, v234
  v_add_u32 v234, s20, v234
  s_waitcnt lgkmcnt(0)
  v_readfirstlane_b32 s46, v243
  s_and_b32 s4, s46, 0xfffff800
  s_mul_i32 s5, s46, 0x2c9277b5
  s_and_b32 s5, s5, 0xfffff800
  s_cmp_eq_u32 s46, 0
  s_cbranch_scc1 K2_done
  s_cmp_ge_u32 s3, 7
  s_cbranch_scc1 K3_codone
  ds_read_b128 v[68:71], v239 offset:11584
  ds_read_b128 v[72:75], v239 offset:18752
  ds_read_b128 v[76:79], v239 offset:25920
  ds_read_b128 v[80:83], v239 offset:33088
  s_mul_i32 s92, s91, 29184
  s_add_u32 s92, s92, 2048
  s_lshl_b32 s93, s97, 3
  s_min_u32 s93, s93, 27136
  s_add_u32 s56, s6, s92
  s_addc_u32 s57, s7, 0
  s_mov_b32 s58, s93
  s_mov_b32 s59, 0x00020000
  v_mov_b32 v241, 0x7ff
  v_add_u32 v231, 7168, v239
  v_add_u32 v232, 14336, v239
  v_add_u32 v233, 21504, v239
  s_waitcnt lgkmcnt(3)
  v_bfi_b32 v68, v241, v68, s4
  v_bfi_b32 v70, v241, v70, s5
  buffer_store_dwordx4 v[68:71], v239, s[56:59], 0 offen sc1
  s_waitcnt lgkmcnt(2)
  v_bfi_b32 v72, v241, v72, s4
  v_bfi_b32 v74, v241, v74, s5
  buffer_store_dwordx4 v[72:75], v231, s[56:59], 0 offen sc1
  s_waitcnt lgkmcnt(1)
  v_bfi_b32 v76, v241, v76, s4
  v_bfi_b32 v78, v241, v78, s5
  buffer_store_dwordx4 v[76:79], v232, s[56:59], 0 offen sc1
  s_waitcnt lgkmcnt(0)
  v_bfi_b32 v80, v241, v80, s4
  v_bfi_b32 v82, v241, v82, s5
  buffer_store_dwordx4 v[80:83], v233, s[56:59], 0 offen sc1
K3_codone:
  s_waitcnt vmcnt(4) lgkmcnt(0)
  v_lshlrev_b32 v241, 4, v0
  s_add_u32 s93, s88, 32768
  v_add_u32 v241, s93, v241
  ds_read_b128 v[100:103], v241 offset:0
  ds_read_b128 v[104:107], v241 offset:1024
  s_waitcnt lgkmcnt(1)
  v_lshlrev_b32 v108, 16, v100
  v_and_b32 v109, s42, v100
  v_lshlrev_b32 v110, 16, v101
  v_and_b32 v111, s42, v101
  v_lshlrev_b32 v112, 16, v102
  v_and_b32 v113, s42, v102
  v_lshlrev_b32 v114, 16, v103
  v_and_b32 v115, s42, v103
  v_pk_mul_f32 v[108:109], v[108:109], s[44:45]
  v_pk_mul_f32 v[110:111], v[110:111], s[44:45]
  v_pk_mul_f32 v[112:113], v[112:113], s[44:45]
  v_pk_mul_f32 v[114:115], v[114:115], s[44:45]
  v_cvt_pk_bf16_f32 v100, v108, v109
  v_cvt_pk_bf16_f32 v101, v110, v111
  v_cvt_pk_bf16_f32 v102, v112, v113
  v_cvt_pk_bf16_f32 v103, v114, v115
  ds_write_b128 v241, v[100:103] offset:0
  s_waitcnt lgkmcnt(1)
  v_lshlrev_b32 v116, 16, v104
  v_and_b32 v117, s42, v104
  v_lshlrev_b32 v118, 16, v105
  v_and_b32 v119, s42, v105
  v_lshlrev_b32 v120, 16, v106
  v_and_b32 v121, s42, v106
  v_lshlrev_b32 v122, 16, v107
  v_and_b32 v123, s42, v107
  v_pk_mul_f32 v[116:117], v[116:117], s[44:45]
  v_pk_mul_f32 v[118:119], v[118:119], s[44:45]
  v_pk_mul_f32 v[120:121], v[120:121], s[44:45]
  v_pk_mul_f32 v[122:123], v[122:123], s[44:45]
  v_cvt_pk_bf16_f32 v104, v116, v117
  v_cvt_pk_bf16_f32 v105, v118, v119
  v_cvt_pk_bf16_f32 v106, v120, v121
  v_cvt_pk_bf16_f32 v107, v122, v123
  ds_write_b128 v241, v[104:107] offset:1024
  s_waitcnt lgkmcnt(0)
  s_barrier
  v_bfe_u32 v132, v0, 2, 2
  v_lshrrev_b32 v133, 5, v0
  v_lshl_add_u32 v133, v133, 3, v132
  v_lshlrev_b32 v133, 7, v133
  v_bfe_u32 v134, v0, 4, 1
  v_bfe_u32 v135, v0, 1, 1
  v_lshl_or_b32 v134, v134, 1, v135
  v_lshlrev_b32 v132, 1, v132
  v_xor_b32 v134, v134, v132
  v_and_b32 v135, 1, v0
  v_lshlrev_b32 v135, 3, v135
  v_add_u32 v133, v133, v135
  v_add_u32 v133, 131072, v133
  v_lshl_add_u32 v230, v134, 4, v133
  v_xor_b32 v134, 4, v134
  v_lshl_add_u32 v231, v134, 4, v133
  ds_read_b64_tr_b16 v[4:5], v230 offset:16384
  ds_read_b64_tr_b16 v[6:7], v230 offset:16896
  ds_read_b64_tr_b16 v[8:9], v231 offset:16384
  ds_read_b64_tr_b16 v[10:11], v231 offset:16896
  ds_read_b64_tr_b16 v[12:13], v230 offset:20480
  ds_read_b64_tr_b16 v[14:15], v230 offset:20992
  ds_read_b64_tr_b16 v[16:17], v231 offset:20480
  ds_read_b64_tr_b16 v[18:19], v231 offset:20992
  ds_read_b64_tr_b16 v[20:21], v230 offset:24576
  ds_read_b64_tr_b16 v[22:23], v230 offset:25088
  ds_read_b64_tr_b16 v[24:25], v231 offset:24576
  ds_read_b64_tr_b16 v[26:27], v231 offset:25088
  ds_read_b64_tr_b16 v[28:29], v230 offset:28672
  ds_read_b64_tr_b16 v[30:31], v230 offset:29184
  ds_read_b64_tr_b16 v[32:33], v231 offset:28672
  ds_read_b64_tr_b16 v[34:35], v231 offset:29184
  v_lshlrev_b32 v242, 1, v0
  v_add_u32 v242, 97760, v242
  v_lshrrev_b32 v243, 5, v0
  v_lshlrev_b32 v243, 3, v243
  v_add_u32 v243, 98080, v243
  ds_read2_b64 v[36:39], v243 offset0:0 offset1:2
  ds_read2_b64 v[40:43], v243 offset0:4 offset1:6
  ds_read2_b64 v[44:47], v243 offset0:8 offset1:10
  ds_read2_b64 v[48:51], v243 offset0:12 offset1:14
  s_mov_b64 exec, s[76:77]
  ds_read_u16 v196, v242
  ds_read_u16 v197, v242 offset:128
  ds_read_u16 v198, v242 offset:64
  ds_read_u16 v199, v242 offset:192
  s_mov_b64 exec, -1
  ds_read_b64_tr_b16 v[132:133], v230 offset:0
  ds_read_b64_tr_b16 v[134:135], v230 offset:512
  ds_read_b64_tr_b16 v[136:137], v231 offset:0
  ds_read_b64_tr_b16 v[138:139], v231 offset:512
  ds_read_b64_tr_b16 v[140:141], v230 offset:4096
  ds_read_b64_tr_b16 v[142:143], v230 offset:4608
  ds_read_b64_tr_b16 v[144:145], v231 offset:4096
  ds_read_b64_tr_b16 v[146:147], v231 offset:4608
  ds_read_b64_tr_b16 v[148:149], v230 offset:8192
  ds_read_b64_tr_b16 v[150:151], v230 offset:8704
  ds_read_b64_tr_b16 v[152:153], v231 offset:8192
  ds_read_b64_tr_b16 v[154:155], v231 offset:8704
  ds_read_b64_tr_b16 v[156:157], v230 offset:12288
  ds_read_b64_tr_b16 v[158:159], v230 offset:12800
  ds_read_b64_tr_b16 v[160:161], v231 offset:12288
  ds_read_b64_tr_b16 v[162:163], v231 offset:12800
  s_waitcnt lgkmcnt(15)
  s_mov_b64 exec, s[76:77]
  v_lshlrev_b32 v196, 16, v196
  v_lshlrev_b32 v197, 16, v197
  v_lshlrev_b32 v198, 16, v198
  v_lshlrev_b32 v199, 16, v199
  v_pk_mul_f32 v[196:197], v[196:197], s[44:45]
  v_pk_mul_f32 v[198:199], v[198:199], s[44:45]
  v_cvt_pk_bf16_f32 v2, v196, v197
  v_cvt_pk_bf16_f32 v3, v198, v199
  s_mov_b64 exec, -1
  buffer_load_dwordx2 v[216:217], v234, s[16:19], 0 offen
  s_mov_b32 s84, 1
  s_mov_b32 s94, 0
K3_poll:
  s_waitcnt vmcnt(0)
K3_poll1:
  v_xor_b32 v218, s46, v217
  v_and_b32 v219, 0xf000f000, v216
  v_or_b32 v218, v218, v219
  v_cmp_ne_u32 vcc, 0, v218
  s_nop 0
  s_cmp_eq_u64 vcc, 0
  s_cbranch_scc1 K3_polled
  s_add_u32 s94, s94, 1
  s_cmp_ge_u32 s94, 131072
  s_cbranch_scc1 K2_done
  s_mov_b64 exec, vcc
  buffer_load_dwordx2 v[216:217], v234, s[16:19], 0 offen sc1
  s_mov_b64 exec, -1
  s_branch K3_poll
K3_polled:
  s_branch K2_after_entries
K2_round:
  s_bitset0_b32 s84, 4
  s_or_b32 s92, s80, s81
  s_cmp_eq_u32 s92, 0
  s_cbranch_scc1 K2_round_c
  s_mul_i32 s93, s2, 50176
  s_add_u32 s93, s93, 16777216
  s_add_u32 s32, s6, s93
  s_addc_u32 s33, s7, 0
  s_mov_b32 s34, 50176
  s_mov_b32 s35, 0x00020000
  s_cmp_lg_u32 s101, 0
  s_cbranch_scc1 K2_round_c
  s_mov_b32 s101, 1
  s_lshl_b32 s93, s3, 6
  v_add_u32 v243, s93, v0
  v_lshlrev_b32 v243, 4, v243
  v_mov_b32 v164, 0
  v_mov_b32 v165, 0
  v_mov_b32 v166, 0
  v_mov_b32 v167, 0
  buffer_store_dwordx4 v[164:167], v243, s[32:35], 0 offen
  v_add_u32 v243, 8192, v243
  buffer_store_dwordx4 v[164:167], v243, s[32:35], 0 offen
  v_add_u32 v243, 8192, v243
  buffer_store_dwordx4 v[164:167], v243, s[32:35], 0 offen
  v_add_u32 v243, 8192, v243
  buffer_store_dwordx4 v[164:167], v243, s[32:35], 0 offen
  v_add_u32 v243, 8192, v243
  buffer_store_dwordx4 v[164:167], v243, s[32:35], 0 offen
  v_add_u32 v243, 8192, v243
  buffer_store_dwordx4 v[164:167], v243, s[32:35], 0 offen
  v_add_u32 v243, 8192, v243
  buffer_store_dwordx4 v[164:167], v243, s[32:35], 0 offen
K2_round_c:
  v_and_b32 v243, 31, v0
  s_lshl_b32 s93, s3, 5
  v_add_u32 v243, s93, v243
  v_mul_u32_u24 v243, 29184, v243
  v_add_u32 v243, s20, v243
  buffer_load_dword v216, v243, s[16:19], 0 offen sc1
  s_lshl_b32 s93, s3, 6
  v_add_u32 v243, s93, v0
  v_lshlrev_b32 v241, 3, v243
  v_cmp_gt_u32 vcc, 256, v243
  s_and_saveexec_b64 s[98:99], vcc
  ds_write_b64 v241, v[52:53] offset:3392
  s_mov_b64 exec, s[98:99]
  v_mov_b32 v241, 0
  ds_write_b64 v241, v[52:53] offset:224
  s_waitcnt vmcnt(0) lgkmcnt(0)
  s_barrier
K2_after_entries:
  v_lshrrev_b32 v217, 16, v216
  v_lshrrev_b32 v241, 3, v0
  v_cmp_lt_u32 vcc, 16, v217
  v_and_b32 v243, 3, v241
  s_or_b32 s92, s80, s81
  s_bcnt1_i32_b32 s91, vcc_lo
  s_mov_b32 s98, vcc_lo
  s_cmp_gt_u32 s91, 16
  s_cselect_b32 s92, 1, s92
  s_cmp_lg_u32 s92, 0
  s_cbranch_scc1 K2_issue_gen
  v_lshrrev_b32 v242, 2, v241
  v_lshl_add_u32 v243, v243, 3, v242
  v_lshlrev_b32 v228, 2, v243
  ds_bpermute_b32 v84, v228, v216 offset:0
  ds_bpermute_b32 v85, v228, v216 offset:8
  ds_bpermute_b32 v86, v228, v216 offset:16
  ds_bpermute_b32 v87, v228, v216 offset:24
  v_mbcnt_lo_u32_b32 v229, s98, 0
  s_mov_b32 s99, 0
  v_lshlrev_b32 v229, 2, v229
  v_mul_u32_u24 v219, 29184, v0
  v_mov_b32 v242, 252
  v_cndmask_b32 v229, v242, v229, s[98:99]
  ds_permute_b32 v90, v229, v216
  ds_permute_b32 v91, v229, v219
  s_lshl_b32 s93, s3, 5
  v_and_b32 v242, 7, v0
  v_add_u32 v243, s93, v243
  v_lshlrev_b32 v242, 1, v242
  v_mul_u32_u24 v243, 29184, v243
  v_add_u32 v218, 1, v242
  v_lshl_add_u32 v243, v242, 3, v243
  v_lshlrev_b32 v241, 2, v241
  s_mov_b32 s94, 8
  v_mov_b32 v228, s90
  v_cmp_lt_u32 vcc, 32, v217
  s_waitcnt lgkmcnt(0)
  ds_bpermute_b32 v88, v241, v90
  ds_bpermute_b32 v124, v241, v91
  ds_bpermute_b32 v89, v241, v90 offset:32
  ds_bpermute_b32 v125, v241, v91 offset:32
  v_cmp_lt_u32_sdwa s[40:41], v242, v84 src0_sel:DWORD src1_sel:WORD_1
  v_cmp_lt_u32_sdwa s[42:43], v218, v84 src0_sel:DWORD src1_sel:WORD_1
  v_mad_u32_u16 v84, v84, s94, v243
  v_add_u32 v243, 58368, v243
  v_cmp_lt_u32_sdwa s[44:45], v242, v85 src0_sel:DWORD src1_sel:WORD_1
  v_cmp_lt_u32_sdwa s[46:47], v218, v85 src0_sel:DWORD src1_sel:WORD_1
  v_mad_u32_u16 v85, v85, s94, v243
  v_add_u32 v243, 58368, v243
  v_cndmask_b32 v84, v228, v84, s[40:41]
  buffer_load_dwordx4 v[100:103], v84, s[16:19], 0 offen offset:2048
  v_cmp_lt_u32_sdwa s[48:49], v242, v86 src0_sel:DWORD src1_sel:WORD_1
  v_cmp_lt_u32_sdwa s[50:51], v218, v86 src0_sel:DWORD src1_sel:WORD_1
  v_mad_u32_u16 v86, v86, s94, v243
  v_add_u32 v243, 58368, v243
  v_cndmask_b32 v85, v228, v85, s[44:45]
  buffer_load_dwordx4 v[104:107], v85, s[16:19], 0 offen offset:2048
  v_cmp_lt_u32_sdwa s[52:53], v242, v87 src0_sel:DWORD src1_sel:WORD_1
  v_cmp_lt_u32_sdwa s[54:55], v218, v87 src0_sel:DWORD src1_sel:WORD_1
  v_mad_u32_u16 v87, v87, s94, v243
  v_cndmask_b32 v86, v228, v86, s[48:49]
  buffer_load_dwordx4 v[108:111], v86, s[16:19], 0 offen offset:2048
  s_mul_i32 s93, s3, 933888
  v_add_u32 v242, 16, v242
  v_cndmask_b32 v87, v228, v87, s[52:53]
  v_add_u32 v218, 16, v218
  buffer_load_dwordx4 v[112:115], v87, s[16:19], 0 offen offset:2048
  v_lshl_add_u32 v243, v242, 3, s93
  s_waitcnt lgkmcnt(0)
  v_cmp_lt_u32_sdwa s[56:57], v242, v88 src0_sel:DWORD src1_sel:WORD_1
  v_cmp_lt_u32_sdwa s[58:59], v218, v88 src0_sel:DWORD src1_sel:WORD_1
  v_mad_u32_u16 v88, v88, s94, v243
  v_add_u32 v88, v88, v124
  v_cndmask_b32 v88, v228, v88, s[56:57]
  buffer_load_dwordx4 v[116:119], v88, s[16:19], 0 offen offset:2048
  v_cmp_lt_u32_sdwa s[60:61], v242, v89 src0_sel:DWORD src1_sel:WORD_1
  v_cmp_lt_u32_sdwa s[62:63], v218, v89 src0_sel:DWORD src1_sel:WORD_1
  v_mad_u32_u16 v89, v89, s94, v243
  v_add_u32 v89, v89, v125
  v_cndmask_b32 v89, v228, v89, s[60:61]
  s_cmp_le_u32 s91, 8
  s_cselect_b32 s91, 5, 6
  s_cbranch_scc1 K2_issue_c5
  buffer_load_dwordx4 v[120:123], v89, s[16:19], 0 offen offset:2048
K2_issue_c5:
  s_mov_b64 s[64:65], 0
  s_mov_b64 s[66:67], 0
  s_mov_b64 s[68:69], 0
  s_mov_b64 s[70:71], 0
  s_branch K2_issue_done
K2_issue_gen:
  s_mov_b32 s91, 8
  v_lshrrev_b32 v241, 4, v0
  v_lshlrev_b32 v243, 5, v241
  ds_bpermute_b32 v84, v243, v216 offset:0
  ds_bpermute_b32 v85, v243, v216 offset:4
  ds_bpermute_b32 v86, v243, v216 offset:8
  ds_bpermute_b32 v87, v243, v216 offset:12
  ds_bpermute_b32 v88, v243, v216 offset:16
  ds_bpermute_b32 v89, v243, v216 offset:20
  ds_bpermute_b32 v90, v243, v216 offset:24
  ds_bpermute_b32 v91, v243, v216 offset:28
  s_cmp_eq_u32 s81, 0
  s_cselect_b32 s92, s3, s82
  s_cmp_eq_u32 s92, s3
  s_cselect_b32 s92, 0, 0x10000
  v_and_b32 v242, 15, v0
  s_add_u32 s93, s80, s92
  v_lshl_add_u32 v242, v242, 1, s93
  v_add_u32 v218, 1, v242
  s_lshl_b32 s93, s3, 5
  v_lshl_add_u32 v241, v241, 3, s93
  v_mul_u32_u24 v241, 29184, v241
  v_lshl_add_u32 v241, v242, 3, v241
  s_mov_b32 s94, 8
  v_mov_b32 v243, s90
  s_add_u32 s95, s80, 32
  v_lshrrev_b32 v217, 16, v216
  v_cmp_lt_u32 vcc, s95, v217
  s_mov_b32 s93, 0
  s_waitcnt lgkmcnt(7)
  v_cmp_lt_u32_sdwa s[40:41], v242, v84 src0_sel:DWORD src1_sel:WORD_1
  v_cmp_lt_u32_sdwa s[42:43], v218, v84 src0_sel:DWORD src1_sel:WORD_1
  v_mad_u32_u16 v84, v84, s94, v241
  v_add_u32 v241, 29184, v241
  s_waitcnt lgkmcnt(6)
  v_cmp_lt_u32_sdwa s[44:45], v242, v85 src0_sel:DWORD src1_sel:WORD_1
  v_cmp_lt_u32_sdwa s[46:47], v218, v85 src0_sel:DWORD src1_sel:WORD_1
  v_mad_u32_u16 v85, v85, s94, v241
  v_add_u32 v241, 29184, v241
  v_cndmask_b32 v84, v243, v84, s[40:41]
  buffer_load_dwordx4 v[100:103], v84, s[16:19], s93 offen offset:2048
  s_waitcnt lgkmcnt(5)
  v_cmp_lt_u32_sdwa s[48:49], v242, v86 src0_sel:DWORD src1_sel:WORD_1
  v_cmp_lt_u32_sdwa s[50:51], v218, v86 src0_sel:DWORD src1_sel:WORD_1
  v_mad_u32_u16 v86, v86, s94, v241
  v_add_u32 v241, 29184, v241
  v_cndmask_b32 v85, v243, v85, s[44:45]
  buffer_load_dwordx4 v[104:107], v85, s[16:19], s93 offen offset:2048
  s_waitcnt lgkmcnt(4)
  v_cmp_lt_u32_sdwa s[52:53], v242, v87 src0_sel:DWORD src1_sel:WORD_1
  v_cmp_lt_u32_sdwa s[54:55], v218, v87 src0_sel:DWORD src1_sel:WORD_1
  v_mad_u32_u16 v87, v87, s94, v241
  v_add_u32 v241, 29184, v241
  v_cndmask_b32 v86, v243, v86, s[48:49]
  buffer_load_dwordx4 v[108:111], v86, s[16:19], s93 offen offset:2048
  s_waitcnt lgkmcnt(3)
  v_cmp_lt_u32_sdwa s[56:57], v242, v88 src0_sel:DWORD src1_sel:WORD_1
  v_cmp_lt_u32_sdwa s[58:59], v218, v88 src0_sel:DWORD src1_sel:WORD_1
  v_mad_u32_u16 v88, v88, s94, v241
  v_add_u32 v241, 29184, v241
  v_cndmask_b32 v87, v243, v87, s[52:53]
  buffer_load_dwordx4 v[112:115], v87, s[16:19], s93 offen offset:2048
  s_waitcnt lgkmcnt(2)
  v_cmp_lt_u32_sdwa s[60:61], v242, v89 src0_sel:DWORD src1_sel:WORD_1
  v_cmp_lt_u32_sdwa s[62:63], v218, v89 src0_sel:DWORD src1_sel:WORD_1
  v_mad_u32_u16 v89, v89, s94, v241
  v_add_u32 v241, 29184, v241
  v_cndmask_b32 v88, v243, v88, s[56:57]
  buffer_load_dwordx4 v[116:119], v88, s[16:19], s93 offen offset:2048
  s_waitcnt lgkmcnt(1)
  v_cmp_lt_u32_sdwa s[64:65], v242, v90 src0_sel:DWORD src1_sel:WORD_1
  v_cmp_lt_u32_sdwa s[66:67], v218, v90 src0_sel:DWORD src1_sel:WORD_1
  v_mad_u32_u16 v90, v90, s94, v241
  v_add_u32 v241, 29184, v241
  v_cndmask_b32 v89, v243, v89, s[60:61]
  buffer_load_dwordx4 v[120:123], v89, s[16:19], s93 offen offset:2048
  s_waitcnt lgkmcnt(0)
  v_cmp_lt_u32_sdwa s[68:69], v242, v91 src0_sel:DWORD src1_sel:WORD_1
  v_cmp_lt_u32_sdwa s[70:71], v218, v91 src0_sel:DWORD src1_sel:WORD_1
  v_mad_u32_u16 v91, v91, s94, v241
  v_cndmask_b32 v90, v243, v90, s[64:65]
  buffer_load_dwordx4 v[124:127], v90, s[16:19], s93 offen offset:2048
  s_nop 0
  v_cndmask_b32 v91, v243, v91, s[68:69]
  buffer_load_dwordx4 v[128:131], v91, s[16:19], s93 offen offset:2048
K2_issue_done:
  s_cmp_lg_u64 vcc, 0
  s_cbranch_scc0 K2_nomore
  v_mov_b32 v241, 0
  v_mov_b32 v243, 1
  ds_write_b32 v241, v243 offset:224
K2_nomore:
  s_mov_b32 exec_lo, 0xfffffffe
  s_mov_b32 exec_hi, 0xfffffffe
  v_mov_b64 v[36:37], 0
  v_mov_b64 v[38:39], 0
  v_mov_b64 v[40:41], 0
  v_mov_b64 v[42:43], 0
  v_mov_b64 v[44:45], 0
  v_mov_b64 v[46:47], 0
  v_mov_b64 v[48:49], 0
  v_mov_b64 v[50:51], 0
  s_mov_b64 exec, -1
  s_and_b32 s93, s2, 31
  s_mul_i32 s93, s93, 75
  s_mul_i32 s94, s3, 10
  s_add_u32 s93, s93, s94
  v_add_u32 v243, s93, v0
  v_mul_u32_u24 v243, 21, v243
  s_mov_b64 exec, 0x3ff
  buffer_load_dword v224, v243, s[12:15], 0 idxen
  s_mov_b64 exec, -1
  s_or_b32 s92, s80, s81
  s_cmp_lg_u32 s92, 0
  s_cselect_b64 s[78:79], -1, 0
  s_cselect_b32 s97, 1, s86
  s_mov_b32 s95, 0
  s_waitcnt vmcnt(1)
K2_tagchk:
  v_mov_b32 v241, 0
  s_mov_b64 exec, s[40:41]
  v_xor_b32 v100, s4, v100
  v_xor_b32 v102, s5, v102
  v_max3_u32 v241, v241, v100, v102
  s_mov_b64 exec, s[44:45]
  v_xor_b32 v104, s4, v104
  v_xor_b32 v106, s5, v106
  v_max3_u32 v241, v241, v104, v106
  s_mov_b64 exec, s[48:49]
  v_xor_b32 v108, s4, v108
  v_xor_b32 v110, s5, v110
  v_max3_u32 v241, v241, v108, v110
  s_mov_b64 exec, s[52:53]
  v_xor_b32 v112, s4, v112
  v_xor_b32 v114, s5, v114
  v_max3_u32 v241, v241, v112, v114
  s_mov_b64 exec, s[56:57]
  v_xor_b32 v116, s4, v116
  v_xor_b32 v118, s5, v118
  v_max3_u32 v241, v241, v116, v118
  s_cmp_le_u32 s91, 5
  s_cbranch_scc1 K2_tc_end
  s_mov_b64 exec, s[60:61]
  v_xor_b32 v120, s4, v120
  v_xor_b32 v122, s5, v122
  v_max3_u32 v241, v241, v120, v122
  s_cmp_le_u32 s91, 6
  s_cbranch_scc1 K2_tc_end
  s_mov_b64 exec, s[64:65]
  v_xor_b32 v124, s4, v124
  v_xor_b32 v126, s5, v126
  v_max3_u32 v241, v241, v124, v126
  s_mov_b64 exec, s[68:69]
  v_xor_b32 v128, s4, v128
  v_xor_b32 v130, s5, v130
  v_max3_u32 v241, v241, v128, v130
K2_tc_end:
  s_mov_b64 exec, -1
  v_cmp_lt_u32 vcc, 0x7ff, v241
  s_nop 0
  s_cmp_eq_u64 vcc, 0
  s_cbranch_scc1 K2_count
K2_retry:
  s_add_u32 s95, s95, 1
  s_cmp_ge_u32 s95, 131072
  s_cbranch_scc1 K2_done
  s_mov_b32 s94, 0
  s_mov_b64 exec, s[40:41]
  v_max_u32 v243, v100, v102
  v_cmp_lt_u32 vcc, 0x7ff, v243
  s_mov_b32 s93, 0
  s_cmp_eq_u64 vcc, 0
  s_cbranch_scc1 K2_rt0
  s_bitset1_b32 s94, 0
  buffer_load_dwordx4 v[100:103], v84, s[16:19], s93 offen offset:2048 sc1
K2_rt0:
  s_mov_b64 exec, s[44:45]
  v_max_u32 v243, v104, v106
  v_cmp_lt_u32 vcc, 0x7ff, v243
  s_mov_b32 s93, 0
  s_cmp_eq_u64 vcc, 0
  s_cbranch_scc1 K2_rt1
  s_bitset1_b32 s94, 1
  buffer_load_dwordx4 v[104:107], v85, s[16:19], s93 offen offset:2048 sc1
K2_rt1:
  s_mov_b64 exec, s[48:49]
  v_max_u32 v243, v108, v110
  v_cmp_lt_u32 vcc, 0x7ff, v243
  s_mov_b32 s93, 0
  s_cmp_eq_u64 vcc, 0
  s_cbranch_scc1 K2_rt2
  s_bitset1_b32 s94, 2
  buffer_load_dwordx4 v[108:111], v86, s[16:19], s93 offen offset:2048 sc1
K2_rt2:
  s_mov_b64 exec, s[52:53]
  v_max_u32 v243, v112, v114
  v_cmp_lt_u32 vcc, 0x7ff, v243
  s_mov_b32 s93, 0
  s_cmp_eq_u64 vcc, 0
  s_cbranch_scc1 K2_rt3
  s_bitset1_b32 s94, 3
  buffer_load_dwordx4 v[112:115], v87, s[16:19], s93 offen offset:2048 sc1
K2_rt3:
  s_mov_b64 exec, s[56:57]
  v_max_u32 v243, v116, v118
  v_cmp_lt_u32 vcc, 0x7ff, v243
  s_mov_b32 s93, 0
  s_cmp_eq_u64 vcc, 0
  s_cbranch_scc1 K2_rt4
  s_bitset1_b32 s94, 4
  buffer_load_dwordx4 v[116:119], v88, s[16:19], s93 offen offset:2048 sc1
K2_rt4:
  s_mov_b64 exec, s[60:61]
  v_max_u32 v243, v120, v122
  v_cmp_lt_u32 vcc, 0x7ff, v243
  s_mov_b32 s93, 0
  s_cmp_eq_u64 vcc, 0
  s_cbranch_scc1 K2_rt5
  s_bitset1_b32 s94, 5
  buffer_load_dwordx4 v[120:123], v89, s[16:19], s93 offen offset:2048 sc1
K2_rt5:
  s_mov_b64 exec, s[64:65]
  v_max_u32 v243, v124, v126
  v_cmp_lt_u32 vcc, 0x7ff, v243
  s_mov_b32 s93, 0
  s_cmp_eq_u64 vcc, 0
  s_cbranch_scc1 K2_rt6
  s_bitset1_b32 s94, 6
  buffer_load_dwordx4 v[124:127], v90, s[16:19], s93 offen offset:2048 sc1
K2_rt6:
  s_mov_b64 exec, s[68:69]
  v_max_u32 v243, v128, v130
  v_cmp_lt_u32 vcc, 0x7ff, v243
  s_mov_b32 s93, 0
  s_cmp_eq_u64 vcc, 0
  s_cbranch_scc1 K2_rt7
  s_bitset1_b32 s94, 7
  buffer_load_dwordx4 v[128:131], v91, s[16:19], s93 offen offset:2048 sc1
K2_rt7:
  s_mov_b64 exec, -1
  v_mov_b32 v241, 0
  s_waitcnt vmcnt(0)
  s_bitcmp1_b32 s94, 0
  s_cbranch_scc0 K2_ru0
  s_mov_b64 exec, s[40:41]
  v_xor_b32 v100, s4, v100
  v_xor_b32 v102, s5, v102
  v_max3_u32 v241, v241, v100, v102
K2_ru0:
  s_bitcmp1_b32 s94, 1
  s_cbranch_scc0 K2_ru1
  s_mov_b64 exec, s[44:45]
  v_xor_b32 v104, s4, v104
  v_xor_b32 v106, s5, v106
  v_max3_u32 v241, v241, v104, v106
K2_ru1:
  s_bitcmp1_b32 s94, 2
  s_cbranch_scc0 K2_ru2
  s_mov_b64 exec, s[48:49]
  v_xor_b32 v108, s4, v108
  v_xor_b32 v110, s5, v110
  v_max3_u32 v241, v241, v108, v110
K2_ru2:
  s_bitcmp1_b32 s94, 3
  s_cbranch_scc0 K2_ru3
  s_mov_b64 exec, s[52:53]
  v_xor_b32 v112, s4, v112
  v_xor_b32 v114, s5, v114
  v_max3_u32 v241, v241, v112, v114
K2_ru3:
  s_bitcmp1_b32 s94, 4
  s_cbranch_scc0 K2_ru4
  s_mov_b64 exec, s[56:57]
  v_xor_b32 v116, s4, v116
  v_xor_b32 v118, s5, v118
  v_max3_u32 v241, v241, v116, v118
K2_ru4:
  s_bitcmp1_b32 s94, 5
  s_cbranch_scc0 K2_ru5
  s_mov_b64 exec, s[60:61]
  v_xor_b32 v120, s4, v120
  v_xor_b32 v122, s5, v122
  v_max3_u32 v241, v241, v120, v122
K2_ru5:
  s_bitcmp1_b32 s94, 6
  s_cbranch_scc0 K2_ru6
  s_mov_b64 exec, s[64:65]
  v_xor_b32 v124, s4, v124
  v_xor_b32 v126, s5, v126
  v_max3_u32 v241, v241, v124, v126
K2_ru6:
  s_bitcmp1_b32 s94, 7
  s_cbranch_scc0 K2_ru7
  s_mov_b64 exec, s[68:69]
  v_xor_b32 v128, s4, v128
  v_xor_b32 v130, s5, v130
  v_max3_u32 v241, v241, v128, v130
K2_ru7:
  s_mov_b64 exec, -1
  v_cmp_lt_u32 vcc, 0x7ff, v241
  s_nop 0
  s_cmp_lg_u64 vcc, 0
  s_cbranch_scc1 K2_retry
K2_count:
  s_cmp_eq_u32 s84, 1
  s_cbranch_scc0 K3_norows
  s_cmp_ge_u32 s3, 7
  s_cbranch_scc1 K3_norows
  s_add_u32 m0, s88, 0
  s_nop 0
  buffer_load_dwordx4 v220, s[8:11], 0 offen lds
  s_add_u32 m0, s88, 1024
  s_nop 0
  buffer_load_dwordx4 v221, s[8:11], 0 offen lds
  s_add_u32 m0, s88, 2048
  s_nop 0
  buffer_load_dwordx4 v222, s[8:11], 0 offen lds
  s_add_u32 m0, s88, 3072
  s_nop 0
  buffer_load_dwordx4 v223, s[8:11], 0 offen lds
K3_norows:
  v_mov_b32 v242, 1
  v_lshrrev_b32 v68, 1, v100
  v_lshrrev_b32 v69, 1, v102
  v_lshrrev_b32 v70, 1, v104
  v_lshrrev_b32 v71, 1, v106
  v_lshrrev_b32 v72, 1, v108
  v_lshrrev_b32 v73, 1, v110
  v_lshrrev_b32 v74, 1, v112
  v_lshrrev_b32 v75, 1, v114
  v_lshrrev_b32 v76, 1, v116
  v_lshrrev_b32 v77, 1, v118
  s_mov_b64 exec, s[40:41]
  ds_add_rtn_u32 v180, v68, v242 offset:3392
  s_mov_b64 exec, s[42:43]
  ds_add_rtn_u32 v181, v69, v242 offset:3392
  s_mov_b64 exec, s[44:45]
  ds_add_rtn_u32 v182, v70, v242 offset:3392
  s_mov_b64 exec, s[46:47]
  ds_add_rtn_u32 v183, v71, v242 offset:3392
  s_mov_b64 exec, s[48:49]
  ds_add_rtn_u32 v184, v72, v242 offset:3392
  s_mov_b64 exec, s[50:51]
  ds_add_rtn_u32 v185, v73, v242 offset:3392
  s_mov_b64 exec, s[52:53]
  ds_add_rtn_u32 v186, v74, v242 offset:3392
  s_mov_b64 exec, s[54:55]
  ds_add_rtn_u32 v187, v75, v242 offset:3392
  s_mov_b64 exec, s[56:57]
  ds_add_rtn_u32 v188, v76, v242 offset:3392
  s_mov_b64 exec, s[58:59]
  ds_add_rtn_u32 v189, v77, v242 offset:3392
  s_mov_b64 exec, -1
  s_cmp_le_u32 s91, 5
  s_cbranch_scc1 K2_cnt_end
  v_lshrrev_b32 v78, 1, v120
  v_lshrrev_b32 v79, 1, v122
  s_mov_b64 exec, s[60:61]
  ds_add_rtn_u32 v190, v78, v242 offset:3392
  s_mov_b64 exec, s[62:63]
  ds_add_rtn_u32 v191, v79, v242 offset:3392
  s_mov_b64 exec, -1
  s_cmp_le_u32 s91, 6
  s_cbranch_scc1 K2_cnt_end
  v_lshrrev_b32 v80, 1, v124
  v_lshrrev_b32 v81, 1, v126
  v_lshrrev_b32 v82, 1, v128
  v_lshrrev_b32 v83, 1, v130
  s_mov_b64 exec, s[64:65]
  ds_add_rtn_u32 v192, v80, v242 offset:3392
  s_mov_b64 exec, s[66:67]
  ds_add_rtn_u32 v193, v81, v242 offset:3392
  s_mov_b64 exec, s[68:69]
  ds_add_rtn_u32 v194, v82, v242 offset:3392
  s_mov_b64 exec, s[70:71]
  ds_add_rtn_u32 v195, v83, v242 offset:3392
K2_cnt_end:
  s_mov_b64 exec, -1
  s_waitcnt lgkmcnt(0)
  s_barrier
  s_cmp_eq_u32 s84, 1
  s_cbranch_scc0 K2_nowh
  s_mov_b32 s92, s22
  s_mov_b32 s93, s23
  s_mov_b32 s94, 16384
  s_mov_b32 s95, 0x00020000
  v_lshrrev_b32 v243, 3, v0
  v_and_b32 v241, 3, v243
  v_lshlrev_b32 v241, 1, v241
  v_and_b32 v242, 7, v0
  v_xor_b32 v241, v241, v242
  v_lshlrev_b32 v241, 4, v241
  v_lshl_add_u32 v241, v243, 7, v241
  s_lshl_b32 s98, s3, 11
  s_add_u32 m0, s88, 34816
  s_nop 0
  buffer_load_dwordx4 v241, s[92:95], s98 offen lds
  buffer_load_dwordx4 v241, s[92:95], s98 offen offset:1024 lds
K2_nowh:
  v_lshlrev_b32 v241, 4, v0
  ds_read_b128 v[164:167], v241 offset:3392
  v_mov_b32 v243, 0
  ds_read_b32 v242, v243 offset:224
  s_mul_i32 s92, s97, 31
  s_not_b32 s93, s92
  s_waitcnt lgkmcnt(1)
  v_add_u32 v172, v164, v165
  v_add3_u32 v172, v172, v166, v167
  v_add_u32 v173, s92, v172
  v_and_b32 v173, s93, v173
  v_mov_b32 v174, v173
  s_nop 1
  v_add_u32_dpp v174, v174, v174 row_shr:1 row_mask:0xf bank_mask:0xf bound_ctrl:0
  s_nop 1
  v_add_u32_dpp v174, v174, v174 row_shr:2 row_mask:0xf bank_mask:0xf bound_ctrl:0
  s_nop 1
  v_add_u32_dpp v174, v174, v174 row_shr:4 row_mask:0xf bank_mask:0xf bound_ctrl:0
  s_nop 1
  v_add_u32_dpp v174, v174, v174 row_shr:8 row_mask:0xf bank_mask:0xf bound_ctrl:0
  s_nop 1
  v_add_u32_dpp v174, v174, v174 row_bcast:15 row_mask:0xa bank_mask:0xf
  s_nop 1
  v_add_u32_dpp v174, v174, v174 row_bcast:31 row_mask:0xc bank_mask:0xf
  s_waitcnt lgkmcnt(0)
  v_readfirstlane_b32 s83, v242
  v_readlane_b32 s96, v174, 63
  v_sub_u32 v176, v174, v173
  v_sub_u32 v174, v174, v173
  v_add_u32 v177, v176, v164
  v_add_u32 v178, v177, v165
  v_add_u32 v179, v178, v166
  s_cmp_eq_u32 s81, 0
  s_cselect_b32 s92, s96, 0
  s_cmp_gt_u32 s92, 3664
  s_cbranch_scc0 K2_modeok
  s_mov_b32 s81, 1
  s_mov_b32 s82, 0
  s_barrier
  s_branch K2_round
K2_modeok:
  ds_write_b128 v241, v[176:179] offset:4416
  s_cmp_le_u32 s91, 5
  s_cbranch_scc1 K2_off_a
  ds_read_b32 v206, v78 offset:4416
  ds_read_b32 v207, v79 offset:4416
  s_cmp_le_u32 s91, 6
  s_cbranch_scc1 K2_off_a
  ds_read_b32 v208, v80 offset:4416
  ds_read_b32 v209, v81 offset:4416
  ds_read_b32 v210, v82 offset:4416
  ds_read_b32 v211, v83 offset:4416
K2_off_a:
  ds_read_b32 v196, v68 offset:4416
  ds_read_b32 v197, v69 offset:4416
  ds_read_b32 v198, v70 offset:4416
  ds_read_b32 v199, v71 offset:4416
  ds_read_b32 v200, v72 offset:4416
  ds_read_b32 v201, v73 offset:4416
  ds_read_b32 v202, v74 offset:4416
  ds_read_b32 v203, v75 offset:4416
  ds_read_b32 v204, v76 offset:4416
  ds_read_b32 v205, v77 offset:4416
  s_add_u32 s92, s96, 31
  s_lshr_b32 s92, s92, 5
  s_lshr_b32 s93, s92, 3
  s_and_b32 s94, s92, 7
  s_min_u32 s95, s93, 0
  s_sub_u32 s85, s93, s95
  s_add_u32 s93, s93, s95
  s_min_u32 s98, s94, 4
  s_sub_u32 s95, s94, s98
  s_mov_b32 s94, s98
  s_lshl_b32 s98, s85, 2
  s_add_u32 s98, s98, s94
  s_cmp_ge_u32 s3, 4
  s_cselect_b32 s85, s93, s85
  s_cselect_b32 s94, s95, s94
  s_cselect_b32 s98, s98, 0
  s_and_b32 s95, s3, 3
  s_mul_i32 s93, s95, s85
  s_add_u32 s93, s93, s98
  s_min_u32 s98, s95, s94
  s_add_u32 s93, s93, s98
  s_cmp_lt_u32 s95, s94
  s_addc_u32 s85, s85, 0
  s_add_u32 s95, s93, s85
  s_lshl_b32 s93, s93, 8
  s_add_u32 s93, s93, 11584
  v_lshlrev_b32 v241, 3, v0
  v_add_u32 v251, s93, v241
  v_lshrrev_b32 v241, 3, v0
  v_lshlrev_b32 v241, 5, v241
  v_add_u32 v250, s93, v241
  s_waitcnt lgkmcnt(9)
  v_add_lshl_u32 v196, v196, v180, 3
  s_waitcnt lgkmcnt(8)
  v_add_lshl_u32 v197, v197, v181, 3
  s_waitcnt lgkmcnt(7)
  v_add_lshl_u32 v198, v198, v182, 3
  s_waitcnt lgkmcnt(6)
  v_add_lshl_u32 v199, v199, v183, 3
  s_waitcnt lgkmcnt(5)
  v_add_lshl_u32 v200, v200, v184, 3
  s_waitcnt lgkmcnt(4)
  v_add_lshl_u32 v201, v201, v185, 3
  s_waitcnt lgkmcnt(3)
  v_add_lshl_u32 v202, v202, v186, 3
  s_waitcnt lgkmcnt(2)
  v_add_lshl_u32 v203, v203, v187, 3
  s_waitcnt lgkmcnt(1)
  v_add_lshl_u32 v204, v204, v188, 3
  s_waitcnt lgkmcnt(0)
  v_add_lshl_u32 v205, v205, v189, 3
  s_mov_b64 exec, s[40:41]
  ds_write_b64 v196, v[100:101] offset:11584
  s_mov_b64 exec, s[42:43]
  ds_write_b64 v197, v[102:103] offset:11584
  s_mov_b64 exec, s[44:45]
  ds_write_b64 v198, v[104:105] offset:11584
  s_mov_b64 exec, s[46:47]
  ds_write_b64 v199, v[106:107] offset:11584
  s_mov_b64 exec, s[48:49]
  ds_write_b64 v200, v[108:109] offset:11584
  s_mov_b64 exec, s[50:51]
  ds_write_b64 v201, v[110:111] offset:11584
  s_mov_b64 exec, s[52:53]
  ds_write_b64 v202, v[112:113] offset:11584
  s_mov_b64 exec, s[54:55]
  ds_write_b64 v203, v[114:115] offset:11584
  s_mov_b64 exec, s[56:57]
  ds_write_b64 v204, v[116:117] offset:11584
  s_mov_b64 exec, s[58:59]
  ds_write_b64 v205, v[118:119] offset:11584
  s_cmp_le_u32 s91, 5
  s_cbranch_scc1 K2_sc_end
  s_mov_b64 exec, -1
  v_add_lshl_u32 v206, v206, v190, 3
  v_add_lshl_u32 v207, v207, v191, 3
  s_mov_b64 exec, s[60:61]
  ds_write_b64 v206, v[120:121] offset:11584
  s_mov_b64 exec, s[62:63]
  ds_write_b64 v207, v[122:123] offset:11584
  s_cmp_le_u32 s91, 6
  s_cbranch_scc1 K2_sc_end
  s_mov_b64 exec, -1
  v_add_lshl_u32 v208, v208, v192, 3
  v_add_lshl_u32 v209, v209, v193, 3
  v_add_lshl_u32 v210, v210, v194, 3
  v_add_lshl_u32 v211, v211, v195, 3
  s_mov_b64 exec, s[64:65]
  ds_write_b64 v208, v[124:125] offset:11584
  s_mov_b64 exec, s[66:67]
  ds_write_b64 v209, v[126:127] offset:11584
  s_mov_b64 exec, s[68:69]
  ds_write_b64 v210, v[128:129] offset:11584
  s_mov_b64 exec, s[70:71]
  ds_write_b64 v211, v[130:131] offset:11584
K2_sc_end:
  s_mov_b64 exec, -1
  s_cmp_eq_u32 s97, 0
  s_cbranch_scc1 K2_nopads
  v_lshlrev_b32 v228, 5, v0
  v_add_u32 v228, 24, v228
  v_mov_b32 v229, s100
  v_add_u32 v175, v174, v172
  v_add_u32 v243, v174, v173
  s_mov_b32 s93, 31
K2_padloop:
  v_cmp_lt_u32 vcc, v175, v243
  s_and_saveexec_b64 s[98:99], vcc
  v_lshlrev_b32 v241, 3, v175
  ds_write_b64 v241, v[228:229] offset:11584
  s_mov_b64 exec, s[98:99]
  v_add_u32 v175, 1, v175
  s_sub_u32 s93, s93, 1
  s_cmp_lg_u32 s93, 0
  s_cbranch_scc1 K2_padloop
K2_nopads:
  s_mov_b32 s63, 0
  s_cmp_eq_u32 s84, 1
  s_cbranch_scc0 K2_norowrd
  s_cmp_ge_u32 s3, 7
  s_cbranch_scc1 K2_norowrd
  s_waitcnt vmcnt(2)
K2_norowrd:
  s_waitcnt lgkmcnt(0)
  s_barrier
  s_cmp_ge_u32 s3, 4
  s_cbranch_scc0 K2_pro_pa
  s_setprio 3
  s_branch K2_pro_q
K2_pro_pa:
  s_setprio 3
  s_mov_b32 s84, 2
  s_cmp_eq_u32 s85, 0
  s_cbranch_scc0 K2_pro_1A
  s_barrier
  s_waitcnt vmcnt(0) lgkmcnt(0)
  s_barrier
  s_branch K2_loop_skip
K2_pro_1A:
  s_sub_u32 s85, s85, 1
  s_cmp_eq_u32 s95, s92
  s_cbranch_scc0 K2_notailA
  s_lshl_b32 s93, s96, 3
  v_mov_b32 v241, s93
  ds_read_b32 v228, v241 offset:11576
  v_lshlrev_b32 v243, 3, v0
  v_add_u32 v241, s93, v243
  v_mov_b32 v229, s100
  s_waitcnt lgkmcnt(0)
  ds_write_b64 v241, v[228:229] offset:11584
K2_notailA:
  ds_read2_b32 v[230:231], v250 offset0:1 offset1:3
  ds_read2_b32 v[232:233], v250 offset0:5 offset1:7
  ds_read_u16 v190, v251 offset:4
  ds_read2_b32 v[204:205], v250 offset0:65 offset1:67
  ds_read2_b32 v[206:207], v250 offset0:69 offset1:71
  ds_read_b64 v[234:235], v251
  ds_read_u16 v240, v251 offset:516
  v_lshl_add_u32 v252, v247, 2, v249
  v_subrev_u32 v252, 256, v252
  s_add_u32 s92, s88, 32768
  s_waitcnt lgkmcnt(5)
  v_mad_u32_u16 v230, v230, s87, v57
  v_mad_u32_u16 v231, v231, s87, v59
  v_mad_u32_u16 v232, v232, s87, v61
  v_mad_u32_u16 v233, v233, s87, v63
  s_add_u32 m0, s92, 0
  s_nop 0
  buffer_load_dwordx4 v230, s[8:11], 0 offen lds
  s_add_u32 m0, s92, 1024
  s_nop 0
  buffer_load_dwordx4 v231, s[8:11], 0 offen lds
  s_add_u32 m0, s92, 16384
  s_nop 0
  buffer_load_dwordx4 v232, s[8:11], 0 offen lds
  s_add_u32 m0, s92, 17408
  s_nop 0
  buffer_load_dwordx4 v233, s[8:11], 0 offen lds
  s_mov_b32 s68, s12
  s_and_b32 s69, s13, 0xffff
  s_mov_b32 s70, 300000
  s_mov_b32 s71, 0x00020000
  s_waitcnt lgkmcnt(4)
  v_lshrrev_b32 v191, 1, v190
  v_add_lshl_u32 v191, v190, v191, 2
  buffer_load_dwordx2 v[188:189], v191, s[68:71], 0 offen
  s_waitcnt lgkmcnt(2)
  v_mad_u32_u16 v204, v204, s87, v57
  v_mad_u32_u16 v205, v205, s87, v59
  v_mad_u32_u16 v206, v206, s87, v61
  v_mad_u32_u16 v207, v207, s87, v63
  s_barrier
  s_waitcnt lgkmcnt(0)
  ds_read2_b64 v[220:223], v234 offset0:32 offset1:228
  ds_read_u16 v56, v250 offset:516
  ds_read_u16 v58, v250 offset:524
  ds_read_u16 v60, v250 offset:532
  ds_read_u16 v62, v250 offset:540
  v_add_u32 v250, 768, v250
  v_readlane_b32 s40, v234, 0
  v_readlane_b32 s44, v234, 31
  v_readlane_b32 s41, v234, 32
  v_readlane_b32 s45, v234, 63
  v_bitop3_b32 v236, v234, 56, v245 bitop3:0x6a
  s_lshr_b32 s60, s40, 3
  s_mov_b32 s61, s60
  s_add_u32 s50, s40, 64
  s_and_b32 s48, s40, 0xffffffe0
  s_sub_u32 s49, 0, s48
  v_lshl_add_u32 v242, s48, 4, v246
  v_mov_b64 v[132:133], 0
  v_mov_b64 v[134:135], 0
  v_mov_b64 v[136:137], 0
  v_mov_b64 v[138:139], 0
  v_mov_b64 v[140:141], 0
  v_mov_b64 v[142:143], 0
  v_mov_b64 v[144:145], 0
  v_mov_b64 v[146:147], 0
  v_mov_b64 v[148:149], 0
  v_mov_b64 v[150:151], 0
  v_mov_b64 v[152:153], 0
  v_mov_b64 v[154:155], 0
  v_mov_b64 v[156:157], 0
  v_mov_b64 v[158:159], 0
  v_mov_b64 v[160:161], 0
  v_mov_b64 v[162:163], 0
  v_bfe_u32 v184, v0, 1, 1
  v_mul_u32_u24 v184, 14336, v184
  v_add_u32 v180, v184, v64
  v_add_u32 v181, v184, v65
  v_add_u32 v182, v184, v66
  v_add_u32 v183, v184, v67
  s_add_u32 m0, s88, 0
  s_nop 0
  buffer_load_dwordx4 v204, s[8:11], 0 offen lds
  s_add_u32 m0, s88, 1024
  s_nop 0
  buffer_load_dwordx4 v205, s[8:11], 0 offen lds
  s_add_u32 m0, s88, 2048
  s_nop 0
  buffer_load_dwordx4 v206, s[8:11], 0 offen lds
  s_add_u32 m0, s88, 3072
  s_nop 0
  buffer_load_dwordx4 v207, s[8:11], 0 offen lds
  s_waitcnt vmcnt(5)
  ds_read_b128 v[164:167], v180 offset:32768
  ds_read_b128 v[168:171], v181 offset:32768
  ds_read_b128 v[172:175], v182 offset:32768
  ds_read_b128 v[176:179], v183 offset:32768
  s_waitcnt lgkmcnt(3)
  v_mfma_f32_32x32x16_bf16 v[68:83], v[164:167], v[4:7], 0
  v_mfma_f32_32x32x16_bf16 v[84:99], v[164:167], v[8:11], 0
  s_waitcnt lgkmcnt(2)
  v_mfma_f32_32x32x16_bf16 v[68:83], v[168:171], v[12:15], v[68:83]
  v_mfma_f32_32x32x16_bf16 v[84:99], v[168:171], v[16:19], v[84:99]
  s_waitcnt lgkmcnt(1)
  v_mfma_f32_32x32x16_bf16 v[68:83], v[172:175], v[20:23], v[68:83]
  v_mfma_f32_32x32x16_bf16 v[84:99], v[172:175], v[24:27], v[84:99]
  s_waitcnt lgkmcnt(0)
  v_mfma_f32_32x32x16_bf16 v[68:83], v[176:179], v[28:31], v[68:83]
  v_mfma_f32_32x32x16_bf16 v[84:99], v[176:179], v[32:35], v[84:99]
  buffer_load_dword v216, v240, s[12:15], 0 idxen
  buffer_load_ushort v217, v240, s[12:15], 0 idxen offset:4
  s_waitcnt vmcnt(6) lgkmcnt(0)
  v_lshlrev_b32 v191, 4, v190
  v_alignbit_b32 v188, v189, v188, v191
  v_bfe_u32 v189, v189, v191, 16
  v_dot2_f32_bf16 v228, v188, s0, v220
  v_dot2_f32_bf16 v229, v188, s1, v221
  v_dot2_f32_bf16 v238, v189, s0, v222
  s_nop 0
  v_mul_f32 v239, v228, v228
  v_cvt_pk_bf16_f32 v224, 1.0, v228
  v_fmac_f32 v239, v229, v229
  v_cvt_pk_bf16_f32 v225, v229, v238
  v_fmac_f32 v239, v238, v238
  v_cvt_pk_bf16_f32 v239, v239, v239
  v_cmp_ne_u16 s[64:65], s100, v235
  v_bfi_b32 v235, s100, v239, v235
  ds_write_b64 v249, v[234:235] offset:0
  ds_read_b64 v[234:235], v251 offset:512
  ds_read_b64 v[214:215], v252 offset:0
  v_lshlrev_b32 v243, 4, v0
  v_add_u32 v243, s92, v243
  v_mov_b32 v204, 0
  v_mov_b32 v205, 0
  v_mov_b32 v206, 0
  v_mov_b32 v207, 0
  s_waitcnt lgkmcnt(0)
  v_add3_u32 v241, v214, v247, s49
  ds_read_b64 v[212:213], v241 offset:32
  s_mov_b64 exec, s[74:75]
  ds_read_b64 v[214:215], v241 offset:0
  s_mov_b64 exec, -1
  ds_write_b128 v243, v[204:207] offset:0
  ds_write_b128 v243, v[204:207] offset:1024
  s_sub_u32 s68, s8, 3072
  s_subb_u32 s69, s9, 0
  s_or_b32 s69, s69, 8388608
  s_mov_b32 s70, 50000
  s_mov_b32 s71, 0x00020000
  s_mov_b32 m0, s88
  v_add_u32 v57, 3072, v57
  v_add_u32 v59, 2048, v59
  v_add_u32 v61, 1024, v61
  s_barrier
  ds_read_b64 v[180:181], v242
  ds_read_b64 v[184:185], v242 offset:256
  v_mov_b32 v182, 0
  v_mov_b32 v183, v2
  v_mov_b32 v186, 0
  v_mov_b32 v187, v3
  s_mov_b64 exec, s[74:75]
  ds_read_b64 v[182:183], v242 offset:512
  ds_read_b64 v[186:187], v242 offset:768
  s_mov_b64 exec, -1
  s_waitcnt lgkmcnt(0)
  v_mfma_f32_32x32x16_bf16 v[68:83], v[212:215], v[180:183], v[68:83]
  v_mfma_f32_32x32x16_bf16 v[84:99], v[212:215], v[184:187], v[84:99]
  s_nop 10
  v_exp_f32 v196, v68
  v_exp_f32 v197, v69
  v_exp_f32 v198, v70
  v_exp_f32 v199, v71
  v_exp_f32 v200, v72
  v_exp_f32 v201, v73
  v_exp_f32 v202, v74
  v_exp_f32 v203, v75
  v_exp_f32 v204, v76
  v_exp_f32 v205, v77
  v_exp_f32 v206, v78
  v_exp_f32 v207, v79
  v_exp_f32 v208, v80
  v_exp_f32 v209, v81
  v_exp_f32 v210, v82
  v_exp_f32 v211, v83
  s_nop 1
  v_mfma_f32_32x32x8_bf16 v[196:211], v[54:55], v[54:55], v[196:211]
  s_setprio 1
  s_mov_b32 s62, 0
  s_cmp_eq_u32 s85, 0
  s_cbranch_scc1 K2_tailA0
  s_sub_u32 s85, s85, 2
  s_cbranch_scc1 K2_preA0
K2_loopA:
  s_setprio 2
  s_waitcnt vmcnt(2)
  ds_read_b128 v[164:167], v64
  ds_read_b128 v[168:171], v65
  ds_read_b128 v[172:175], v66
  ds_read_b128 v[176:179], v67
  ds_read_b64 v[214:215], v252 offset:256
  s_and_b64 exec, s[74:75], s[64:65]
  ds_write_b64 v236, v[224:225]
  s_mov_b64 exec, -1
  ds_read_b64_tr_b16 v[188:189], v244 offset:0
  ds_read_b64_tr_b16 v[190:191], v244 offset:512
  ds_read_b64_tr_b16 v[192:193], v244 offset:1024
  ds_read_b64_tr_b16 v[194:195], v244 offset:1536
  ds_write_b64 v236, v[52:53]
  ds_read2_b64 v[220:223], v234 offset0:32 offset1:228
  ds_read_u16 v240, v251 offset:1028
  s_and_b32 s48, s41, 0xffffffe0
  s_sub_u32 s49, 0, s48
  v_lshl_add_u32 v242, s48, 4, v246
  ds_read_b64 v[180:181], v242
  ds_read_b64 v[184:185], v242 offset:256
  s_waitcnt lgkmcnt(10)
  v_add3_u32 v241, v214, v247, s49
  ds_read_b64 v[212:213], v241 offset:32
  s_mov_b64 exec, s[74:75]
  ds_read_b64 v[214:215], v241 offset:0
  ds_read_b64 v[182:183], v242 offset:512
  ds_read_b64 v[186:187], v242 offset:768
  s_mov_b64 exec, -1
  buffer_load_dwordx4 v[56:57], s[68:71], 0 idxen offen offset:0 lds
  buffer_load_dwordx4 v[58:59], s[68:71], 0 idxen offen offset:1024 lds
  buffer_load_dwordx4 v[60:61], s[68:71], 0 idxen offen offset:2048 lds
  buffer_load_dwordx4 v[62:63], s[68:71], 0 idxen offen offset:3072 lds
  ds_read_u16 v56, v250 offset:4
  ds_read_u16 v58, v250 offset:12
  ds_read_u16 v60, v250 offset:20
  ds_read_u16 v62, v250 offset:28
  s_cmp_ge_u32 s44, s50
  s_cbranch_scc1 K2_flushA0
K2_backA0:
  s_setprio 0
  v_mfma_f32_32x32x16_bf16 v[100:115], v[164:167], v[4:7], 0
  v_rcp_f32 v196, v196
  v_rcp_f32 v197, v197
  v_rcp_f32 v198, v198
  v_rcp_f32 v199, v199
  v_mfma_f32_32x32x16_bf16 v[116:131], v[164:167], v[8:11], 0
  v_rcp_f32 v200, v200
  v_rcp_f32 v201, v201
  v_rcp_f32 v202, v202
  v_rcp_f32 v203, v203
  v_mfma_f32_32x32x16_bf16 v[100:115], v[168:171], v[12:15], v[100:115]
  v_rcp_f32 v204, v204
  v_rcp_f32 v205, v205
  v_rcp_f32 v206, v206
  v_rcp_f32 v207, v207
  v_rcp_f32 v208, v208
  v_rcp_f32 v209, v209
  v_rcp_f32 v210, v210
  v_rcp_f32 v211, v211
  s_setprio 1
  v_pk_mul_f32 v[196:197], v[196:197], v[68:69]
  v_pk_mul_f32 v[198:199], v[198:199], v[70:71]
  v_pk_mul_f32 v[200:201], v[200:201], v[72:73]
  v_pk_mul_f32 v[202:203], v[202:203], v[74:75]
  v_pk_mul_f32 v[204:205], v[204:205], v[76:77]
  v_pk_mul_f32 v[206:207], v[206:207], v[78:79]
  v_pk_mul_f32 v[208:209], v[208:209], v[80:81]
  v_pk_mul_f32 v[210:211], v[210:211], v[82:83]
  v_mfma_f32_32x32x16_bf16 v[116:131], v[168:171], v[16:19], v[116:131]
  v_exp_f32 v68, v84
  v_exp_f32 v69, v85
  v_exp_f32 v70, v86
  v_mfma_f32_32x32x16_bf16 v[100:115], v[172:175], v[20:23], v[100:115]
  v_exp_f32 v71, v87
  v_exp_f32 v72, v88
  v_exp_f32 v73, v89
  v_mfma_f32_32x32x16_bf16 v[116:131], v[172:175], v[24:27], v[116:131]
  v_exp_f32 v74, v90
  v_exp_f32 v75, v91
  v_exp_f32 v76, v92
  v_mfma_f32_32x32x16_bf16 v[100:115], v[176:179], v[28:31], v[100:115]
  v_exp_f32 v77, v93
  v_exp_f32 v78, v94
  v_exp_f32 v79, v95
  v_exp_f32 v80, v96
  v_exp_f32 v81, v97
  v_exp_f32 v82, v98
  v_exp_f32 v83, v99
  s_nop 1
  v_mfma_f32_32x32x8_bf16 v[68:83], v[54:55], v[54:55], v[68:83]
  v_cvt_pk_bf16_f32 v196, v196, v197
  v_cvt_pk_bf16_f32 v197, v198, v199
  v_cvt_pk_bf16_f32 v198, v200, v201
  v_cvt_pk_bf16_f32 v199, v202, v203
  v_cvt_pk_bf16_f32 v200, v204, v205
  s_waitcnt lgkmcnt(0)
  v_mfma_f32_32x32x16_bf16 v[132:147], v[196:199], v[188:191], v[132:147]
  v_cvt_pk_bf16_f32 v201, v206, v207
  v_cvt_pk_bf16_f32 v202, v208, v209
  v_cvt_pk_bf16_f32 v203, v210, v211
  v_readlane_b32 s42, v234, 0
  v_readlane_b32 s46, v234, 31
  v_mfma_f32_32x32x16_bf16 v[132:147], v[200:203], v[192:195], v[132:147]
  v_readlane_b32 s43, v234, 32
  v_readlane_b32 s47, v234, 63
  v_bitop3_b32 v237, v234, 56, v245 bitop3:0x6a
  s_waitcnt vmcnt(4)
  v_rcp_f32 v68, v68
  v_rcp_f32 v69, v69
  v_rcp_f32 v70, v70
  v_rcp_f32 v71, v71
  v_rcp_f32 v72, v72
  v_rcp_f32 v73, v73
  v_mfma_f32_32x32x16_bf16 v[100:115], v[212:215], v[180:183], v[100:115]
  v_rcp_f32 v74, v74
  v_rcp_f32 v75, v75
  v_rcp_f32 v76, v76
  v_rcp_f32 v77, v77
  v_mfma_f32_32x32x16_bf16 v[116:131], v[176:179], v[32:35], v[116:131]
  v_rcp_f32 v78, v78
  v_rcp_f32 v79, v79
  v_rcp_f32 v80, v80
  v_rcp_f32 v81, v81
  v_rcp_f32 v82, v82
  v_rcp_f32 v83, v83
  v_dot2_f32_bf16 v228, v216, s0, v220
  v_dot2_f32_bf16 v229, v216, s1, v221
  v_dot2_f32_bf16 v238, v217, s0, v222
  v_pk_mul_f32 v[68:69], v[68:69], v[84:85]
  v_pk_mul_f32 v[70:71], v[70:71], v[86:87]
  v_pk_mul_f32 v[72:73], v[72:73], v[88:89]
  v_pk_mul_f32 v[74:75], v[74:75], v[90:91]
  v_pk_mul_f32 v[76:77], v[76:77], v[92:93]
  v_pk_mul_f32 v[78:79], v[78:79], v[94:95]
  v_pk_mul_f32 v[80:81], v[80:81], v[96:97]
  v_pk_mul_f32 v[82:83], v[82:83], v[98:99]
  v_mul_f32 v239, v228, v228
  v_cvt_pk_bf16_f32 v226, 1.0, v228
  v_fmac_f32 v239, v229, v229
  v_cvt_pk_bf16_f32 v227, v229, v238
  v_exp_f32 v196, v100
  v_exp_f32 v197, v101
  v_exp_f32 v198, v102
  v_exp_f32 v199, v103
  v_mfma_f32_32x32x16_bf16 v[116:131], v[212:215], v[184:187], v[116:131]
  v_exp_f32 v200, v104
  v_exp_f32 v201, v105
  v_exp_f32 v202, v106
  v_exp_f32 v203, v107
  v_exp_f32 v204, v108
  v_exp_f32 v205, v109
  v_exp_f32 v206, v110
  v_exp_f32 v207, v111
  v_exp_f32 v208, v112
  v_exp_f32 v209, v113
  v_exp_f32 v210, v114
  v_exp_f32 v211, v115
  v_fmac_f32 v239, v238, v238
  v_cvt_pk_bf16_f32 v239, v239, v239
  v_mfma_f32_32x32x8_bf16 v[196:211], v[54:55], v[54:55], v[196:211]
  v_cmp_ne_u16 s[66:67], s100, v235
  v_bfi_b32 v235, s100, v239, v235
  v_cvt_pk_bf16_f32 v68, v68, v69
  v_cvt_pk_bf16_f32 v69, v70, v71
  v_cvt_pk_bf16_f32 v70, v72, v73
  v_cvt_pk_bf16_f32 v71, v74, v75
  v_cvt_pk_bf16_f32 v72, v76, v77
  v_cvt_pk_bf16_f32 v73, v78, v79
  v_mfma_f32_32x32x16_bf16 v[148:163], v[68:71], v[188:191], v[148:163]
  v_cvt_pk_bf16_f32 v74, v80, v81
  v_cvt_pk_bf16_f32 v75, v82, v83
  s_sub_u32 s85, s85, 1
  ds_write_b64 v249, v[234:235] offset:512
  v_mfma_f32_32x32x16_bf16 v[148:163], v[72:75], v[192:195], v[148:163]
  s_cbranch_scc1 K2_preA1
  s_setprio 2
  s_waitcnt vmcnt(0)
  ds_read_b128 v[164:167], v64
  ds_read_b128 v[168:171], v65
  ds_read_b128 v[172:175], v66
  ds_read_b128 v[176:179], v67
  ds_read_b64 v[214:215], v252 offset:512
  s_and_b64 exec, s[76:77], s[64:65]
  ds_write_b64 v236, v[224:225]
  s_mov_b64 exec, -1
  ds_read_b64_tr_b16 v[188:189], v244 offset:0
  ds_read_b64_tr_b16 v[190:191], v244 offset:512
  ds_read_b64_tr_b16 v[192:193], v244 offset:1024
  ds_read_b64_tr_b16 v[194:195], v244 offset:1536
  ds_write_b64 v236, v[52:53]
  ds_read_b64 v[234:235], v251 offset:1024
  s_and_b32 s48, s42, 0xffffffe0
  s_sub_u32 s49, 0, s48
  v_lshl_add_u32 v242, s48, 4, v246
  ds_read_b64 v[180:181], v242
  ds_read_b64 v[184:185], v242 offset:256
  s_waitcnt lgkmcnt(9)
  v_add3_u32 v241, v214, v247, s49
  ds_read_b64 v[212:213], v241 offset:32
  s_mov_b64 exec, s[74:75]
  ds_read_b64 v[214:215], v241 offset:0
  ds_read_b64 v[182:183], v242 offset:512
  ds_read_b64 v[186:187], v242 offset:768
  s_mov_b64 exec, -1
  buffer_load_dwordx4 v[56:57], s[68:71], 0 idxen offen offset:0 lds
  buffer_load_dwordx4 v[58:59], s[68:71], 0 idxen offen offset:1024 lds
  buffer_load_dwordx4 v[60:61], s[68:71], 0 idxen offen offset:2048 lds
  buffer_load_dwordx4 v[62:63], s[68:71], 0 idxen offen offset:3072 lds
  buffer_load_dword v216, v240, s[12:15], 0 idxen
  buffer_load_ushort v217, v240, s[12:15], 0 idxen offset:4
  ds_read_u16 v56, v250 offset:260
  ds_read_u16 v58, v250 offset:268
  ds_read_u16 v60, v250 offset:276
  ds_read_u16 v62, v250 offset:284
  s_cmp_ge_u32 s45, s50
  s_cbranch_scc1 K2_flushA1
K2_backA1:
  s_setprio 0
  v_mfma_f32_32x32x16_bf16 v[68:83], v[164:167], v[4:7], 0
  v_rcp_f32 v196, v196
  v_rcp_f32 v197, v197
  v_rcp_f32 v198, v198
  v_rcp_f32 v199, v199
  v_mfma_f32_32x32x16_bf16 v[84:99], v[164:167], v[8:11], 0
  v_rcp_f32 v200, v200
  v_rcp_f32 v201, v201
  v_rcp_f32 v202, v202
  v_rcp_f32 v203, v203
  v_mfma_f32_32x32x16_bf16 v[68:83], v[168:171], v[12:15], v[68:83]
  v_rcp_f32 v204, v204
  v_rcp_f32 v205, v205
  v_rcp_f32 v206, v206
  v_rcp_f32 v207, v207
  v_rcp_f32 v208, v208
  v_rcp_f32 v209, v209
  v_rcp_f32 v210, v210
  v_rcp_f32 v211, v211
  s_setprio 1
  v_pk_mul_f32 v[196:197], v[196:197], v[100:101]
  v_pk_mul_f32 v[198:199], v[198:199], v[102:103]
  v_pk_mul_f32 v[200:201], v[200:201], v[104:105]
  v_pk_mul_f32 v[202:203], v[202:203], v[106:107]
  v_pk_mul_f32 v[204:205], v[204:205], v[108:109]
  v_pk_mul_f32 v[206:207], v[206:207], v[110:111]
  v_pk_mul_f32 v[208:209], v[208:209], v[112:113]
  v_pk_mul_f32 v[210:211], v[210:211], v[114:115]
  v_mfma_f32_32x32x16_bf16 v[84:99], v[168:171], v[16:19], v[84:99]
  v_exp_f32 v100, v116
  v_exp_f32 v101, v117
  v_exp_f32 v102, v118
  v_mfma_f32_32x32x16_bf16 v[68:83], v[172:175], v[20:23], v[68:83]
  v_exp_f32 v103, v119
  v_exp_f32 v104, v120
  v_exp_f32 v105, v121
  v_mfma_f32_32x32x16_bf16 v[84:99], v[172:175], v[24:27], v[84:99]
  v_exp_f32 v106, v122
  v_exp_f32 v107, v123
  v_exp_f32 v108, v124
  v_mfma_f32_32x32x16_bf16 v[68:83], v[176:179], v[28:31], v[68:83]
  v_exp_f32 v109, v125
  v_exp_f32 v110, v126
  v_exp_f32 v111, v127
  v_exp_f32 v112, v128
  v_exp_f32 v113, v129
  v_exp_f32 v114, v130
  v_exp_f32 v115, v131
  s_nop 1
  v_mfma_f32_32x32x8_bf16 v[100:115], v[54:55], v[54:55], v[100:115]
  v_cvt_pk_bf16_f32 v196, v196, v197
  v_cvt_pk_bf16_f32 v197, v198, v199
  v_cvt_pk_bf16_f32 v198, v200, v201
  v_cvt_pk_bf16_f32 v199, v202, v203
  v_cvt_pk_bf16_f32 v200, v204, v205
  s_waitcnt lgkmcnt(0)
  v_mfma_f32_32x32x16_bf16 v[132:147], v[196:199], v[188:191], v[132:147]
  v_cvt_pk_bf16_f32 v201, v206, v207
  v_cvt_pk_bf16_f32 v202, v208, v209
  v_cvt_pk_bf16_f32 v203, v210, v211
  s_nop 1
  v_mfma_f32_32x32x16_bf16 v[132:147], v[200:203], v[192:195], v[132:147]
  s_nop 0
  v_rcp_f32 v100, v100
  v_rcp_f32 v101, v101
  v_rcp_f32 v102, v102
  v_rcp_f32 v103, v103
  v_rcp_f32 v104, v104
  v_rcp_f32 v105, v105
  v_mfma_f32_32x32x16_bf16 v[68:83], v[212:215], v[180:183], v[68:83]
  v_rcp_f32 v106, v106
  v_rcp_f32 v107, v107
  v_rcp_f32 v108, v108
  v_rcp_f32 v109, v109
  v_mfma_f32_32x32x16_bf16 v[84:99], v[176:179], v[32:35], v[84:99]
  v_rcp_f32 v110, v110
  v_rcp_f32 v111, v111
  v_rcp_f32 v112, v112
  v_rcp_f32 v113, v113
  v_rcp_f32 v114, v114
  v_rcp_f32 v115, v115
  v_pk_mul_f32 v[100:101], v[100:101], v[116:117]
  v_pk_mul_f32 v[102:103], v[102:103], v[118:119]
  v_pk_mul_f32 v[104:105], v[104:105], v[120:121]
  v_pk_mul_f32 v[106:107], v[106:107], v[122:123]
  v_pk_mul_f32 v[108:109], v[108:109], v[124:125]
  v_pk_mul_f32 v[110:111], v[110:111], v[126:127]
  v_pk_mul_f32 v[112:113], v[112:113], v[128:129]
  v_pk_mul_f32 v[114:115], v[114:115], v[130:131]
  v_exp_f32 v196, v68
  v_exp_f32 v197, v69
  v_exp_f32 v198, v70
  v_exp_f32 v199, v71
  v_mfma_f32_32x32x16_bf16 v[84:99], v[212:215], v[184:187], v[84:99]
  v_exp_f32 v200, v72
  v_exp_f32 v201, v73
  v_exp_f32 v202, v74
  v_exp_f32 v203, v75
  v_exp_f32 v204, v76
  v_exp_f32 v205, v77
  v_exp_f32 v206, v78
  v_exp_f32 v207, v79
  v_exp_f32 v208, v80
  v_exp_f32 v209, v81
  v_exp_f32 v210, v82
  v_exp_f32 v211, v83
  s_nop 1
  v_mfma_f32_32x32x8_bf16 v[196:211], v[54:55], v[54:55], v[196:211]
  v_cvt_pk_bf16_f32 v100, v100, v101
  v_cvt_pk_bf16_f32 v101, v102, v103
  v_cvt_pk_bf16_f32 v102, v104, v105
  v_cvt_pk_bf16_f32 v103, v106, v107
  v_cvt_pk_bf16_f32 v104, v108, v109
  v_cvt_pk_bf16_f32 v105, v110, v111
  v_mfma_f32_32x32x16_bf16 v[148:163], v[100:103], v[188:191], v[148:163]
  v_cvt_pk_bf16_f32 v106, v112, v113
  v_cvt_pk_bf16_f32 v107, v114, v115
  s_sub_u32 s85, s85, 1
  s_nop 0
  v_mfma_f32_32x32x16_bf16 v[148:163], v[104:107], v[192:195], v[148:163]
  s_cbranch_scc1 K2_preA2
  s_setprio 2
  s_waitcnt vmcnt(2)
  ds_read_b128 v[164:167], v64
  ds_read_b128 v[168:171], v65
  ds_read_b128 v[172:175], v66
  ds_read_b128 v[176:179], v67
  ds_read_b64 v[214:215], v252 offset:768
  s_and_b64 exec, s[74:75], s[66:67]
  ds_write_b64 v237, v[226:227]
  s_mov_b64 exec, -1
  ds_read_b64_tr_b16 v[188:189], v244 offset:0
  ds_read_b64_tr_b16 v[190:191], v244 offset:512
  ds_read_b64_tr_b16 v[192:193], v244 offset:1024
  ds_read_b64_tr_b16 v[194:195], v244 offset:1536
  ds_write_b64 v237, v[52:53]
  ds_read2_b64 v[220:223], v234 offset0:32 offset1:228
  ds_read_u16 v240, v251 offset:1540
  s_and_b32 s48, s43, 0xffffffe0
  s_sub_u32 s49, 0, s48
  v_lshl_add_u32 v242, s48, 4, v246
  ds_read_b64 v[180:181], v242
  ds_read_b64 v[184:185], v242 offset:256
  s_waitcnt lgkmcnt(10)
  v_add3_u32 v241, v214, v247, s49
  ds_read_b64 v[212:213], v241 offset:32
  s_mov_b64 exec, s[74:75]
  ds_read_b64 v[214:215], v241 offset:0
  ds_read_b64 v[182:183], v242 offset:512
  ds_read_b64 v[186:187], v242 offset:768
  s_mov_b64 exec, -1
  buffer_load_dwordx4 v[56:57], s[68:71], 0 idxen offen offset:0 lds
  buffer_load_dwordx4 v[58:59], s[68:71], 0 idxen offen offset:1024 lds
  buffer_load_dwordx4 v[60:61], s[68:71], 0 idxen offen offset:2048 lds
  buffer_load_dwordx4 v[62:63], s[68:71], 0 idxen offen offset:3072 lds
  ds_read_u16 v56, v250 offset:516
  ds_read_u16 v58, v250 offset:524
  ds_read_u16 v60, v250 offset:532
  ds_read_u16 v62, v250 offset:540
  s_cmp_ge_u32 s46, s50
  s_cbranch_scc1 K2_flushA2
K2_backA2:
  s_setprio 0
  v_mfma_f32_32x32x16_bf16 v[100:115], v[164:167], v[4:7], 0
  v_rcp_f32 v196, v196
  v_rcp_f32 v197, v197
  v_rcp_f32 v198, v198
  v_rcp_f32 v199, v199
  v_mfma_f32_32x32x16_bf16 v[116:131], v[164:167], v[8:11], 0
  v_rcp_f32 v200, v200
  v_rcp_f32 v201, v201
  v_rcp_f32 v202, v202
  v_rcp_f32 v203, v203
  v_mfma_f32_32x32x16_bf16 v[100:115], v[168:171], v[12:15], v[100:115]
  v_rcp_f32 v204, v204
  v_rcp_f32 v205, v205
  v_rcp_f32 v206, v206
  v_rcp_f32 v207, v207
  v_rcp_f32 v208, v208
  v_rcp_f32 v209, v209
  v_rcp_f32 v210, v210
  v_rcp_f32 v211, v211
  s_setprio 1
  v_pk_mul_f32 v[196:197], v[196:197], v[68:69]
  v_pk_mul_f32 v[198:199], v[198:199], v[70:71]
  v_pk_mul_f32 v[200:201], v[200:201], v[72:73]
  v_pk_mul_f32 v[202:203], v[202:203], v[74:75]
  v_pk_mul_f32 v[204:205], v[204:205], v[76:77]
  v_pk_mul_f32 v[206:207], v[206:207], v[78:79]
  v_pk_mul_f32 v[208:209], v[208:209], v[80:81]
  v_pk_mul_f32 v[210:211], v[210:211], v[82:83]
  v_mfma_f32_32x32x16_bf16 v[116:131], v[168:171], v[16:19], v[116:131]
  v_exp_f32 v68, v84
  v_exp_f32 v69, v85
  v_exp_f32 v70, v86
  v_mfma_f32_32x32x16_bf16 v[100:115], v[172:175], v[20:23], v[100:115]
  v_exp_f32 v71, v87
  v_exp_f32 v72, v88
  v_exp_f32 v73, v89
  v_mfma_f32_32x32x16_bf16 v[116:131], v[172:175], v[24:27], v[116:131]
  v_exp_f32 v74, v90
  v_exp_f32 v75, v91
  v_exp_f32 v76, v92
  v_mfma_f32_32x32x16_bf16 v[100:115], v[176:179], v[28:31], v[100:115]
  v_exp_f32 v77, v93
  v_exp_f32 v78, v94
  v_exp_f32 v79, v95
  v_exp_f32 v80, v96
  v_exp_f32 v81, v97
  v_exp_f32 v82, v98
  v_exp_f32 v83, v99
  s_nop 1
  v_mfma_f32_32x32x8_bf16 v[68:83], v[54:55], v[54:55], v[68:83]
  v_cvt_pk_bf16_f32 v196, v196, v197
  v_cvt_pk_bf16_f32 v197, v198, v199
  v_cvt_pk_bf16_f32 v198, v200, v201
  v_cvt_pk_bf16_f32 v199, v202, v203
  v_cvt_pk_bf16_f32 v200, v204, v205
  s_waitcnt lgkmcnt(0)
  v_mfma_f32_32x32x16_bf16 v[132:147], v[196:199], v[188:191], v[132:147]
  v_cvt_pk_bf16_f32 v201, v206, v207
  v_cvt_pk_bf16_f32 v202, v208, v209
  v_cvt_pk_bf16_f32 v203, v210, v211
  v_readlane_b32 s40, v234, 0
  v_readlane_b32 s44, v234, 31
  v_mfma_f32_32x32x16_bf16 v[132:147], v[200:203], v[192:195], v[132:147]
  v_readlane_b32 s41, v234, 32
  v_readlane_b32 s45, v234, 63
  v_bitop3_b32 v236, v234, 56, v245 bitop3:0x6a
  s_waitcnt vmcnt(4)
  v_rcp_f32 v68, v68
  v_rcp_f32 v69, v69
  v_rcp_f32 v70, v70
  v_rcp_f32 v71, v71
  v_rcp_f32 v72, v72
  v_rcp_f32 v73, v73
  v_mfma_f32_32x32x16_bf16 v[100:115], v[212:215], v[180:183], v[100:115]
  v_rcp_f32 v74, v74
  v_rcp_f32 v75, v75
  v_rcp_f32 v76, v76
  v_rcp_f32 v77, v77
  v_mfma_f32_32x32x16_bf16 v[116:131], v[176:179], v[32:35], v[116:131]
  v_rcp_f32 v78, v78
  v_rcp_f32 v79, v79
  v_rcp_f32 v80, v80
  v_rcp_f32 v81, v81
  v_rcp_f32 v82, v82
  v_rcp_f32 v83, v83
  v_dot2_f32_bf16 v228, v216, s0, v220
  v_dot2_f32_bf16 v229, v216, s1, v221
  v_dot2_f32_bf16 v238, v217, s0, v222
  v_pk_mul_f32 v[68:69], v[68:69], v[84:85]
  v_pk_mul_f32 v[70:71], v[70:71], v[86:87]
  v_pk_mul_f32 v[72:73], v[72:73], v[88:89]
  v_pk_mul_f32 v[74:75], v[74:75], v[90:91]
  v_pk_mul_f32 v[76:77], v[76:77], v[92:93]
  v_pk_mul_f32 v[78:79], v[78:79], v[94:95]
  v_pk_mul_f32 v[80:81], v[80:81], v[96:97]
  v_pk_mul_f32 v[82:83], v[82:83], v[98:99]
  v_mul_f32 v239, v228, v228
  v_cvt_pk_bf16_f32 v224, 1.0, v228
  v_fmac_f32 v239, v229, v229
  v_cvt_pk_bf16_f32 v225, v229, v238
  v_exp_f32 v196, v100
  v_exp_f32 v197, v101
  v_exp_f32 v198, v102
  v_exp_f32 v199, v103
  v_mfma_f32_32x32x16_bf16 v[116:131], v[212:215], v[184:187], v[116:131]
  v_exp_f32 v200, v104
  v_exp_f32 v201, v105
  v_exp_f32 v202, v106
  v_exp_f32 v203, v107
  v_exp_f32 v204, v108
  v_exp_f32 v205, v109
  v_exp_f32 v206, v110
  v_exp_f32 v207, v111
  v_exp_f32 v208, v112
  v_exp_f32 v209, v113
  v_exp_f32 v210, v114
  v_exp_f32 v211, v115
  v_fmac_f32 v239, v238, v238
  v_cvt_pk_bf16_f32 v239, v239, v239
  v_mfma_f32_32x32x8_bf16 v[196:211], v[54:55], v[54:55], v[196:211]
  v_cmp_ne_u16 s[64:65], s100, v235
  v_bfi_b32 v235, s100, v239, v235
  v_cvt_pk_bf16_f32 v68, v68, v69
  v_cvt_pk_bf16_f32 v69, v70, v71
  v_cvt_pk_bf16_f32 v70, v72, v73
  v_cvt_pk_bf16_f32 v71, v74, v75
  v_cvt_pk_bf16_f32 v72, v76, v77
  v_cvt_pk_bf16_f32 v73, v78, v79
  v_mfma_f32_32x32x16_bf16 v[148:163], v[68:71], v[188:191], v[148:163]
  v_cvt_pk_bf16_f32 v74, v80, v81
  v_cvt_pk_bf16_f32 v75, v82, v83
  s_sub_u32 s85, s85, 1
  ds_write_b64 v249, v[234:235] offset:0
  v_mfma_f32_32x32x16_bf16 v[148:163], v[72:75], v[192:195], v[148:163]
  s_cbranch_scc1 K2_preA3
  s_setprio 2
  s_waitcnt vmcnt(0)
  ds_read_b128 v[164:167], v64
  ds_read_b128 v[168:171], v65
  ds_read_b128 v[172:175], v66
  ds_read_b128 v[176:179], v67
  ds_read_b64 v[214:215], v252 offset:0
  s_and_b64 exec, s[76:77], s[66:67]
  ds_write_b64 v237, v[226:227]
  s_mov_b64 exec, -1
  ds_read_b64_tr_b16 v[188:189], v244 offset:0
  ds_read_b64_tr_b16 v[190:191], v244 offset:512
  ds_read_b64_tr_b16 v[192:193], v244 offset:1024
  ds_read_b64_tr_b16 v[194:195], v244 offset:1536
  ds_write_b64 v237, v[52:53]
  ds_read_b64 v[234:235], v251 offset:1536
  s_and_b32 s48, s40, 0xffffffe0
  s_sub_u32 s49, 0, s48
  v_lshl_add_u32 v242, s48, 4, v246
  ds_read_b64 v[180:181], v242
  ds_read_b64 v[184:185], v242 offset:256
  s_waitcnt lgkmcnt(9)
  v_add3_u32 v241, v214, v247, s49
  ds_read_b64 v[212:213], v241 offset:32
  s_mov_b64 exec, s[74:75]
  ds_read_b64 v[214:215], v241 offset:0
  ds_read_b64 v[182:183], v242 offset:512
  ds_read_b64 v[186:187], v242 offset:768
  s_mov_b64 exec, -1
  buffer_load_dwordx4 v[56:57], s[68:71], 0 idxen offen offset:0 lds
  buffer_load_dwordx4 v[58:59], s[68:71], 0 idxen offen offset:1024 lds
  buffer_load_dwordx4 v[60:61], s[68:71], 0 idxen offen offset:2048 lds
  buffer_load_dwordx4 v[62:63], s[68:71], 0 idxen offen offset:3072 lds
  buffer_load_dword v216, v240, s[12:15], 0 idxen
  buffer_load_ushort v217, v240, s[12:15], 0 idxen offset:4
  ds_read_u16 v56, v250 offset:772
  ds_read_u16 v58, v250 offset:780
  ds_read_u16 v60, v250 offset:788
  ds_read_u16 v62, v250 offset:796
  s_cmp_ge_u32 s47, s50
  s_cbranch_scc1 K2_flushA3
K2_backA3:
  s_setprio 0
  v_mfma_f32_32x32x16_bf16 v[68:83], v[164:167], v[4:7], 0
  v_rcp_f32 v196, v196
  v_rcp_f32 v197, v197
  v_rcp_f32 v198, v198
  v_rcp_f32 v199, v199
  v_mfma_f32_32x32x16_bf16 v[84:99], v[164:167], v[8:11], 0
  v_rcp_f32 v200, v200
  v_rcp_f32 v201, v201
  v_rcp_f32 v202, v202
  v_rcp_f32 v203, v203
  v_mfma_f32_32x32x16_bf16 v[68:83], v[168:171], v[12:15], v[68:83]
  v_rcp_f32 v204, v204
  v_rcp_f32 v205, v205
  v_rcp_f32 v206, v206
  v_rcp_f32 v207, v207
  v_rcp_f32 v208, v208
  v_rcp_f32 v209, v209
  v_rcp_f32 v210, v210
  v_rcp_f32 v211, v211
  s_setprio 1
  v_pk_mul_f32 v[196:197], v[196:197], v[100:101]
  v_pk_mul_f32 v[198:199], v[198:199], v[102:103]
  v_pk_mul_f32 v[200:201], v[200:201], v[104:105]
  v_pk_mul_f32 v[202:203], v[202:203], v[106:107]
  v_pk_mul_f32 v[204:205], v[204:205], v[108:109]
  v_pk_mul_f32 v[206:207], v[206:207], v[110:111]
  v_pk_mul_f32 v[208:209], v[208:209], v[112:113]
  v_pk_mul_f32 v[210:211], v[210:211], v[114:115]
  v_mfma_f32_32x32x16_bf16 v[84:99], v[168:171], v[16:19], v[84:99]
  v_exp_f32 v100, v116
  v_exp_f32 v101, v117
  v_exp_f32 v102, v118
  v_mfma_f32_32x32x16_bf16 v[68:83], v[172:175], v[20:23], v[68:83]
  v_exp_f32 v103, v119
  v_exp_f32 v104, v120
  v_exp_f32 v105, v121
  v_mfma_f32_32x32x16_bf16 v[84:99], v[172:175], v[24:27], v[84:99]
  v_exp_f32 v106, v122
  v_exp_f32 v107, v123
  v_exp_f32 v108, v124
  v_mfma_f32_32x32x16_bf16 v[68:83], v[176:179], v[28:31], v[68:83]
  v_exp_f32 v109, v125
  v_exp_f32 v110, v126
  v_exp_f32 v111, v127
  v_exp_f32 v112, v128
  v_exp_f32 v113, v129
  v_exp_f32 v114, v130
  v_exp_f32 v115, v131
  s_nop 1
  v_mfma_f32_32x32x8_bf16 v[100:115], v[54:55], v[54:55], v[100:115]
  v_cvt_pk_bf16_f32 v196, v196, v197
  v_cvt_pk_bf16_f32 v197, v198, v199
  v_cvt_pk_bf16_f32 v198, v200, v201
  v_cvt_pk_bf16_f32 v199, v202, v203
  v_cvt_pk_bf16_f32 v200, v204, v205
  s_waitcnt lgkmcnt(0)
  v_mfma_f32_32x32x16_bf16 v[132:147], v[196:199], v[188:191], v[132:147]
  v_cvt_pk_bf16_f32 v201, v206, v207
  v_cvt_pk_bf16_f32 v202, v208, v209
  v_cvt_pk_bf16_f32 v203, v210, v211
  s_nop 1
  v_mfma_f32_32x32x16_bf16 v[132:147], v[200:203], v[192:195], v[132:147]
  s_nop 0
  v_rcp_f32 v100, v100
  v_rcp_f32 v101, v101
  v_rcp_f32 v102, v102
  v_rcp_f32 v103, v103
  v_rcp_f32 v104, v104
  v_rcp_f32 v105, v105
  v_mfma_f32_32x32x16_bf16 v[68:83], v[212:215], v[180:183], v[68:83]
  v_rcp_f32 v106, v106
  v_rcp_f32 v107, v107
  v_rcp_f32 v108, v108
  v_rcp_f32 v109, v109
  v_mfma_f32_32x32x16_bf16 v[84:99], v[176:179], v[32:35], v[84:99]
  v_rcp_f32 v110, v110
  v_rcp_f32 v111, v111
  v_rcp_f32 v112, v112
  v_rcp_f32 v113, v113
  v_rcp_f32 v114, v114
  v_rcp_f32 v115, v115
  v_pk_mul_f32 v[100:101], v[100:101], v[116:117]
  v_pk_mul_f32 v[102:103], v[102:103], v[118:119]
  v_pk_mul_f32 v[104:105], v[104:105], v[120:121]
  v_pk_mul_f32 v[106:107], v[106:107], v[122:123]
  v_pk_mul_f32 v[108:109], v[108:109], v[124:125]
  v_pk_mul_f32 v[110:111], v[110:111], v[126:127]
  v_pk_mul_f32 v[112:113], v[112:113], v[128:129]
  v_pk_mul_f32 v[114:115], v[114:115], v[130:131]
  v_exp_f32 v196, v68
  v_exp_f32 v197, v69
  v_exp_f32 v198, v70
  v_exp_f32 v199, v71
  v_mfma_f32_32x32x16_bf16 v[84:99], v[212:215], v[184:187], v[84:99]
  v_exp_f32 v200, v72
  v_exp_f32 v201, v73
  v_exp_f32 v202, v74
  v_exp_f32 v203, v75
  v_exp_f32 v204, v76
  v_exp_f32 v205, v77
  v_exp_f32 v206, v78
  v_exp_f32 v207, v79
  v_exp_f32 v208, v80
  v_exp_f32 v209, v81
  v_exp_f32 v210, v82
  v_exp_f32 v211, v83
  s_nop 1
  v_mfma_f32_32x32x8_bf16 v[196:211], v[54:55], v[54:55], v[196:211]
  v_cvt_pk_bf16_f32 v100, v100, v101
  v_cvt_pk_bf16_f32 v101, v102, v103
  v_cvt_pk_bf16_f32 v102, v104, v105
  v_cvt_pk_bf16_f32 v103, v106, v107
  v_cvt_pk_bf16_f32 v104, v108, v109
  v_cvt_pk_bf16_f32 v105, v110, v111
  v_mfma_f32_32x32x16_bf16 v[148:163], v[100:103], v[188:191], v[148:163]
  v_cvt_pk_bf16_f32 v106, v112, v113
  v_cvt_pk_bf16_f32 v107, v114, v115
  s_sub_u32 s85, s85, 1
  s_nop 0
  v_mfma_f32_32x32x16_bf16 v[148:163], v[104:107], v[192:195], v[148:163]
  v_add_u32 v251, 1024, v251
  v_add_u32 v250, 1024, v250
  s_cbranch_scc0 K2_loopA
  s_branch K2_preA0
K2_entryB:
  s_setprio 2
  s_mov_b32 s62, 0
  s_cmp_eq_u32 s85, 0
  s_cbranch_scc1 K2_tailB0
  s_sub_u32 s85, s85, 2
  s_cbranch_scc1 K2_preB0
K2_loopB:
  s_setprio 3
  s_waitcnt vmcnt(2)
  ds_read_b128 v[164:167], v64
  ds_read_b128 v[168:171], v65
  ds_read_b128 v[172:175], v66
  ds_read_b128 v[176:179], v67
  ds_read_b64 v[214:215], v252 offset:256
  s_and_b64 exec, s[74:75], s[64:65]
  ds_write_b64 v236, v[224:225]
  s_mov_b64 exec, -1
  ds_read_b64_tr_b16 v[188:189], v244 offset:0
  ds_read_b64_tr_b16 v[190:191], v244 offset:512
  ds_read_b64_tr_b16 v[192:193], v244 offset:1024
  ds_read_b64_tr_b16 v[194:195], v244 offset:1536
  ds_write_b64 v236, v[52:53]
  ds_read2_b64 v[220:223], v234 offset0:32 offset1:228
  ds_read_u16 v240, v251 offset:1028
  s_and_b32 s48, s41, 0xffffffe0
  s_sub_u32 s49, 0, s48
  v_lshl_add_u32 v242, s48, 4, v246
  ds_read_b64 v[180:181], v242
  ds_read_b64 v[184:185], v242 offset:256
  s_waitcnt lgkmcnt(10)
  v_add3_u32 v241, v214, v247, s49
  ds_read_b64 v[212:213], v241 offset:32
  s_mov_b64 exec, s[74:75]
  ds_read_b64 v[214:215], v241 offset:0
  ds_read_b64 v[182:183], v242 offset:512
  ds_read_b64 v[186:187], v242 offset:768
  s_mov_b64 exec, -1
  buffer_load_dwordx4 v[56:57], s[68:71], 0 idxen offen offset:0 lds
  buffer_load_dwordx4 v[58:59], s[68:71], 0 idxen offen offset:1024 lds
  buffer_load_dwordx4 v[60:61], s[68:71], 0 idxen offen offset:2048 lds
  buffer_load_dwordx4 v[62:63], s[68:71], 0 idxen offen offset:3072 lds
  ds_read_u16 v56, v250 offset:4
  ds_read_u16 v58, v250 offset:12
  ds_read_u16 v60, v250 offset:20
  ds_read_u16 v62, v250 offset:28
  s_cmp_ge_u32 s44, s50
  s_cbranch_scc1 K2_flushB0
K2_backB0:
  s_setprio 0
  v_mfma_f32_32x32x16_bf16 v[100:115], v[164:167], v[4:7], 0
  v_rcp_f32 v196, v196
  v_rcp_f32 v197, v197
  v_rcp_f32 v198, v198
  v_rcp_f32 v199, v199
  v_mfma_f32_32x32x16_bf16 v[116:131], v[164:167], v[8:11], 0
  v_rcp_f32 v200, v200
  v_rcp_f32 v201, v201
  v_rcp_f32 v202, v202
  v_rcp_f32 v203, v203
  v_mfma_f32_32x32x16_bf16 v[100:115], v[168:171], v[12:15], v[100:115]
  v_rcp_f32 v204, v204
  v_rcp_f32 v205, v205
  v_rcp_f32 v206, v206
  v_rcp_f32 v207, v207
  v_rcp_f32 v208, v208
  v_rcp_f32 v209, v209
  v_rcp_f32 v210, v210
  v_rcp_f32 v211, v211
  s_setprio 2
  v_pk_mul_f32 v[196:197], v[196:197], v[68:69]
  v_pk_mul_f32 v[198:199], v[198:199], v[70:71]
  v_pk_mul_f32 v[200:201], v[200:201], v[72:73]
  v_pk_mul_f32 v[202:203], v[202:203], v[74:75]
  v_pk_mul_f32 v[204:205], v[204:205], v[76:77]
  v_pk_mul_f32 v[206:207], v[206:207], v[78:79]
  v_pk_mul_f32 v[208:209], v[208:209], v[80:81]
  v_pk_mul_f32 v[210:211], v[210:211], v[82:83]
  v_mfma_f32_32x32x16_bf16 v[116:131], v[168:171], v[16:19], v[116:131]
  v_exp_f32 v68, v84
  v_exp_f32 v69, v85
  v_exp_f32 v70, v86
  v_mfma_f32_32x32x16_bf16 v[100:115], v[172:175], v[20:23], v[100:115]
  v_exp_f32 v71, v87
  v_exp_f32 v72, v88
  v_exp_f32 v73, v89
  v_mfma_f32_32x32x16_bf16 v[116:131], v[172:175], v[24:27], v[116:131]
  v_exp_f32 v74, v90
  v_exp_f32 v75, v91
  v_exp_f32 v76, v92
  v_mfma_f32_32x32x16_bf16 v[100:115], v[176:179], v[28:31], v[100:115]
  v_exp_f32 v77, v93
  v_exp_f32 v78, v94
  v_exp_f32 v79, v95
  v_exp_f32 v80, v96
  v_exp_f32 v81, v97
  v_exp_f32 v82, v98
  v_exp_f32 v83, v99
  s_nop 1
  v_mfma_f32_32x32x8_bf16 v[68:83], v[54:55], v[54:55], v[68:83]
  v_cvt_pk_bf16_f32 v196, v196, v197
  v_cvt_pk_bf16_f32 v197, v198, v199
  v_cvt_pk_bf16_f32 v198, v200, v201
  v_cvt_pk_bf16_f32 v199, v202, v203
  v_cvt_pk_bf16_f32 v200, v204, v205
  s_waitcnt lgkmcnt(0)
  v_mfma_f32_32x32x16_bf16 v[132:147], v[196:199], v[188:191], v[132:147]
  v_cvt_pk_bf16_f32 v201, v206, v207
  v_cvt_pk_bf16_f32 v202, v208, v209
  v_cvt_pk_bf16_f32 v203, v210, v211
  v_readlane_b32 s42, v234, 0
  v_readlane_b32 s46, v234, 31
  v_mfma_f32_32x32x16_bf16 v[132:147], v[200:203], v[192:195], v[132:147]
  v_readlane_b32 s43, v234, 32
  v_readlane_b32 s47, v234, 63
  v_bitop3_b32 v237, v234, 56, v245 bitop3:0x6a
  s_waitcnt vmcnt(4)
  v_rcp_f32 v68, v68
  v_rcp_f32 v69, v69
  v_rcp_f32 v70, v70
  v_rcp_f32 v71, v71
  v_rcp_f32 v72, v72
  v_rcp_f32 v73, v73
  v_mfma_f32_32x32x16_bf16 v[100:115], v[212:215], v[180:183], v[100:115]
  v_rcp_f32 v74, v74
  v_rcp_f32 v75, v75
  v_rcp_f32 v76, v76
  v_rcp_f32 v77, v77
  v_mfma_f32_32x32x16_bf16 v[116:131], v[176:179], v[32:35], v[116:131]
  v_rcp_f32 v78, v78
  v_rcp_f32 v79, v79
  v_rcp_f32 v80, v80
  v_rcp_f32 v81, v81
  v_rcp_f32 v82, v82
  v_rcp_f32 v83, v83
  v_dot2_f32_bf16 v228, v216, s0, v220
  v_dot2_f32_bf16 v229, v216, s1, v221
  v_dot2_f32_bf16 v238, v217, s0, v222
  v_pk_mul_f32 v[68:69], v[68:69], v[84:85]
  v_pk_mul_f32 v[70:71], v[70:71], v[86:87]
  v_pk_mul_f32 v[72:73], v[72:73], v[88:89]
  v_pk_mul_f32 v[74:75], v[74:75], v[90:91]
  v_pk_mul_f32 v[76:77], v[76:77], v[92:93]
  v_pk_mul_f32 v[78:79], v[78:79], v[94:95]
  v_pk_mul_f32 v[80:81], v[80:81], v[96:97]
  v_pk_mul_f32 v[82:83], v[82:83], v[98:99]
  v_mul_f32 v239, v228, v228
  v_cvt_pk_bf16_f32 v226, 1.0, v228
  v_fmac_f32 v239, v229, v229
  v_cvt_pk_bf16_f32 v227, v229, v238
  v_exp_f32 v196, v100
  v_exp_f32 v197, v101
  v_exp_f32 v198, v102
  v_exp_f32 v199, v103
  v_mfma_f32_32x32x16_bf16 v[116:131], v[212:215], v[184:187], v[116:131]
  v_exp_f32 v200, v104
  v_exp_f32 v201, v105
  v_exp_f32 v202, v106
  v_exp_f32 v203, v107
  v_exp_f32 v204, v108
  v_exp_f32 v205, v109
  v_exp_f32 v206, v110
  v_exp_f32 v207, v111
  v_exp_f32 v208, v112
  v_exp_f32 v209, v113
  v_exp_f32 v210, v114
  v_exp_f32 v211, v115
  v_fmac_f32 v239, v238, v238
  v_cvt_pk_bf16_f32 v239, v239, v239
  v_mfma_f32_32x32x8_bf16 v[196:211], v[54:55], v[54:55], v[196:211]
  v_cmp_ne_u16 s[66:67], s100, v235
  v_bfi_b32 v235, s100, v239, v235
  v_cvt_pk_bf16_f32 v68, v68, v69
  v_cvt_pk_bf16_f32 v69, v70, v71
  v_cvt_pk_bf16_f32 v70, v72, v73
  v_cvt_pk_bf16_f32 v71, v74, v75
  v_cvt_pk_bf16_f32 v72, v76, v77
  v_cvt_pk_bf16_f32 v73, v78, v79
  v_mfma_f32_32x32x16_bf16 v[148:163], v[68:71], v[188:191], v[148:163]
  v_cvt_pk_bf16_f32 v74, v80, v81
  v_cvt_pk_bf16_f32 v75, v82, v83
  s_sub_u32 s85, s85, 1
  ds_write_b64 v249, v[234:235] offset:512
  v_mfma_f32_32x32x16_bf16 v[148:163], v[72:75], v[192:195], v[148:163]
  s_cbranch_scc1 K2_preB1
  s_setprio 3
  s_waitcnt vmcnt(0)
  ds_read_b128 v[164:167], v64
  ds_read_b128 v[168:171], v65
  ds_read_b128 v[172:175], v66
  ds_read_b128 v[176:179], v67
  ds_read_b64 v[214:215], v252 offset:512
  s_and_b64 exec, s[76:77], s[64:65]
  ds_write_b64 v236, v[224:225]
  s_mov_b64 exec, -1
  ds_read_b64_tr_b16 v[188:189], v244 offset:0
  ds_read_b64_tr_b16 v[190:191], v244 offset:512
  ds_read_b64_tr_b16 v[192:193], v244 offset:1024
  ds_read_b64_tr_b16 v[194:195], v244 offset:1536
  ds_write_b64 v236, v[52:53]
  ds_read_b64 v[234:235], v251 offset:1024
  s_and_b32 s48, s42, 0xffffffe0
  s_sub_u32 s49, 0, s48
  v_lshl_add_u32 v242, s48, 4, v246
  ds_read_b64 v[180:181], v242
  ds_read_b64 v[184:185], v242 offset:256
  s_waitcnt lgkmcnt(9)
  v_add3_u32 v241, v214, v247, s49
  ds_read_b64 v[212:213], v241 offset:32
  s_mov_b64 exec, s[74:75]
  ds_read_b64 v[214:215], v241 offset:0
  ds_read_b64 v[182:183], v242 offset:512
  ds_read_b64 v[186:187], v242 offset:768
  s_mov_b64 exec, -1
  buffer_load_dwordx4 v[56:57], s[68:71], 0 idxen offen offset:0 lds
  buffer_load_dwordx4 v[58:59], s[68:71], 0 idxen offen offset:1024 lds
  buffer_load_dwordx4 v[60:61], s[68:71], 0 idxen offen offset:2048 lds
  buffer_load_dwordx4 v[62:63], s[68:71], 0 idxen offen offset:3072 lds
  buffer_load_dword v216, v240, s[12:15], 0 idxen
  buffer_load_ushort v217, v240, s[12:15], 0 idxen offset:4
  ds_read_u16 v56, v250 offset:260
  ds_read_u16 v58, v250 offset:268
  ds_read_u16 v60, v250 offset:276
  ds_read_u16 v62, v250 offset:284
  s_cmp_ge_u32 s45, s50
  s_cbranch_scc1 K2_flushB1
K2_backB1:
  s_setprio 0
  v_mfma_f32_32x32x16_bf16 v[68:83], v[164:167], v[4:7], 0
  v_rcp_f32 v196, v196
  v_rcp_f32 v197, v197
  v_rcp_f32 v198, v198
  v_rcp_f32 v199, v199
  v_mfma_f32_32x32x16_bf16 v[84:99], v[164:167], v[8:11], 0
  v_rcp_f32 v200, v200
  v_rcp_f32 v201, v201
  v_rcp_f32 v202, v202
  v_rcp_f32 v203, v203
  v_mfma_f32_32x32x16_bf16 v[68:83], v[168:171], v[12:15], v[68:83]
  v_rcp_f32 v204, v204
  v_rcp_f32 v205, v205
  v_rcp_f32 v206, v206
  v_rcp_f32 v207, v207
  v_rcp_f32 v208, v208
  v_rcp_f32 v209, v209
  v_rcp_f32 v210, v210
  v_rcp_f32 v211, v211
  s_setprio 2
  v_pk_mul_f32 v[196:197], v[196:197], v[100:101]
  v_pk_mul_f32 v[198:199], v[198:199], v[102:103]
  v_pk_mul_f32 v[200:201], v[200:201], v[104:105]
  v_pk_mul_f32 v[202:203], v[202:203], v[106:107]
  v_pk_mul_f32 v[204:205], v[204:205], v[108:109]
  v_pk_mul_f32 v[206:207], v[206:207], v[110:111]
  v_pk_mul_f32 v[208:209], v[208:209], v[112:113]
  v_pk_mul_f32 v[210:211], v[210:211], v[114:115]
  v_mfma_f32_32x32x16_bf16 v[84:99], v[168:171], v[16:19], v[84:99]
  v_exp_f32 v100, v116
  v_exp_f32 v101, v117
  v_exp_f32 v102, v118
  v_mfma_f32_32x32x16_bf16 v[68:83], v[172:175], v[20:23], v[68:83]
  v_exp_f32 v103, v119
  v_exp_f32 v104, v120
  v_exp_f32 v105, v121
  v_mfma_f32_32x32x16_bf16 v[84:99], v[172:175], v[24:27], v[84:99]
  v_exp_f32 v106, v122
  v_exp_f32 v107, v123
  v_exp_f32 v108, v124
  v_mfma_f32_32x32x16_bf16 v[68:83], v[176:179], v[28:31], v[68:83]
  v_exp_f32 v109, v125
  v_exp_f32 v110, v126
  v_exp_f32 v111, v127
  v_exp_f32 v112, v128
  v_exp_f32 v113, v129
  v_exp_f32 v114, v130
  v_exp_f32 v115, v131
  s_nop 1
  v_mfma_f32_32x32x8_bf16 v[100:115], v[54:55], v[54:55], v[100:115]
  v_cvt_pk_bf16_f32 v196, v196, v197
  v_cvt_pk_bf16_f32 v197, v198, v199
  v_cvt_pk_bf16_f32 v198, v200, v201
  v_cvt_pk_bf16_f32 v199, v202, v203
  v_cvt_pk_bf16_f32 v200, v204, v205
  s_waitcnt lgkmcnt(0)
  v_mfma_f32_32x32x16_bf16 v[132:147], v[196:199], v[188:191], v[132:147]
  v_cvt_pk_bf16_f32 v201, v206, v207
  v_cvt_pk_bf16_f32 v202, v208, v209
  v_cvt_pk_bf16_f32 v203, v210, v211
  s_nop 1
  v_mfma_f32_32x32x16_bf16 v[132:147], v[200:203], v[192:195], v[132:147]
  s_nop 0
  v_rcp_f32 v100, v100
  v_rcp_f32 v101, v101
  v_rcp_f32 v102, v102
  v_rcp_f32 v103, v103
  v_rcp_f32 v104, v104
  v_rcp_f32 v105, v105
  v_mfma_f32_32x32x16_bf16 v[68:83], v[212:215], v[180:183], v[68:83]
  v_rcp_f32 v106, v106
  v_rcp_f32 v107, v107
  v_rcp_f32 v108, v108
  v_rcp_f32 v109, v109
  v_mfma_f32_32x32x16_bf16 v[84:99], v[176:179], v[32:35], v[84:99]
  v_rcp_f32 v110, v110
  v_rcp_f32 v111, v111
  v_rcp_f32 v112, v112
  v_rcp_f32 v113, v113
  v_rcp_f32 v114, v114
  v_rcp_f32 v115, v115
  v_pk_mul_f32 v[100:101], v[100:101], v[116:117]
  v_pk_mul_f32 v[102:103], v[102:103], v[118:119]
  v_pk_mul_f32 v[104:105], v[104:105], v[120:121]
  v_pk_mul_f32 v[106:107], v[106:107], v[122:123]
  v_pk_mul_f32 v[108:109], v[108:109], v[124:125]
  v_pk_mul_f32 v[110:111], v[110:111], v[126:127]
  v_pk_mul_f32 v[112:113], v[112:113], v[128:129]
  v_pk_mul_f32 v[114:115], v[114:115], v[130:131]
  v_exp_f32 v196, v68
  v_exp_f32 v197, v69
  v_exp_f32 v198, v70
  v_exp_f32 v199, v71
  v_mfma_f32_32x32x16_bf16 v[84:99], v[212:215], v[184:187], v[84:99]
  v_exp_f32 v200, v72
  v_exp_f32 v201, v73
  v_exp_f32 v202, v74
  v_exp_f32 v203, v75
  v_exp_f32 v204, v76
  v_exp_f32 v205, v77
  v_exp_f32 v206, v78
  v_exp_f32 v207, v79
  v_exp_f32 v208, v80
  v_exp_f32 v209, v81
  v_exp_f32 v210, v82
  v_exp_f32 v211, v83
  s_nop 1
  v_mfma_f32_32x32x8_bf16 v[196:211], v[54:55], v[54:55], v[196:211]
  v_cvt_pk_bf16_f32 v100, v100, v101
  v_cvt_pk_bf16_f32 v101, v102, v103
  v_cvt_pk_bf16_f32 v102, v104, v105
  v_cvt_pk_bf16_f32 v103, v106, v107
  v_cvt_pk_bf16_f32 v104, v108, v109
  v_cvt_pk_bf16_f32 v105, v110, v111
  v_mfma_f32_32x32x16_bf16 v[148:163], v[100:103], v[188:191], v[148:163]
  v_cvt_pk_bf16_f32 v106, v112, v113
  v_cvt_pk_bf16_f32 v107, v114, v115
  s_sub_u32 s85, s85, 1
  s_nop 0
  v_mfma_f32_32x32x16_bf16 v[148:163], v[104:107], v[192:195], v[148:163]
  s_cbranch_scc1 K2_preB2
  s_setprio 3
  s_waitcnt vmcnt(2)
  ds_read_b128 v[164:167], v64
  ds_read_b128 v[168:171], v65
  ds_read_b128 v[172:175], v66
  ds_read_b128 v[176:179], v67
  ds_read_b64 v[214:215], v252 offset:768
  s_and_b64 exec, s[74:75], s[66:67]
  ds_write_b64 v237, v[226:227]
  s_mov_b64 exec, -1
  ds_read_b64_tr_b16 v[188:189], v244 offset:0
  ds_read_b64_tr_b16 v[190:191], v244 offset:512
  ds_read_b64_tr_b16 v[192:193], v244 offset:1024
  ds_read_b64_tr_b16 v[194:195], v244 offset:1536
  ds_write_b64 v237, v[52:53]
  ds_read2_b64 v[220:223], v234 offset0:32 offset1:228
  ds_read_u16 v240, v251 offset:1540
  s_and_b32 s48, s43, 0xffffffe0
  s_sub_u32 s49, 0, s48
  v_lshl_add_u32 v242, s48, 4, v246
  ds_read_b64 v[180:181], v242
  ds_read_b64 v[184:185], v242 offset:256
  s_waitcnt lgkmcnt(10)
  v_add3_u32 v241, v214, v247, s49
  ds_read_b64 v[212:213], v241 offset:32
  s_mov_b64 exec, s[74:75]
  ds_read_b64 v[214:215], v241 offset:0
  ds_read_b64 v[182:183], v242 offset:512
  ds_read_b64 v[186:187], v242 offset:768
  s_mov_b64 exec, -1
  buffer_load_dwordx4 v[56:57], s[68:71], 0 idxen offen offset:0 lds
  buffer_load_dwordx4 v[58:59], s[68:71], 0 idxen offen offset:1024 lds
  buffer_load_dwordx4 v[60:61], s[68:71], 0 idxen offen offset:2048 lds
  buffer_load_dwordx4 v[62:63], s[68:71], 0 idxen offen offset:3072 lds
  ds_read_u16 v56, v250 offset:516
  ds_read_u16 v58, v250 offset:524
  ds_read_u16 v60, v250 offset:532
  ds_read_u16 v62, v250 offset:540
  s_cmp_ge_u32 s46, s50
  s_cbranch_scc1 K2_flushB2
K2_backB2:
  s_setprio 0
  v_mfma_f32_32x32x16_bf16 v[100:115], v[164:167], v[4:7], 0
  v_rcp_f32 v196, v196
  v_rcp_f32 v197, v197
  v_rcp_f32 v198, v198
  v_rcp_f32 v199, v199
  v_mfma_f32_32x32x16_bf16 v[116:131], v[164:167], v[8:11], 0
  v_rcp_f32 v200, v200
  v_rcp_f32 v201, v201
  v_rcp_f32 v202, v202
  v_rcp_f32 v203, v203
  v_mfma_f32_32x32x16_bf16 v[100:115], v[168:171], v[12:15], v[100:115]
  v_rcp_f32 v204, v204
  v_rcp_f32 v205, v205
  v_rcp_f32 v206, v206
  v_rcp_f32 v207, v207
  v_rcp_f32 v208, v208
  v_rcp_f32 v209, v209
  v_rcp_f32 v210, v210
  v_rcp_f32 v211, v211
  s_setprio 2
  v_pk_mul_f32 v[196:197], v[196:197], v[68:69]
  v_pk_mul_f32 v[198:199], v[198:199], v[70:71]
  v_pk_mul_f32 v[200:201], v[200:201], v[72:73]
  v_pk_mul_f32 v[202:203], v[202:203], v[74:75]
  v_pk_mul_f32 v[204:205], v[204:205], v[76:77]
  v_pk_mul_f32 v[206:207], v[206:207], v[78:79]
  v_pk_mul_f32 v[208:209], v[208:209], v[80:81]
  v_pk_mul_f32 v[210:211], v[210:211], v[82:83]
  v_mfma_f32_32x32x16_bf16 v[116:131], v[168:171], v[16:19], v[116:131]
  v_exp_f32 v68, v84
  v_exp_f32 v69, v85
  v_exp_f32 v70, v86
  v_mfma_f32_32x32x16_bf16 v[100:115], v[172:175], v[20:23], v[100:115]
  v_exp_f32 v71, v87
  v_exp_f32 v72, v88
  v_exp_f32 v73, v89
  v_mfma_f32_32x32x16_bf16 v[116:131], v[172:175], v[24:27], v[116:131]
  v_exp_f32 v74, v90
  v_exp_f32 v75, v91
  v_exp_f32 v76, v92
  v_mfma_f32_32x32x16_bf16 v[100:115], v[176:179], v[28:31], v[100:115]
  v_exp_f32 v77, v93
  v_exp_f32 v78, v94
  v_exp_f32 v79, v95
  v_exp_f32 v80, v96
  v_exp_f32 v81, v97
  v_exp_f32 v82, v98
  v_exp_f32 v83, v99
  s_nop 1
  v_mfma_f32_32x32x8_bf16 v[68:83], v[54:55], v[54:55], v[68:83]
  v_cvt_pk_bf16_f32 v196, v196, v197
  v_cvt_pk_bf16_f32 v197, v198, v199
  v_cvt_pk_bf16_f32 v198, v200, v201
  v_cvt_pk_bf16_f32 v199, v202, v203
  v_cvt_pk_bf16_f32 v200, v204, v205
  s_waitcnt lgkmcnt(0)
  v_mfma_f32_32x32x16_bf16 v[132:147], v[196:199], v[188:191], v[132:147]
  v_cvt_pk_bf16_f32 v201, v206, v207
  v_cvt_pk_bf16_f32 v202, v208, v209
  v_cvt_pk_bf16_f32 v203, v210, v211
  v_readlane_b32 s40, v234, 0
  v_readlane_b32 s44, v234, 31
  v_mfma_f32_32x32x16_bf16 v[132:147], v[200:203], v[192:195], v[132:147]
  v_readlane_b32 s41, v234, 32
  v_readlane_b32 s45, v234, 63
  v_bitop3_b32 v236, v234, 56, v245 bitop3:0x6a
  s_waitcnt vmcnt(4)
  v_rcp_f32 v68, v68
  v_rcp_f32 v69, v69
  v_rcp_f32 v70, v70
  v_rcp_f32 v71, v71
  v_rcp_f32 v72, v72
  v_rcp_f32 v73, v73
  v_mfma_f32_32x32x16_bf16 v[100:115], v[212:215], v[180:183], v[100:115]
  v_rcp_f32 v74, v74
  v_rcp_f32 v75, v75
  v_rcp_f32 v76, v76
  v_rcp_f32 v77, v77
  v_mfma_f32_32x32x16_bf16 v[116:131], v[176:179], v[32:35], v[116:131]
  v_rcp_f32 v78, v78
  v_rcp_f32 v79, v79
  v_rcp_f32 v80, v80
  v_rcp_f32 v81, v81
  v_rcp_f32 v82, v82
  v_rcp_f32 v83, v83
  v_dot2_f32_bf16 v228, v216, s0, v220
  v_dot2_f32_bf16 v229, v216, s1, v221
  v_dot2_f32_bf16 v238, v217, s0, v222
  v_pk_mul_f32 v[68:69], v[68:69], v[84:85]
  v_pk_mul_f32 v[70:71], v[70:71], v[86:87]
  v_pk_mul_f32 v[72:73], v[72:73], v[88:89]
  v_pk_mul_f32 v[74:75], v[74:75], v[90:91]
  v_pk_mul_f32 v[76:77], v[76:77], v[92:93]
  v_pk_mul_f32 v[78:79], v[78:79], v[94:95]
  v_pk_mul_f32 v[80:81], v[80:81], v[96:97]
  v_pk_mul_f32 v[82:83], v[82:83], v[98:99]
  v_mul_f32 v239, v228, v228
  v_cvt_pk_bf16_f32 v224, 1.0, v228
  v_fmac_f32 v239, v229, v229
  v_cvt_pk_bf16_f32 v225, v229, v238
  v_exp_f32 v196, v100
  v_exp_f32 v197, v101
  v_exp_f32 v198, v102
  v_exp_f32 v199, v103
  v_mfma_f32_32x32x16_bf16 v[116:131], v[212:215], v[184:187], v[116:131]
  v_exp_f32 v200, v104
  v_exp_f32 v201, v105
  v_exp_f32 v202, v106
  v_exp_f32 v203, v107
  v_exp_f32 v204, v108
  v_exp_f32 v205, v109
  v_exp_f32 v206, v110
  v_exp_f32 v207, v111
  v_exp_f32 v208, v112
  v_exp_f32 v209, v113
  v_exp_f32 v210, v114
  v_exp_f32 v211, v115
  v_fmac_f32 v239, v238, v238
  v_cvt_pk_bf16_f32 v239, v239, v239
  v_mfma_f32_32x32x8_bf16 v[196:211], v[54:55], v[54:55], v[196:211]
  v_cmp_ne_u16 s[64:65], s100, v235
  v_bfi_b32 v235, s100, v239, v235
  v_cvt_pk_bf16_f32 v68, v68, v69
  v_cvt_pk_bf16_f32 v69, v70, v71
  v_cvt_pk_bf16_f32 v70, v72, v73
  v_cvt_pk_bf16_f32 v71, v74, v75
  v_cvt_pk_bf16_f32 v72, v76, v77
  v_cvt_pk_bf16_f32 v73, v78, v79
  v_mfma_f32_32x32x16_bf16 v[148:163], v[68:71], v[188:191], v[148:163]
  v_cvt_pk_bf16_f32 v74, v80, v81
  v_cvt_pk_bf16_f32 v75, v82, v83
  s_sub_u32 s85, s85, 1
  ds_write_b64 v249, v[234:235] offset:0
  v_mfma_f32_32x32x16_bf16 v[148:163], v[72:75], v[192:195], v[148:163]
  s_cbranch_scc1 K2_preB3
  s_setprio 3
  s_waitcnt vmcnt(0)
  ds_read_b128 v[164:167], v64
  ds_read_b128 v[168:171], v65
  ds_read_b128 v[172:175], v66
  ds_read_b128 v[176:179], v67
  ds_read_b64 v[214:215], v252 offset:0
  s_and_b64 exec, s[76:77], s[66:67]
  ds_write_b64 v237, v[226:227]
  s_mov_b64 exec, -1
  ds_read_b64_tr_b16 v[188:189], v244 offset:0
  ds_read_b64_tr_b16 v[190:191], v244 offset:512
  ds_read_b64_tr_b16 v[192:193], v244 offset:1024
  ds_read_b64_tr_b16 v[194:195], v244 offset:1536
  ds_write_b64 v237, v[52:53]
  ds_read_b64 v[234:235], v251 offset:1536
  s_and_b32 s48, s40, 0xffffffe0
  s_sub_u32 s49, 0, s48
  v_lshl_add_u32 v242, s48, 4, v246
  ds_read_b64 v[180:181], v242
  ds_read_b64 v[184:185], v242 offset:256
  s_waitcnt lgkmcnt(9)
  v_add3_u32 v241, v214, v247, s49
  ds_read_b64 v[212:213], v241 offset:32
  s_mov_b64 exec, s[74:75]
  ds_read_b64 v[214:215], v241 offset:0
  ds_read_b64 v[182:183], v242 offset:512
  ds_read_b64 v[186:187], v242 offset:768
  s_mov_b64 exec, -1
  buffer_load_dwordx4 v[56:57], s[68:71], 0 idxen offen offset:0 lds
  buffer_load_dwordx4 v[58:59], s[68:71], 0 idxen offen offset:1024 lds
  buffer_load_dwordx4 v[60:61], s[68:71], 0 idxen offen offset:2048 lds
  buffer_load_dwordx4 v[62:63], s[68:71], 0 idxen offen offset:3072 lds
  buffer_load_dword v216, v240, s[12:15], 0 idxen
  buffer_load_ushort v217, v240, s[12:15], 0 idxen offset:4
  ds_read_u16 v56, v250 offset:772
  ds_read_u16 v58, v250 offset:780
  ds_read_u16 v60, v250 offset:788
  ds_read_u16 v62, v250 offset:796
  s_cmp_ge_u32 s47, s50
  s_cbranch_scc1 K2_flushB3
K2_backB3:
  s_setprio 0
  v_mfma_f32_32x32x16_bf16 v[68:83], v[164:167], v[4:7], 0
  v_rcp_f32 v196, v196
  v_rcp_f32 v197, v197
  v_rcp_f32 v198, v198
  v_rcp_f32 v199, v199
  v_mfma_f32_32x32x16_bf16 v[84:99], v[164:167], v[8:11], 0
  v_rcp_f32 v200, v200
  v_rcp_f32 v201, v201
  v_rcp_f32 v202, v202
  v_rcp_f32 v203, v203
  v_mfma_f32_32x32x16_bf16 v[68:83], v[168:171], v[12:15], v[68:83]
  v_rcp_f32 v204, v204
  v_rcp_f32 v205, v205
  v_rcp_f32 v206, v206
  v_rcp_f32 v207, v207
  v_rcp_f32 v208, v208
  v_rcp_f32 v209, v209
  v_rcp_f32 v210, v210
  v_rcp_f32 v211, v211
  s_setprio 2
  v_pk_mul_f32 v[196:197], v[196:197], v[100:101]
  v_pk_mul_f32 v[198:199], v[198:199], v[102:103]
  v_pk_mul_f32 v[200:201], v[200:201], v[104:105]
  v_pk_mul_f32 v[202:203], v[202:203], v[106:107]
  v_pk_mul_f32 v[204:205], v[204:205], v[108:109]
  v_pk_mul_f32 v[206:207], v[206:207], v[110:111]
  v_pk_mul_f32 v[208:209], v[208:209], v[112:113]
  v_pk_mul_f32 v[210:211], v[210:211], v[114:115]
  v_mfma_f32_32x32x16_bf16 v[84:99], v[168:171], v[16:19], v[84:99]
  v_exp_f32 v100, v116
  v_exp_f32 v101, v117
  v_exp_f32 v102, v118
  v_mfma_f32_32x32x16_bf16 v[68:83], v[172:175], v[20:23], v[68:83]
  v_exp_f32 v103, v119
  v_exp_f32 v104, v120
  v_exp_f32 v105, v121
  v_mfma_f32_32x32x16_bf16 v[84:99], v[172:175], v[24:27], v[84:99]
  v_exp_f32 v106, v122
  v_exp_f32 v107, v123
  v_exp_f32 v108, v124
  v_mfma_f32_32x32x16_bf16 v[68:83], v[176:179], v[28:31], v[68:83]
  v_exp_f32 v109, v125
  v_exp_f32 v110, v126
  v_exp_f32 v111, v127
  v_exp_f32 v112, v128
  v_exp_f32 v113, v129
  v_exp_f32 v114, v130
  v_exp_f32 v115, v131
  s_nop 1
  v_mfma_f32_32x32x8_bf16 v[100:115], v[54:55], v[54:55], v[100:115]
  v_cvt_pk_bf16_f32 v196, v196, v197
  v_cvt_pk_bf16_f32 v197, v198, v199
  v_cvt_pk_bf16_f32 v198, v200, v201
  v_cvt_pk_bf16_f32 v199, v202, v203
  v_cvt_pk_bf16_f32 v200, v204, v205
  s_waitcnt lgkmcnt(0)
  v_mfma_f32_32x32x16_bf16 v[132:147], v[196:199], v[188:191], v[132:147]
  v_cvt_pk_bf16_f32 v201, v206, v207
  v_cvt_pk_bf16_f32 v202, v208, v209
  v_cvt_pk_bf16_f32 v203, v210, v211
  s_nop 1
  v_mfma_f32_32x32x16_bf16 v[132:147], v[200:203], v[192:195], v[132:147]
  s_nop 0
  v_rcp_f32 v100, v100
  v_rcp_f32 v101, v101
  v_rcp_f32 v102, v102
  v_rcp_f32 v103, v103
  v_rcp_f32 v104, v104
  v_rcp_f32 v105, v105
  v_mfma_f32_32x32x16_bf16 v[68:83], v[212:215], v[180:183], v[68:83]
  v_rcp_f32 v106, v106
  v_rcp_f32 v107, v107
  v_rcp_f32 v108, v108
  v_rcp_f32 v109, v109
  v_mfma_f32_32x32x16_bf16 v[84:99], v[176:179], v[32:35], v[84:99]
  v_rcp_f32 v110, v110
  v_rcp_f32 v111, v111
  v_rcp_f32 v112, v112
  v_rcp_f32 v113, v113
  v_rcp_f32 v114, v114
  v_rcp_f32 v115, v115
  v_pk_mul_f32 v[100:101], v[100:101], v[116:117]
  v_pk_mul_f32 v[102:103], v[102:103], v[118:119]
  v_pk_mul_f32 v[104:105], v[104:105], v[120:121]
  v_pk_mul_f32 v[106:107], v[106:107], v[122:123]
  v_pk_mul_f32 v[108:109], v[108:109], v[124:125]
  v_pk_mul_f32 v[110:111], v[110:111], v[126:127]
  v_pk_mul_f32 v[112:113], v[112:113], v[128:129]
  v_pk_mul_f32 v[114:115], v[114:115], v[130:131]
  v_exp_f32 v196, v68
  v_exp_f32 v197, v69
  v_exp_f32 v198, v70
  v_exp_f32 v199, v71
  v_mfma_f32_32x32x16_bf16 v[84:99], v[212:215], v[184:187], v[84:99]
  v_exp_f32 v200, v72
  v_exp_f32 v201, v73
  v_exp_f32 v202, v74
  v_exp_f32 v203, v75
  v_exp_f32 v204, v76
  v_exp_f32 v205, v77
  v_exp_f32 v206, v78
  v_exp_f32 v207, v79
  v_exp_f32 v208, v80
  v_exp_f32 v209, v81
  v_exp_f32 v210, v82
  v_exp_f32 v211, v83
  s_nop 1
  v_mfma_f32_32x32x8_bf16 v[196:211], v[54:55], v[54:55], v[196:211]
  v_cvt_pk_bf16_f32 v100, v100, v101
  v_cvt_pk_bf16_f32 v101, v102, v103
  v_cvt_pk_bf16_f32 v102, v104, v105
  v_cvt_pk_bf16_f32 v103, v106, v107
  v_cvt_pk_bf16_f32 v104, v108, v109
  v_cvt_pk_bf16_f32 v105, v110, v111
  v_mfma_f32_32x32x16_bf16 v[148:163], v[100:103], v[188:191], v[148:163]
  v_cvt_pk_bf16_f32 v106, v112, v113
  v_cvt_pk_bf16_f32 v107, v114, v115
  s_sub_u32 s85, s85, 1
  s_nop 0
  v_mfma_f32_32x32x16_bf16 v[148:163], v[104:107], v[192:195], v[148:163]
  v_add_u32 v251, 1024, v251
  v_add_u32 v250, 1024, v250
  s_cbranch_scc0 K2_loopB
  s_branch K2_preB0
K2_exit3:
  s_lshr_b32 s62, s47, 3
  s_branch K2_loop_done
K2_exit0:
  s_lshr_b32 s62, s44, 3
  s_branch K2_loop_done
K2_exit1:
  s_lshr_b32 s62, s45, 3
  s_branch K2_loop_done
K2_exit2:
  s_lshr_b32 s62, s46, 3
K2_loop_done:
  v_subrev_u32 v57, 3072, v57
  v_subrev_u32 v59, 2048, v59
  v_subrev_u32 v61, 1024, v61
  s_setprio 0
  s_add_u32 s51, s62, 1
  s_or_b32 s92, s80, s81
  s_or_b32 s92, s92, s83
  s_cmp_lg_u32 s92, 0
  s_cbranch_scc1 K2_noearly
  s_waitcnt vmcnt(0) lgkmcnt(0)
  s_mov_b32 s84, 3
  s_mul_i32 s93, s2, 196
  s_lshl_b32 s94, s3, 5
  s_add_u32 s93, s93, s94
  s_lshl_b32 s93, s93, 7
  v_lshrrev_b32 v243, 3, v0
  v_lshlrev_b32 v243, 9, v243
  v_add_u32 v243, s93, v243
  v_add_u32 v216, v243, v57
  v_add_u32 v217, v243, v59
  v_add_u32 v217, 128, v217
  v_add_u32 v218, v243, v61
  v_add_u32 v218, 256, v218
  v_add_u32 v219, v243, v63
  v_add_u32 v219, 384, v219
  s_cmp_ge_u32 s3, 7
  s_cbranch_scc1 K2_epi_w7ae
K2_epi_rowse:
  s_add_u32 m0, s88, 0
  s_nop 0
  buffer_load_dwordx4 v216, s[8:11], 0 offen lds
  s_add_u32 m0, s88, 1024
  s_nop 0
  buffer_load_dwordx4 v217, s[8:11], 0 offen lds
  s_add_u32 m0, s88, 2048
  s_nop 0
  buffer_load_dwordx4 v218, s[8:11], 0 offen lds
  s_add_u32 m0, s88, 3072
  s_nop 0
  buffer_load_dwordx4 v219, s[8:11], 0 offen lds
K2_epi_w7ae:
K2_noearly:
  s_nop 7
  v_subrev_u32 v243, s60, v253
  v_and_b32 v243, 7, v243
  v_add_u32 v243, s60, v243
  v_cmp_gt_u32 s[52:53], s51, v243
  v_cmp_eq_u32 s[54:55], s61, v243
  v_cmp_eq_u32 s[58:59], s62, v243
  v_lshl_add_u32 v241, v243, 4, v254
  v_mad_u32_u24 v243, v243, s89, v248
  s_or_b64 s[54:55], s[54:55], s[58:59]
  s_or_b64 s[54:55], s[54:55], s[78:79]
  s_and_b64 s[54:55], s[54:55], s[52:53]
  s_andn2_b64 s[56:57], s[52:53], s[54:55]
  v_cvt_pk_bf16_f32 v196, v132, v133
  v_cvt_pk_bf16_f32 v197, v134, v135
  v_cvt_pk_bf16_f32 v198, v136, v137
  v_cvt_pk_bf16_f32 v199, v138, v139
  v_cvt_pk_bf16_f32 v200, v140, v141
  v_cvt_pk_bf16_f32 v201, v142, v143
  v_cvt_pk_bf16_f32 v202, v144, v145
  v_cvt_pk_bf16_f32 v203, v146, v147
  v_cvt_pk_bf16_f32 v204, v148, v149
  v_cvt_pk_bf16_f32 v205, v150, v151
  v_cvt_pk_bf16_f32 v206, v152, v153
  v_cvt_pk_bf16_f32 v207, v154, v155
  v_cvt_pk_bf16_f32 v208, v156, v157
  v_cvt_pk_bf16_f32 v209, v158, v159
  v_cvt_pk_bf16_f32 v210, v160, v161
  v_cvt_pk_bf16_f32 v211, v162, v163
  s_cmp_lg_u64 s[78:79], 0
  s_cbranch_scc1 K2_ffg_2
  s_and_b64 exec, s[56:57], s[72:73]
  v_mfma_f32_32x32x16_bf16 v[164:179], v[36:39], v[196:199], 0
  ds_write_b64 v243, v[196:197] offset:0
  ds_write_b64 v243, v[198:199] offset:16
  ds_write_b64 v243, v[200:201] offset:32
  ds_write_b64 v243, v[202:203] offset:48
  ds_write_b64 v243, v[204:205] offset:64
  ds_write_b64 v243, v[206:207] offset:80
  ds_write_b64 v243, v[208:209] offset:96
  ds_write_b64 v243, v[210:211] offset:112
  v_mfma_f32_32x32x16_bf16 v[164:179], v[40:43], v[200:203], v[164:179]
  s_and_b64 exec, s[54:55], s[72:73]
  ds_pk_add_bf16 v243, v196 offset:0
  ds_pk_add_bf16 v243, v197 offset:4
  ds_pk_add_bf16 v243, v198 offset:16
  ds_pk_add_bf16 v243, v199 offset:20
  v_mfma_f32_32x32x16_bf16 v[164:179], v[44:47], v[204:207], v[164:179]
  ds_pk_add_bf16 v243, v200 offset:32
  ds_pk_add_bf16 v243, v201 offset:36
  ds_pk_add_bf16 v243, v202 offset:48
  ds_pk_add_bf16 v243, v203 offset:52
  v_mfma_f32_32x32x16_bf16 v[164:179], v[48:51], v[208:211], v[164:179]
  ds_pk_add_bf16 v243, v204 offset:64
  ds_pk_add_bf16 v243, v205 offset:68
  ds_pk_add_bf16 v243, v206 offset:80
  ds_pk_add_bf16 v243, v207 offset:84
  ds_pk_add_bf16 v243, v208 offset:96
  ds_pk_add_bf16 v243, v209 offset:100
  ds_pk_add_bf16 v243, v210 offset:112
  ds_pk_add_bf16 v243, v211 offset:116
  s_nop 3
  s_and_b64 exec, s[56:57], s[74:75]
  ds_write_b32 v241, v164 offset:41408
  s_and_b64 exec, s[54:55], s[74:75]
  ds_add_f32 v241, v164 offset:41408
  s_mov_b64 exec, -1
  s_branch K2_ffe_3
K2_ffg_2:
  s_and_b64 exec, s[56:57], s[72:73]
  v_mfma_f32_32x32x16_bf16 v[164:179], v[36:39], v[196:199], 0
  ds_write_b64 v243, v[196:197] offset:0
  ds_write_b64 v243, v[198:199] offset:16
  v_mfma_f32_32x32x16_bf16 v[164:179], v[40:43], v[200:203], v[164:179]
  ds_write_b64 v243, v[200:201] offset:32
  ds_write_b64 v243, v[202:203] offset:48
  v_mfma_f32_32x32x16_bf16 v[164:179], v[44:47], v[204:207], v[164:179]
  ds_write_b64 v243, v[204:205] offset:64
  ds_write_b64 v243, v[206:207] offset:80
  v_mfma_f32_32x32x16_bf16 v[164:179], v[48:51], v[208:211], v[164:179]
  ds_write_b64 v243, v[208:209] offset:96
  ds_write_b64 v243, v[210:211] offset:112
  s_and_b64 exec, s[54:55], s[72:73]
  s_cbranch_execz K2_fa_4
  s_cmp_lg_u64 s[78:79], 0
  s_cbranch_scc1 K2_fs_5
  ds_pk_add_bf16 v243, v196 offset:0
  ds_pk_add_bf16 v243, v197 offset:4
  ds_pk_add_bf16 v243, v198 offset:16
  ds_pk_add_bf16 v243, v199 offset:20
  ds_pk_add_bf16 v243, v200 offset:32
  ds_pk_add_bf16 v243, v201 offset:36
  ds_pk_add_bf16 v243, v202 offset:48
  ds_pk_add_bf16 v243, v203 offset:52
  ds_pk_add_bf16 v243, v204 offset:64
  ds_pk_add_bf16 v243, v205 offset:68
  ds_pk_add_bf16 v243, v206 offset:80
  ds_pk_add_bf16 v243, v207 offset:84
  ds_pk_add_bf16 v243, v208 offset:96
  ds_pk_add_bf16 v243, v209 offset:100
  ds_pk_add_bf16 v243, v210 offset:112
  ds_pk_add_bf16 v243, v211 offset:116
K2_fa_4:
  s_nop 11
  s_and_b64 exec, s[56:57], s[74:75]
  ds_write_b32 v241, v164 offset:41408
  s_and_b64 exec, s[54:55], s[74:75]
  s_cbranch_execz K2_fb_6
  ds_add_f32 v241, v164 offset:41408
K2_fb_6:
  s_mov_b64 exec, -1
K2_ffe_3:
  s_cmp_eq_u32 s63, 0
  s_cbranch_scc1 K2_noviol
  v_mov_b32 v241, 0
  v_mov_b32 v243, 1
  ds_write_b32 v241, v243 offset:228
K2_noviol:
  s_waitcnt lgkmcnt(0)
  v_bfe_u32 v164, v0, 2, 2
  v_lshrrev_b32 v165, 5, v0
  v_lshl_add_u32 v165, v165, 3, v164
  v_lshlrev_b32 v165, 7, v165
  v_bfe_u32 v166, v0, 4, 1
  v_bfe_u32 v167, v0, 1, 1
  v_lshl_or_b32 v166, v166, 1, v167
  v_lshlrev_b32 v164, 1, v164
  v_xor_b32 v166, v166, v164
  v_and_b32 v167, 1, v0
  v_lshlrev_b32 v167, 3, v167
  v_add_u32 v165, v165, v167
  v_add_u32 v165, 131072, v165
  v_lshl_add_u32 v230, v166, 4, v165
  v_xor_b32 v166, 4, v166
  v_lshl_add_u32 v231, v166, 4, v165
  s_cmp_ge_u32 s3, 4
  s_cbranch_scc0 K2_epi_wfulle
  s_cmp_eq_u32 s101, 0
  s_cbranch_scc1 K2_epi_whalfe
  s_cmp_ge_u32 s3, 7
  s_cbranch_scc1 K2_epi_wdonee
K2_epi_wfulle:
  ds_read_b64_tr_b16 v[68:69], v230 offset:2048
  ds_read_b64_tr_b16 v[70:71], v230 offset:2560
  ds_read_b64_tr_b16 v[72:73], v231 offset:2048
  ds_read_b64_tr_b16 v[74:75], v231 offset:2560
  ds_read_b64_tr_b16 v[76:77], v230 offset:6144
  ds_read_b64_tr_b16 v[78:79], v230 offset:6656
  ds_read_b64_tr_b16 v[80:81], v231 offset:6144
  ds_read_b64_tr_b16 v[82:83], v231 offset:6656
  ds_read_b64_tr_b16 v[84:85], v230 offset:10240
  ds_read_b64_tr_b16 v[86:87], v230 offset:10752
  ds_read_b64_tr_b16 v[88:89], v231 offset:10240
  ds_read_b64_tr_b16 v[90:91], v231 offset:10752
  ds_read_b64_tr_b16 v[92:93], v230 offset:14336
  ds_read_b64_tr_b16 v[94:95], v230 offset:14848
  ds_read_b64_tr_b16 v[96:97], v231 offset:14336
  ds_read_b64_tr_b16 v[98:99], v231 offset:14848
  ds_read_b64_tr_b16 v[100:101], v230 offset:18432
  ds_read_b64_tr_b16 v[102:103], v230 offset:18944
  ds_read_b64_tr_b16 v[104:105], v231 offset:18432
  ds_read_b64_tr_b16 v[106:107], v231 offset:18944
  ds_read_b64_tr_b16 v[108:109], v230 offset:22528
  ds_read_b64_tr_b16 v[110:111], v230 offset:23040
  ds_read_b64_tr_b16 v[112:113], v231 offset:22528
  ds_read_b64_tr_b16 v[114:115], v231 offset:23040
  ds_read_b64_tr_b16 v[116:117], v230 offset:26624
  ds_read_b64_tr_b16 v[118:119], v230 offset:27136
  ds_read_b64_tr_b16 v[120:121], v231 offset:26624
  ds_read_b64_tr_b16 v[122:123], v231 offset:27136
  ds_read_b64_tr_b16 v[124:125], v230 offset:30720
  ds_read_b64_tr_b16 v[126:127], v230 offset:31232
  ds_read_b64_tr_b16 v[128:129], v231 offset:30720
  ds_read_b64_tr_b16 v[130:131], v231 offset:31232
  s_branch K2_epi_wdonee
K2_epi_whalfe:
  s_bitcmp1_b32 s3, 1
  s_cbranch_scc0 K2_epi_wh0e
  v_mov_b32 v230, v231
K2_epi_wh0e:
  ds_read_b64_tr_b16 v[68:69], v230 offset:2048
  ds_read_b64_tr_b16 v[70:71], v230 offset:2560
  ds_read_b64_tr_b16 v[72:73], v230 offset:6144
  ds_read_b64_tr_b16 v[74:75], v230 offset:6656
  ds_read_b64_tr_b16 v[76:77], v230 offset:10240
  ds_read_b64_tr_b16 v[78:79], v230 offset:10752
  ds_read_b64_tr_b16 v[80:81], v230 offset:14336
  ds_read_b64_tr_b16 v[82:83], v230 offset:14848
  ds_read_b64_tr_b16 v[84:85], v230 offset:18432
  ds_read_b64_tr_b16 v[86:87], v230 offset:18944
  ds_read_b64_tr_b16 v[88:89], v230 offset:22528
  ds_read_b64_tr_b16 v[90:91], v230 offset:23040
  ds_read_b64_tr_b16 v[92:93], v230 offset:26624
  ds_read_b64_tr_b16 v[94:95], v230 offset:27136
  ds_read_b64_tr_b16 v[96:97], v230 offset:30720
  ds_read_b64_tr_b16 v[98:99], v230 offset:31232
K2_epi_wdonee:
  s_bitset1_b32 s84, 4
K2_loop_skip:
  s_cmp_eq_u32 s81, 0
  s_cbranch_scc1 K2_rc_nosplit
  s_add_u32 s82, s82, 1
  s_cmp_lt_u32 s82, 8
  s_cbranch_scc1 K2_rc_next
  s_mov_b32 s81, 0
  s_mov_b32 s82, 0
K2_rc_nosplit:
  s_cmp_eq_u32 s83, 0
  s_cbranch_scc1 K2_epi
  s_add_u32 s80, s80, 32
K2_rc_next:
  s_waitcnt vmcnt(0) lgkmcnt(0)
  s_barrier
  v_mov_b32 v241, 0
  ds_read_b32 v243, v241 offset:228
  s_waitcnt lgkmcnt(0)
  v_readfirstlane_b32 s92, v243
  s_cmp_eq_u32 s92, 0
  s_cbranch_scc1 K2_round_b
K2_redo:
  s_lshl_b32 s93, s3, 6
  v_add_u32 v243, s93, v0
  v_lshlrev_b32 v241, 4, v243
  v_mov_b32 v164, 0
  v_mov_b32 v165, 0
  v_mov_b32 v166, 0
  v_mov_b32 v167, 0
  v_add_u32 v241, 41408, v241
  ds_write_b128 v241, v[164:167] offset:0
  ds_write_b128 v241, v[164:167] offset:8192
  ds_write_b128 v241, v[164:167] offset:16384
  v_cmp_gt_u32 vcc, 326, v243
  s_and_saveexec_b64 s[98:99], vcc
  ds_write_b128 v241, v[164:167] offset:24576
  s_mov_b64 exec, s[98:99]
  s_mov_b32 s86, 1
  s_mov_b32 s80, 0
  s_mov_b32 s81, 0
  s_mov_b32 s82, 0
  s_mov_b32 s84, 2
K2_round_b:
  s_barrier
  s_branch K2_round
K2_pro_q:
  s_cmp_eq_u32 s84, 1
  s_cbranch_scc0 K2_pro_q1
  v_add_u32 v204, -16384, v64
  v_add_u32 v205, -16384, v65
  v_add_u32 v206, -16384, v66
  v_add_u32 v207, -16384, v67
  ds_read_b128 v[164:167], v204
  ds_read_b128 v[168:171], v205
  ds_read_b128 v[172:175], v206
  ds_read_b128 v[176:179], v207
  ds_read_b128 v[180:183], v64
  ds_read_b128 v[184:187], v65
  ds_read_b128 v[188:191], v66
  ds_read_b128 v[192:195], v67
  s_lshl_b32 s93, s3, 12
  v_and_b32 v213, 31, v0
  v_lshrrev_b32 v214, 5, v0
  v_lshlrev_b32 v214, 9, v214
  v_lshl_add_u32 v212, v213, 3, v214
  v_add_u32 v212, s93, v212
  v_add_u32 v212, 54816, v212
  s_waitcnt lgkmcnt(0)
K2_pro_q1:
  s_barrier
  s_cmp_eq_u32 s84, 1
  s_cbranch_scc0 K2_pro_e
  s_mov_b32 s84, 2
  v_mfma_f32_32x32x16_bf16 v[68:83], v[164:167], v[132:135], 0
  v_mfma_f32_32x32x16_bf16 v[84:99], v[164:167], v[136:139], 0
  v_mfma_f32_32x32x16_bf16 v[68:83], v[168:171], v[140:143], v[68:83]
  v_mfma_f32_32x32x16_bf16 v[84:99], v[168:171], v[144:147], v[84:99]
  v_mfma_f32_32x32x16_bf16 v[68:83], v[172:175], v[148:151], v[68:83]
  v_mfma_f32_32x32x16_bf16 v[84:99], v[172:175], v[152:155], v[84:99]
  v_mfma_f32_32x32x16_bf16 v[68:83], v[176:179], v[156:159], v[68:83]
  v_mfma_f32_32x32x16_bf16 v[84:99], v[176:179], v[160:163], v[84:99]
  s_cmp_ge_u32 s3, 7
  s_cbranch_scc1 K2_q1only
  v_mfma_f32_32x32x16_bf16 v[100:115], v[180:183], v[132:135], 0
  v_mfma_f32_32x32x16_bf16 v[116:131], v[180:183], v[136:139], 0
  v_mfma_f32_32x32x16_bf16 v[100:115], v[184:187], v[140:143], v[100:115]
  v_mfma_f32_32x32x16_bf16 v[116:131], v[184:187], v[144:147], v[116:131]
  s_nop 7
  v_mfma_f32_32x32x16_bf16 v[100:115], v[188:191], v[148:151], v[100:115]
  v_cvt_pk_bf16_f32 v164, v68, v69
  v_cvt_pk_bf16_f32 v165, v70, v71
  v_cvt_pk_bf16_f32 v166, v72, v73
  v_cvt_pk_bf16_f32 v167, v74, v75
  v_cvt_pk_bf16_f32 v172, v84, v85
  v_cvt_pk_bf16_f32 v173, v86, v87
  v_mfma_f32_32x32x16_bf16 v[116:131], v[188:191], v[152:155], v[116:131]
  v_cvt_pk_bf16_f32 v174, v88, v89
  v_cvt_pk_bf16_f32 v175, v90, v91
  ds_write_b64 v212, v[164:165] offset:0
  ds_write_b64 v212, v[166:167] offset:1024
  ds_write_b64 v212, v[172:173] offset:256
  ds_write_b64 v212, v[174:175] offset:1280
  v_mfma_f32_32x32x16_bf16 v[100:115], v[192:195], v[156:159], v[100:115]
  v_cvt_pk_bf16_f32 v168, v76, v77
  v_cvt_pk_bf16_f32 v169, v78, v79
  v_cvt_pk_bf16_f32 v170, v80, v81
  v_cvt_pk_bf16_f32 v171, v82, v83
  v_cvt_pk_bf16_f32 v176, v92, v93
  v_cvt_pk_bf16_f32 v177, v94, v95
  v_mfma_f32_32x32x16_bf16 v[116:131], v[192:195], v[160:163], v[116:131]
  v_cvt_pk_bf16_f32 v178, v96, v97
  v_cvt_pk_bf16_f32 v179, v98, v99
  ds_write_b64 v212, v[168:169] offset:2048
  ds_write_b64 v212, v[170:171] offset:3072
  ds_write_b64 v212, v[176:177] offset:2304
  ds_write_b64 v212, v[178:179] offset:3328
  s_nop 6
  v_cvt_pk_bf16_f32 v180, v100, v101
  v_cvt_pk_bf16_f32 v181, v102, v103
  v_cvt_pk_bf16_f32 v182, v104, v105
  v_cvt_pk_bf16_f32 v183, v106, v107
  v_cvt_pk_bf16_f32 v188, v116, v117
  v_cvt_pk_bf16_f32 v189, v118, v119
  v_cvt_pk_bf16_f32 v190, v120, v121
  v_cvt_pk_bf16_f32 v191, v122, v123
  ds_write_b64 v212, v[180:181] offset:16384
  ds_write_b64 v212, v[182:183] offset:17408
  ds_write_b64 v212, v[188:189] offset:16640
  ds_write_b64 v212, v[190:191] offset:17664
  s_cmp_eq_u32 s3, 6
  s_cbranch_scc1 K2_pro_e
  v_cvt_pk_bf16_f32 v184, v108, v109
  v_cvt_pk_bf16_f32 v185, v110, v111
  v_cvt_pk_bf16_f32 v186, v112, v113
  v_cvt_pk_bf16_f32 v187, v114, v115
  v_cvt_pk_bf16_f32 v192, v124, v125
  v_cvt_pk_bf16_f32 v193, v126, v127
  v_cvt_pk_bf16_f32 v194, v128, v129
  v_cvt_pk_bf16_f32 v195, v130, v131
  ds_write_b64 v212, v[184:185] offset:18432
  ds_write_b64 v212, v[186:187] offset:19456
  ds_write_b64 v212, v[192:193] offset:18688
  ds_write_b64 v212, v[194:195] offset:19712
  s_branch K2_pro_e
K2_q1only:
  s_nop 11
  v_cvt_pk_bf16_f32 v164, v68, v69
  v_cvt_pk_bf16_f32 v165, v70, v71
  v_cvt_pk_bf16_f32 v166, v72, v73
  v_cvt_pk_bf16_f32 v167, v74, v75
  v_cvt_pk_bf16_f32 v172, v84, v85
  v_cvt_pk_bf16_f32 v173, v86, v87
  v_cvt_pk_bf16_f32 v174, v88, v89
  v_cvt_pk_bf16_f32 v175, v90, v91
  ds_write_b64 v212, v[164:165] offset:0
  ds_write_b64 v212, v[166:167] offset:1024
  ds_write_b64 v212, v[172:173] offset:256
  ds_write_b64 v212, v[174:175] offset:1280
  v_cvt_pk_bf16_f32 v168, v76, v77
  v_cvt_pk_bf16_f32 v169, v78, v79
  v_cvt_pk_bf16_f32 v170, v80, v81
  v_cvt_pk_bf16_f32 v171, v82, v83
  v_cvt_pk_bf16_f32 v176, v92, v93
  v_cvt_pk_bf16_f32 v177, v94, v95
  v_cvt_pk_bf16_f32 v178, v96, v97
  v_cvt_pk_bf16_f32 v179, v98, v99
  ds_write_b64 v212, v[168:169] offset:2048
  ds_write_b64 v212, v[170:171] offset:3072
  ds_write_b64 v212, v[176:177] offset:2304
  ds_write_b64 v212, v[178:179] offset:3328
K2_pro_e:
  s_waitcnt vmcnt(0) lgkmcnt(0)
  s_barrier
  s_cmp_eq_u32 s85, 0
  s_cbranch_scc0 K2_pro_1B
  s_branch K2_loop_skip
K2_pro_1B:
  s_sub_u32 s85, s85, 1
  s_cmp_eq_u32 s95, s92
  s_cbranch_scc0 K2_notailB
  s_lshl_b32 s93, s96, 3
  v_mov_b32 v241, s93
  ds_read_b32 v228, v241 offset:11576
  v_lshlrev_b32 v243, 3, v0
  v_add_u32 v241, s93, v243
  v_mov_b32 v229, s100
  s_waitcnt lgkmcnt(0)
  ds_write_b64 v241, v[228:229] offset:11584
K2_notailB:
  ds_read2_b32 v[230:231], v250 offset0:1 offset1:3
  ds_read2_b32 v[232:233], v250 offset0:5 offset1:7
  ds_read_u16 v190, v251 offset:4
  ds_read2_b32 v[204:205], v250 offset0:65 offset1:67
  ds_read2_b32 v[206:207], v250 offset0:69 offset1:71
  ds_read_b64 v[234:235], v251
  ds_read_u16 v240, v251 offset:516
  v_lshl_add_u32 v252, v247, 2, v249
  v_subrev_u32 v252, 256, v252
  s_add_u32 s92, s88, 32768
  s_waitcnt lgkmcnt(5)
  v_mad_u32_u16 v230, v230, s87, v57
  v_mad_u32_u16 v231, v231, s87, v59
  v_mad_u32_u16 v232, v232, s87, v61
  v_mad_u32_u16 v233, v233, s87, v63
  s_add_u32 m0, s88, 0
  s_nop 0
  buffer_load_dwordx4 v230, s[8:11], 0 offen lds
  s_add_u32 m0, s88, 1024
  s_nop 0
  buffer_load_dwordx4 v231, s[8:11], 0 offen lds
  s_add_u32 m0, s88, 2048
  s_nop 0
  buffer_load_dwordx4 v232, s[8:11], 0 offen lds
  s_add_u32 m0, s88, 3072
  s_nop 0
  buffer_load_dwordx4 v233, s[8:11], 0 offen lds
  s_mov_b32 s68, s12
  s_and_b32 s69, s13, 0xffff
  s_mov_b32 s70, 300000
  s_mov_b32 s71, 0x00020000
  s_waitcnt lgkmcnt(4)
  v_lshrrev_b32 v191, 1, v190
  v_add_lshl_u32 v191, v190, v191, 2
  buffer_load_dwordx2 v[188:189], v191, s[68:71], 0 offen
  s_waitcnt lgkmcnt(2)
  v_mad_u32_u16 v204, v204, s87, v57
  v_mad_u32_u16 v205, v205, s87, v59
  v_mad_u32_u16 v206, v206, s87, v61
  v_mad_u32_u16 v207, v207, s87, v63
  s_waitcnt lgkmcnt(0)
  ds_read2_b64 v[220:223], v234 offset0:32 offset1:228
  ds_read_u16 v56, v250 offset:516
  ds_read_u16 v58, v250 offset:524
  ds_read_u16 v60, v250 offset:532
  ds_read_u16 v62, v250 offset:540
  v_add_u32 v250, 768, v250
  v_readlane_b32 s40, v234, 0
  v_readlane_b32 s44, v234, 31
  v_readlane_b32 s41, v234, 32
  v_readlane_b32 s45, v234, 63
  v_bitop3_b32 v236, v234, 56, v245 bitop3:0x6a
  s_lshr_b32 s60, s40, 3
  s_mov_b32 s61, s60
  s_add_u32 s50, s40, 64
  s_and_b32 s48, s40, 0xffffffe0
  s_sub_u32 s49, 0, s48
  v_lshl_add_u32 v242, s48, 4, v246
  v_mov_b64 v[132:133], 0
  v_mov_b64 v[134:135], 0
  v_mov_b64 v[136:137], 0
  v_mov_b64 v[138:139], 0
  v_mov_b64 v[140:141], 0
  v_mov_b64 v[142:143], 0
  v_mov_b64 v[144:145], 0
  v_mov_b64 v[146:147], 0
  v_mov_b64 v[148:149], 0
  v_mov_b64 v[150:151], 0
  v_mov_b64 v[152:153], 0
  v_mov_b64 v[154:155], 0
  v_mov_b64 v[156:157], 0
  v_mov_b64 v[158:159], 0
  v_mov_b64 v[160:161], 0
  v_mov_b64 v[162:163], 0
  s_waitcnt vmcnt(1)
  ds_read_b128 v[164:167], v64 offset:0
  ds_read_b128 v[168:171], v65 offset:0
  ds_read_b128 v[172:175], v66 offset:0
  ds_read_b128 v[176:179], v67 offset:0
  s_waitcnt lgkmcnt(3)
  v_mfma_f32_32x32x16_bf16 v[68:83], v[164:167], v[4:7], 0
  v_mfma_f32_32x32x16_bf16 v[84:99], v[164:167], v[8:11], 0
  s_waitcnt lgkmcnt(2)
  v_mfma_f32_32x32x16_bf16 v[68:83], v[168:171], v[12:15], v[68:83]
  v_mfma_f32_32x32x16_bf16 v[84:99], v[168:171], v[16:19], v[84:99]
  s_waitcnt lgkmcnt(1)
  v_mfma_f32_32x32x16_bf16 v[68:83], v[172:175], v[20:23], v[68:83]
  v_mfma_f32_32x32x16_bf16 v[84:99], v[172:175], v[24:27], v[84:99]
  s_waitcnt lgkmcnt(0)
  s_add_u32 m0, s88, 0
  s_nop 0
  buffer_load_dwordx4 v204, s[8:11], 0 offen lds
  s_add_u32 m0, s88, 1024
  s_nop 0
  buffer_load_dwordx4 v205, s[8:11], 0 offen lds
  s_add_u32 m0, s88, 2048
  s_nop 0
  buffer_load_dwordx4 v206, s[8:11], 0 offen lds
  s_add_u32 m0, s88, 3072
  s_nop 0
  buffer_load_dwordx4 v207, s[8:11], 0 offen lds
  v_mfma_f32_32x32x16_bf16 v[68:83], v[176:179], v[28:31], v[68:83]
  v_mfma_f32_32x32x16_bf16 v[84:99], v[176:179], v[32:35], v[84:99]
  buffer_load_dword v216, v240, s[12:15], 0 idxen
  buffer_load_ushort v217, v240, s[12:15], 0 idxen offset:4
  s_waitcnt vmcnt(6) lgkmcnt(0)
  v_lshlrev_b32 v191, 4, v190
  v_alignbit_b32 v188, v189, v188, v191
  v_bfe_u32 v189, v189, v191, 16
  v_dot2_f32_bf16 v228, v188, s0, v220
  v_dot2_f32_bf16 v229, v188, s1, v221
  v_dot2_f32_bf16 v238, v189, s0, v222
  s_nop 0
  v_mul_f32 v239, v228, v228
  v_cvt_pk_bf16_f32 v224, 1.0, v228
  v_fmac_f32 v239, v229, v229
  v_cvt_pk_bf16_f32 v225, v229, v238
  v_fmac_f32 v239, v238, v238
  v_cvt_pk_bf16_f32 v239, v239, v239
  v_cmp_ne_u16 s[64:65], s100, v235
  v_bfi_b32 v235, s100, v239, v235
  ds_write_b64 v249, v[234:235] offset:0
  ds_read_b64 v[234:235], v251 offset:512
  ds_read_b64 v[214:215], v252 offset:0
  v_lshlrev_b32 v243, 4, v0
  v_add_u32 v243, s92, v243
  v_mov_b32 v204, 0
  v_mov_b32 v205, 0
  v_mov_b32 v206, 0
  v_mov_b32 v207, 0
  s_waitcnt lgkmcnt(0)
  v_add3_u32 v241, v214, v247, s49
  ds_read_b64 v[212:213], v241 offset:32
  s_mov_b64 exec, s[74:75]
  ds_read_b64 v[214:215], v241 offset:0
  s_mov_b64 exec, -1
  ds_write_b128 v243, v[204:207] offset:0
  ds_write_b128 v243, v[204:207] offset:1024
  s_sub_u32 s68, s8, 3072
  s_subb_u32 s69, s9, 0
  s_or_b32 s69, s69, 8388608
  s_mov_b32 s70, 50000
  s_mov_b32 s71, 0x00020000
  s_mov_b32 m0, s88
  v_add_u32 v57, 3072, v57
  v_add_u32 v59, 2048, v59
  v_add_u32 v61, 1024, v61
  ds_read_b64 v[180:181], v242
  ds_read_b64 v[184:185], v242 offset:256
  v_mov_b32 v182, 0
  v_mov_b32 v183, v2
  v_mov_b32 v186, 0
  v_mov_b32 v187, v3
  s_mov_b64 exec, s[74:75]
  ds_read_b64 v[182:183], v242 offset:512
  ds_read_b64 v[186:187], v242 offset:768
  s_mov_b64 exec, -1
  s_waitcnt lgkmcnt(0)
  v_mfma_f32_32x32x16_bf16 v[68:83], v[212:215], v[180:183], v[68:83]
  v_mfma_f32_32x32x16_bf16 v[84:99], v[212:215], v[184:187], v[84:99]
  s_nop 10
  v_exp_f32 v196, v68
  v_exp_f32 v197, v69
  v_exp_f32 v198, v70
  v_exp_f32 v199, v71
  v_exp_f32 v200, v72
  v_exp_f32 v201, v73
  v_exp_f32 v202, v74
  v_exp_f32 v203, v75
  v_exp_f32 v204, v76
  v_exp_f32 v205, v77
  v_exp_f32 v206, v78
  v_exp_f32 v207, v79
  v_exp_f32 v208, v80
  v_exp_f32 v209, v81
  v_exp_f32 v210, v82
  v_exp_f32 v211, v83
  s_nop 1
  v_mfma_f32_32x32x8_bf16 v[196:211], v[54:55], v[54:55], v[196:211]
  s_branch K2_entryB
K2_tailA0:
  s_setprio 0
  s_and_b64 exec, s[74:75], s[64:65]
  ds_write_b64 v236, v[224:225]
  s_mov_b64 exec, -1
  ds_read_b64_tr_b16 v[188:189], v244 offset:0
  ds_read_b64_tr_b16 v[190:191], v244 offset:512
  ds_read_b64_tr_b16 v[192:193], v244 offset:1024
  ds_read_b64_tr_b16 v[194:195], v244 offset:1536
  ds_write_b64 v236, v[52:53]
  s_cmp_ge_u32 s44, s50
  s_cbranch_scc1 K2_tfulA0
K2_backTA0:
  s_nop 3
  v_rcp_f32 v196, v196
  v_rcp_f32 v197, v197
  v_rcp_f32 v198, v198
  v_rcp_f32 v199, v199
  v_rcp_f32 v200, v200
  v_rcp_f32 v201, v201
  v_rcp_f32 v202, v202
  v_rcp_f32 v203, v203
  v_rcp_f32 v204, v204
  v_rcp_f32 v205, v205
  v_rcp_f32 v206, v206
  v_rcp_f32 v207, v207
  v_rcp_f32 v208, v208
  v_rcp_f32 v209, v209
  v_rcp_f32 v210, v210
  v_rcp_f32 v211, v211
  s_setprio 1
  v_pk_mul_f32 v[196:197], v[196:197], v[68:69]
  v_pk_mul_f32 v[198:199], v[198:199], v[70:71]
  v_pk_mul_f32 v[200:201], v[200:201], v[72:73]
  v_pk_mul_f32 v[202:203], v[202:203], v[74:75]
  v_pk_mul_f32 v[204:205], v[204:205], v[76:77]
  v_pk_mul_f32 v[206:207], v[206:207], v[78:79]
  v_pk_mul_f32 v[208:209], v[208:209], v[80:81]
  v_pk_mul_f32 v[210:211], v[210:211], v[82:83]
  v_exp_f32 v68, v84
  v_exp_f32 v69, v85
  v_exp_f32 v70, v86
  v_exp_f32 v71, v87
  v_exp_f32 v72, v88
  v_exp_f32 v73, v89
  v_exp_f32 v74, v90
  v_exp_f32 v75, v91
  v_exp_f32 v76, v92
  v_exp_f32 v77, v93
  v_exp_f32 v78, v94
  v_exp_f32 v79, v95
  v_exp_f32 v80, v96
  v_exp_f32 v81, v97
  v_exp_f32 v82, v98
  v_exp_f32 v83, v99
  s_nop 1
  v_mfma_f32_32x32x8_bf16 v[68:83], v[54:55], v[54:55], v[68:83]
  v_cvt_pk_bf16_f32 v196, v196, v197
  v_cvt_pk_bf16_f32 v197, v198, v199
  v_cvt_pk_bf16_f32 v198, v200, v201
  v_cvt_pk_bf16_f32 v199, v202, v203
  v_cvt_pk_bf16_f32 v200, v204, v205
  s_waitcnt lgkmcnt(0)
  v_mfma_f32_32x32x16_bf16 v[132:147], v[196:199], v[188:191], v[132:147]
  v_cvt_pk_bf16_f32 v201, v206, v207
  v_cvt_pk_bf16_f32 v202, v208, v209
  v_cvt_pk_bf16_f32 v203, v210, v211
  s_nop 1
  v_mfma_f32_32x32x16_bf16 v[132:147], v[200:203], v[192:195], v[132:147]
  s_nop 0
  v_rcp_f32 v68, v68
  v_rcp_f32 v69, v69
  v_rcp_f32 v70, v70
  v_rcp_f32 v71, v71
  v_rcp_f32 v72, v72
  v_rcp_f32 v73, v73
  v_rcp_f32 v74, v74
  v_rcp_f32 v75, v75
  v_rcp_f32 v76, v76
  v_rcp_f32 v77, v77
  v_rcp_f32 v78, v78
  v_rcp_f32 v79, v79
  v_rcp_f32 v80, v80
  v_rcp_f32 v81, v81
  v_rcp_f32 v82, v82
  v_rcp_f32 v83, v83
  v_pk_mul_f32 v[68:69], v[68:69], v[84:85]
  v_pk_mul_f32 v[70:71], v[70:71], v[86:87]
  v_pk_mul_f32 v[72:73], v[72:73], v[88:89]
  v_pk_mul_f32 v[74:75], v[74:75], v[90:91]
  v_pk_mul_f32 v[76:77], v[76:77], v[92:93]
  v_pk_mul_f32 v[78:79], v[78:79], v[94:95]
  v_pk_mul_f32 v[80:81], v[80:81], v[96:97]
  v_pk_mul_f32 v[82:83], v[82:83], v[98:99]
  v_cvt_pk_bf16_f32 v68, v68, v69
  v_cvt_pk_bf16_f32 v69, v70, v71
  v_cvt_pk_bf16_f32 v70, v72, v73
  v_cvt_pk_bf16_f32 v71, v74, v75
  v_cvt_pk_bf16_f32 v72, v76, v77
  v_cvt_pk_bf16_f32 v73, v78, v79
  v_mfma_f32_32x32x16_bf16 v[148:163], v[68:71], v[188:191], v[148:163]
  v_cvt_pk_bf16_f32 v74, v80, v81
  v_cvt_pk_bf16_f32 v75, v82, v83
  s_nop 1
  v_mfma_f32_32x32x16_bf16 v[148:163], v[72:75], v[192:195], v[148:163]
  s_branch K2_exit0
K2_tfulA0:
  s_mov_b32 s62, 1
  s_branch K2_flushA0
K2_preA0:
  s_setprio 2
  s_waitcnt vmcnt(2)
  ds_read_b128 v[164:167], v64
  ds_read_b128 v[168:171], v65
  ds_read_b128 v[172:175], v66
  ds_read_b128 v[176:179], v67
  ds_read_b64 v[214:215], v252 offset:256
  s_and_b64 exec, s[74:75], s[64:65]
  ds_write_b64 v236, v[224:225]
  s_mov_b64 exec, -1
  ds_read_b64_tr_b16 v[188:189], v244 offset:0
  ds_read_b64_tr_b16 v[190:191], v244 offset:512
  ds_read_b64_tr_b16 v[192:193], v244 offset:1024
  ds_read_b64_tr_b16 v[194:195], v244 offset:1536
  ds_write_b64 v236, v[52:53]
  s_and_b32 s48, s41, 0xffffffe0
  s_sub_u32 s49, 0, s48
  v_lshl_add_u32 v242, s48, 4, v246
  ds_read_b64 v[180:181], v242
  ds_read_b64 v[184:185], v242 offset:256
  s_waitcnt lgkmcnt(8)
  v_add3_u32 v241, v214, v247, s49
  ds_read_b64 v[212:213], v241 offset:32
  s_mov_b64 exec, s[74:75]
  ds_read_b64 v[214:215], v241 offset:0
  ds_read_b64 v[182:183], v242 offset:512
  ds_read_b64 v[186:187], v242 offset:768
  s_mov_b64 exec, -1
  s_cmp_ge_u32 s44, s50
  s_cbranch_scc1 K2_pfulA0
K2_backPA0:
  s_setprio 0
  v_mfma_f32_32x32x16_bf16 v[100:115], v[164:167], v[4:7], 0
  v_rcp_f32 v196, v196
  v_rcp_f32 v197, v197
  v_rcp_f32 v198, v198
  v_rcp_f32 v199, v199
  v_mfma_f32_32x32x16_bf16 v[116:131], v[164:167], v[8:11], 0
  v_rcp_f32 v200, v200
  v_rcp_f32 v201, v201
  v_rcp_f32 v202, v202
  v_rcp_f32 v203, v203
  v_mfma_f32_32x32x16_bf16 v[100:115], v[168:171], v[12:15], v[100:115]
  v_rcp_f32 v204, v204
  v_rcp_f32 v205, v205
  v_rcp_f32 v206, v206
  v_rcp_f32 v207, v207
  v_rcp_f32 v208, v208
  v_rcp_f32 v209, v209
  v_rcp_f32 v210, v210
  v_rcp_f32 v211, v211
  s_setprio 1
  v_pk_mul_f32 v[196:197], v[196:197], v[68:69]
  v_pk_mul_f32 v[198:199], v[198:199], v[70:71]
  v_pk_mul_f32 v[200:201], v[200:201], v[72:73]
  v_pk_mul_f32 v[202:203], v[202:203], v[74:75]
  v_pk_mul_f32 v[204:205], v[204:205], v[76:77]
  v_pk_mul_f32 v[206:207], v[206:207], v[78:79]
  v_pk_mul_f32 v[208:209], v[208:209], v[80:81]
  v_pk_mul_f32 v[210:211], v[210:211], v[82:83]
  v_mfma_f32_32x32x16_bf16 v[116:131], v[168:171], v[16:19], v[116:131]
  v_exp_f32 v68, v84
  v_exp_f32 v69, v85
  v_exp_f32 v70, v86
  v_mfma_f32_32x32x16_bf16 v[100:115], v[172:175], v[20:23], v[100:115]
  v_exp_f32 v71, v87
  v_exp_f32 v72, v88
  v_exp_f32 v73, v89
  v_mfma_f32_32x32x16_bf16 v[116:131], v[172:175], v[24:27], v[116:131]
  v_exp_f32 v74, v90
  v_exp_f32 v75, v91
  v_exp_f32 v76, v92
  v_mfma_f32_32x32x16_bf16 v[100:115], v[176:179], v[28:31], v[100:115]
  v_exp_f32 v77, v93
  v_exp_f32 v78, v94
  v_exp_f32 v79, v95
  v_exp_f32 v80, v96
  v_exp_f32 v81, v97
  v_exp_f32 v82, v98
  v_exp_f32 v83, v99
  s_nop 1
  v_mfma_f32_32x32x8_bf16 v[68:83], v[54:55], v[54:55], v[68:83]
  v_cvt_pk_bf16_f32 v196, v196, v197
  v_cvt_pk_bf16_f32 v197, v198, v199
  v_cvt_pk_bf16_f32 v198, v200, v201
  v_cvt_pk_bf16_f32 v199, v202, v203
  v_cvt_pk_bf16_f32 v200, v204, v205
  s_waitcnt lgkmcnt(0)
  v_mfma_f32_32x32x16_bf16 v[132:147], v[196:199], v[188:191], v[132:147]
  v_cvt_pk_bf16_f32 v201, v206, v207
  v_cvt_pk_bf16_f32 v202, v208, v209
  v_cvt_pk_bf16_f32 v203, v210, v211
  s_nop 1
  v_mfma_f32_32x32x16_bf16 v[132:147], v[200:203], v[192:195], v[132:147]
  s_nop 0
  v_rcp_f32 v68, v68
  v_rcp_f32 v69, v69
  v_rcp_f32 v70, v70
  v_rcp_f32 v71, v71
  v_rcp_f32 v72, v72
  v_rcp_f32 v73, v73
  v_mfma_f32_32x32x16_bf16 v[100:115], v[212:215], v[180:183], v[100:115]
  v_rcp_f32 v74, v74
  v_rcp_f32 v75, v75
  v_rcp_f32 v76, v76
  v_rcp_f32 v77, v77
  v_mfma_f32_32x32x16_bf16 v[116:131], v[176:179], v[32:35], v[116:131]
  v_rcp_f32 v78, v78
  v_rcp_f32 v79, v79
  v_rcp_f32 v80, v80
  v_rcp_f32 v81, v81
  v_rcp_f32 v82, v82
  v_rcp_f32 v83, v83
  v_pk_mul_f32 v[68:69], v[68:69], v[84:85]
  v_pk_mul_f32 v[70:71], v[70:71], v[86:87]
  v_pk_mul_f32 v[72:73], v[72:73], v[88:89]
  v_pk_mul_f32 v[74:75], v[74:75], v[90:91]
  v_pk_mul_f32 v[76:77], v[76:77], v[92:93]
  v_pk_mul_f32 v[78:79], v[78:79], v[94:95]
  v_pk_mul_f32 v[80:81], v[80:81], v[96:97]
  v_pk_mul_f32 v[82:83], v[82:83], v[98:99]
  v_exp_f32 v196, v100
  v_exp_f32 v197, v101
  v_exp_f32 v198, v102
  v_exp_f32 v199, v103
  v_mfma_f32_32x32x16_bf16 v[116:131], v[212:215], v[184:187], v[116:131]
  v_exp_f32 v200, v104
  v_exp_f32 v201, v105
  v_exp_f32 v202, v106
  v_exp_f32 v203, v107
  v_exp_f32 v204, v108
  v_exp_f32 v205, v109
  v_exp_f32 v206, v110
  v_exp_f32 v207, v111
  v_exp_f32 v208, v112
  v_exp_f32 v209, v113
  v_exp_f32 v210, v114
  v_exp_f32 v211, v115
  s_nop 1
  v_mfma_f32_32x32x8_bf16 v[196:211], v[54:55], v[54:55], v[196:211]
  v_cvt_pk_bf16_f32 v68, v68, v69
  v_cvt_pk_bf16_f32 v69, v70, v71
  v_cvt_pk_bf16_f32 v70, v72, v73
  v_cvt_pk_bf16_f32 v71, v74, v75
  v_cvt_pk_bf16_f32 v72, v76, v77
  v_cvt_pk_bf16_f32 v73, v78, v79
  v_mfma_f32_32x32x16_bf16 v[148:163], v[68:71], v[188:191], v[148:163]
  v_cvt_pk_bf16_f32 v74, v80, v81
  v_cvt_pk_bf16_f32 v75, v82, v83
  s_nop 1
  v_mfma_f32_32x32x16_bf16 v[148:163], v[72:75], v[192:195], v[148:163]
  s_branch K2_tailA1
K2_pfulA0:
  s_mov_b32 s62, 2
  s_branch K2_flushA0
K2_tailA1:
  s_setprio 0
  s_and_b64 exec, s[76:77], s[64:65]
  ds_write_b64 v236, v[224:225]
  s_mov_b64 exec, -1
  ds_read_b64_tr_b16 v[188:189], v244 offset:0
  ds_read_b64_tr_b16 v[190:191], v244 offset:512
  ds_read_b64_tr_b16 v[192:193], v244 offset:1024
  ds_read_b64_tr_b16 v[194:195], v244 offset:1536
  ds_write_b64 v236, v[52:53]
  s_cmp_ge_u32 s45, s50
  s_cbranch_scc1 K2_tfulA1
K2_backTA1:
  s_nop 3
  v_rcp_f32 v196, v196
  v_rcp_f32 v197, v197
  v_rcp_f32 v198, v198
  v_rcp_f32 v199, v199
  v_rcp_f32 v200, v200
  v_rcp_f32 v201, v201
  v_rcp_f32 v202, v202
  v_rcp_f32 v203, v203
  v_rcp_f32 v204, v204
  v_rcp_f32 v205, v205
  v_rcp_f32 v206, v206
  v_rcp_f32 v207, v207
  v_rcp_f32 v208, v208
  v_rcp_f32 v209, v209
  v_rcp_f32 v210, v210
  v_rcp_f32 v211, v211
  s_setprio 1
  v_pk_mul_f32 v[196:197], v[196:197], v[100:101]
  v_pk_mul_f32 v[198:199], v[198:199], v[102:103]
  v_pk_mul_f32 v[200:201], v[200:201], v[104:105]
  v_pk_mul_f32 v[202:203], v[202:203], v[106:107]
  v_pk_mul_f32 v[204:205], v[204:205], v[108:109]
  v_pk_mul_f32 v[206:207], v[206:207], v[110:111]
  v_pk_mul_f32 v[208:209], v[208:209], v[112:113]
  v_pk_mul_f32 v[210:211], v[210:211], v[114:115]
  v_exp_f32 v100, v116
  v_exp_f32 v101, v117
  v_exp_f32 v102, v118
  v_exp_f32 v103, v119
  v_exp_f32 v104, v120
  v_exp_f32 v105, v121
  v_exp_f32 v106, v122
  v_exp_f32 v107, v123
  v_exp_f32 v108, v124
  v_exp_f32 v109, v125
  v_exp_f32 v110, v126
  v_exp_f32 v111, v127
  v_exp_f32 v112, v128
  v_exp_f32 v113, v129
  v_exp_f32 v114, v130
  v_exp_f32 v115, v131
  s_nop 1
  v_mfma_f32_32x32x8_bf16 v[100:115], v[54:55], v[54:55], v[100:115]
  v_cvt_pk_bf16_f32 v196, v196, v197
  v_cvt_pk_bf16_f32 v197, v198, v199
  v_cvt_pk_bf16_f32 v198, v200, v201
  v_cvt_pk_bf16_f32 v199, v202, v203
  v_cvt_pk_bf16_f32 v200, v204, v205
  s_waitcnt lgkmcnt(0)
  v_mfma_f32_32x32x16_bf16 v[132:147], v[196:199], v[188:191], v[132:147]
  v_cvt_pk_bf16_f32 v201, v206, v207
  v_cvt_pk_bf16_f32 v202, v208, v209
  v_cvt_pk_bf16_f32 v203, v210, v211
  s_nop 1
  v_mfma_f32_32x32x16_bf16 v[132:147], v[200:203], v[192:195], v[132:147]
  s_nop 0
  v_rcp_f32 v100, v100
  v_rcp_f32 v101, v101
  v_rcp_f32 v102, v102
  v_rcp_f32 v103, v103
  v_rcp_f32 v104, v104
  v_rcp_f32 v105, v105
  v_rcp_f32 v106, v106
  v_rcp_f32 v107, v107
  v_rcp_f32 v108, v108
  v_rcp_f32 v109, v109
  v_rcp_f32 v110, v110
  v_rcp_f32 v111, v111
  v_rcp_f32 v112, v112
  v_rcp_f32 v113, v113
  v_rcp_f32 v114, v114
  v_rcp_f32 v115, v115
  v_pk_mul_f32 v[100:101], v[100:101], v[116:117]
  v_pk_mul_f32 v[102:103], v[102:103], v[118:119]
  v_pk_mul_f32 v[104:105], v[104:105], v[120:121]
  v_pk_mul_f32 v[106:107], v[106:107], v[122:123]
  v_pk_mul_f32 v[108:109], v[108:109], v[124:125]
  v_pk_mul_f32 v[110:111], v[110:111], v[126:127]
  v_pk_mul_f32 v[112:113], v[112:113], v[128:129]
  v_pk_mul_f32 v[114:115], v[114:115], v[130:131]
  v_cvt_pk_bf16_f32 v100, v100, v101
  v_cvt_pk_bf16_f32 v101, v102, v103
  v_cvt_pk_bf16_f32 v102, v104, v105
  v_cvt_pk_bf16_f32 v103, v106, v107
  v_cvt_pk_bf16_f32 v104, v108, v109
  v_cvt_pk_bf16_f32 v105, v110, v111
  v_mfma_f32_32x32x16_bf16 v[148:163], v[100:103], v[188:191], v[148:163]
  v_cvt_pk_bf16_f32 v106, v112, v113
  v_cvt_pk_bf16_f32 v107, v114, v115
  s_nop 1
  v_mfma_f32_32x32x16_bf16 v[148:163], v[104:107], v[192:195], v[148:163]
  s_branch K2_exit1
K2_tfulA1:
  s_mov_b32 s62, 1
  s_branch K2_flushA1
K2_preA1:
  s_setprio 2
  s_waitcnt vmcnt(0)
  ds_read_b128 v[164:167], v64
  ds_read_b128 v[168:171], v65
  ds_read_b128 v[172:175], v66
  ds_read_b128 v[176:179], v67
  ds_read_b64 v[214:215], v252 offset:512
  s_and_b64 exec, s[76:77], s[64:65]
  ds_write_b64 v236, v[224:225]
  s_mov_b64 exec, -1
  ds_read_b64_tr_b16 v[188:189], v244 offset:0
  ds_read_b64_tr_b16 v[190:191], v244 offset:512
  ds_read_b64_tr_b16 v[192:193], v244 offset:1024
  ds_read_b64_tr_b16 v[194:195], v244 offset:1536
  ds_write_b64 v236, v[52:53]
  s_and_b32 s48, s42, 0xffffffe0
  s_sub_u32 s49, 0, s48
  v_lshl_add_u32 v242, s48, 4, v246
  ds_read_b64 v[180:181], v242
  ds_read_b64 v[184:185], v242 offset:256
  s_waitcnt lgkmcnt(8)
  v_add3_u32 v241, v214, v247, s49
  ds_read_b64 v[212:213], v241 offset:32
  s_mov_b64 exec, s[74:75]
  ds_read_b64 v[214:215], v241 offset:0
  ds_read_b64 v[182:183], v242 offset:512
  ds_read_b64 v[186:187], v242 offset:768
  s_mov_b64 exec, -1
  s_cmp_ge_u32 s45, s50
  s_cbranch_scc1 K2_pfulA1
K2_backPA1:
  s_setprio 0
  v_mfma_f32_32x32x16_bf16 v[68:83], v[164:167], v[4:7], 0
  v_rcp_f32 v196, v196
  v_rcp_f32 v197, v197
  v_rcp_f32 v198, v198
  v_rcp_f32 v199, v199
  v_mfma_f32_32x32x16_bf16 v[84:99], v[164:167], v[8:11], 0
  v_rcp_f32 v200, v200
  v_rcp_f32 v201, v201
  v_rcp_f32 v202, v202
  v_rcp_f32 v203, v203
  v_mfma_f32_32x32x16_bf16 v[68:83], v[168:171], v[12:15], v[68:83]
  v_rcp_f32 v204, v204
  v_rcp_f32 v205, v205
  v_rcp_f32 v206, v206
  v_rcp_f32 v207, v207
  v_rcp_f32 v208, v208
  v_rcp_f32 v209, v209
  v_rcp_f32 v210, v210
  v_rcp_f32 v211, v211
  s_setprio 1
  v_pk_mul_f32 v[196:197], v[196:197], v[100:101]
  v_pk_mul_f32 v[198:199], v[198:199], v[102:103]
  v_pk_mul_f32 v[200:201], v[200:201], v[104:105]
  v_pk_mul_f32 v[202:203], v[202:203], v[106:107]
  v_pk_mul_f32 v[204:205], v[204:205], v[108:109]
  v_pk_mul_f32 v[206:207], v[206:207], v[110:111]
  v_pk_mul_f32 v[208:209], v[208:209], v[112:113]
  v_pk_mul_f32 v[210:211], v[210:211], v[114:115]
  v_mfma_f32_32x32x16_bf16 v[84:99], v[168:171], v[16:19], v[84:99]
  v_exp_f32 v100, v116
  v_exp_f32 v101, v117
  v_exp_f32 v102, v118
  v_mfma_f32_32x32x16_bf16 v[68:83], v[172:175], v[20:23], v[68:83]
  v_exp_f32 v103, v119
  v_exp_f32 v104, v120
  v_exp_f32 v105, v121
  v_mfma_f32_32x32x16_bf16 v[84:99], v[172:175], v[24:27], v[84:99]
  v_exp_f32 v106, v122
  v_exp_f32 v107, v123
  v_exp_f32 v108, v124
  v_mfma_f32_32x32x16_bf16 v[68:83], v[176:179], v[28:31], v[68:83]
  v_exp_f32 v109, v125
  v_exp_f32 v110, v126
  v_exp_f32 v111, v127
  v_exp_f32 v112, v128
  v_exp_f32 v113, v129
  v_exp_f32 v114, v130
  v_exp_f32 v115, v131
  s_nop 1
  v_mfma_f32_32x32x8_bf16 v[100:115], v[54:55], v[54:55], v[100:115]
  v_cvt_pk_bf16_f32 v196, v196, v197
  v_cvt_pk_bf16_f32 v197, v198, v199
  v_cvt_pk_bf16_f32 v198, v200, v201
  v_cvt_pk_bf16_f32 v199, v202, v203
  v_cvt_pk_bf16_f32 v200, v204, v205
  s_waitcnt lgkmcnt(0)
  v_mfma_f32_32x32x16_bf16 v[132:147], v[196:199], v[188:191], v[132:147]
  v_cvt_pk_bf16_f32 v201, v206, v207
  v_cvt_pk_bf16_f32 v202, v208, v209
  v_cvt_pk_bf16_f32 v203, v210, v211
  s_nop 1
  v_mfma_f32_32x32x16_bf16 v[132:147], v[200:203], v[192:195], v[132:147]
  s_nop 0
  v_rcp_f32 v100, v100
  v_rcp_f32 v101, v101
  v_rcp_f32 v102, v102
  v_rcp_f32 v103, v103
  v_rcp_f32 v104, v104
  v_rcp_f32 v105, v105
  v_mfma_f32_32x32x16_bf16 v[68:83], v[212:215], v[180:183], v[68:83]
  v_rcp_f32 v106, v106
  v_rcp_f32 v107, v107
  v_rcp_f32 v108, v108
  v_rcp_f32 v109, v109
  v_mfma_f32_32x32x16_bf16 v[84:99], v[176:179], v[32:35], v[84:99]
  v_rcp_f32 v110, v110
  v_rcp_f32 v111, v111
  v_rcp_f32 v112, v112
  v_rcp_f32 v113, v113
  v_rcp_f32 v114, v114
  v_rcp_f32 v115, v115
  v_pk_mul_f32 v[100:101], v[100:101], v[116:117]
  v_pk_mul_f32 v[102:103], v[102:103], v[118:119]
  v_pk_mul_f32 v[104:105], v[104:105], v[120:121]
  v_pk_mul_f32 v[106:107], v[106:107], v[122:123]
  v_pk_mul_f32 v[108:109], v[108:109], v[124:125]
  v_pk_mul_f32 v[110:111], v[110:111], v[126:127]
  v_pk_mul_f32 v[112:113], v[112:113], v[128:129]
  v_pk_mul_f32 v[114:115], v[114:115], v[130:131]
  v_exp_f32 v196, v68
  v_exp_f32 v197, v69
  v_exp_f32 v198, v70
  v_exp_f32 v199, v71
  v_mfma_f32_32x32x16_bf16 v[84:99], v[212:215], v[184:187], v[84:99]
  v_exp_f32 v200, v72
  v_exp_f32 v201, v73
  v_exp_f32 v202, v74
  v_exp_f32 v203, v75
  v_exp_f32 v204, v76
  v_exp_f32 v205, v77
  v_exp_f32 v206, v78
  v_exp_f32 v207, v79
  v_exp_f32 v208, v80
  v_exp_f32 v209, v81
  v_exp_f32 v210, v82
  v_exp_f32 v211, v83
  s_nop 1
  v_mfma_f32_32x32x8_bf16 v[196:211], v[54:55], v[54:55], v[196:211]
  v_cvt_pk_bf16_f32 v100, v100, v101
  v_cvt_pk_bf16_f32 v101, v102, v103
  v_cvt_pk_bf16_f32 v102, v104, v105
  v_cvt_pk_bf16_f32 v103, v106, v107
  v_cvt_pk_bf16_f32 v104, v108, v109
  v_cvt_pk_bf16_f32 v105, v110, v111
  v_mfma_f32_32x32x16_bf16 v[148:163], v[100:103], v[188:191], v[148:163]
  v_cvt_pk_bf16_f32 v106, v112, v113
  v_cvt_pk_bf16_f32 v107, v114, v115
  s_nop 1
  v_mfma_f32_32x32x16_bf16 v[148:163], v[104:107], v[192:195], v[148:163]
  s_branch K2_tailA2
K2_pfulA1:
  s_mov_b32 s62, 2
  s_branch K2_flushA1
K2_tailA2:
  s_setprio 0
  s_and_b64 exec, s[74:75], s[66:67]
  ds_write_b64 v237, v[226:227]
  s_mov_b64 exec, -1
  ds_read_b64_tr_b16 v[188:189], v244 offset:0
  ds_read_b64_tr_b16 v[190:191], v244 offset:512
  ds_read_b64_tr_b16 v[192:193], v244 offset:1024
  ds_read_b64_tr_b16 v[194:195], v244 offset:1536
  ds_write_b64 v237, v[52:53]
  s_cmp_ge_u32 s46, s50
  s_cbranch_scc1 K2_tfulA2
K2_backTA2:
  s_nop 3
  v_rcp_f32 v196, v196
  v_rcp_f32 v197, v197
  v_rcp_f32 v198, v198
  v_rcp_f32 v199, v199
  v_rcp_f32 v200, v200
  v_rcp_f32 v201, v201
  v_rcp_f32 v202, v202
  v_rcp_f32 v203, v203
  v_rcp_f32 v204, v204
  v_rcp_f32 v205, v205
  v_rcp_f32 v206, v206
  v_rcp_f32 v207, v207
  v_rcp_f32 v208, v208
  v_rcp_f32 v209, v209
  v_rcp_f32 v210, v210
  v_rcp_f32 v211, v211
  s_setprio 1
  v_pk_mul_f32 v[196:197], v[196:197], v[68:69]
  v_pk_mul_f32 v[198:199], v[198:199], v[70:71]
  v_pk_mul_f32 v[200:201], v[200:201], v[72:73]
  v_pk_mul_f32 v[202:203], v[202:203], v[74:75]
  v_pk_mul_f32 v[204:205], v[204:205], v[76:77]
  v_pk_mul_f32 v[206:207], v[206:207], v[78:79]
  v_pk_mul_f32 v[208:209], v[208:209], v[80:81]
  v_pk_mul_f32 v[210:211], v[210:211], v[82:83]
  v_exp_f32 v68, v84
  v_exp_f32 v69, v85
  v_exp_f32 v70, v86
  v_exp_f32 v71, v87
  v_exp_f32 v72, v88
  v_exp_f32 v73, v89
  v_exp_f32 v74, v90
  v_exp_f32 v75, v91
  v_exp_f32 v76, v92
  v_exp_f32 v77, v93
  v_exp_f32 v78, v94
  v_exp_f32 v79, v95
  v_exp_f32 v80, v96
  v_exp_f32 v81, v97
  v_exp_f32 v82, v98
  v_exp_f32 v83, v99
  s_nop 1
  v_mfma_f32_32x32x8_bf16 v[68:83], v[54:55], v[54:55], v[68:83]
  v_cvt_pk_bf16_f32 v196, v196, v197
  v_cvt_pk_bf16_f32 v197, v198, v199
  v_cvt_pk_bf16_f32 v198, v200, v201
  v_cvt_pk_bf16_f32 v199, v202, v203
  v_cvt_pk_bf16_f32 v200, v204, v205
  s_waitcnt lgkmcnt(0)
  v_mfma_f32_32x32x16_bf16 v[132:147], v[196:199], v[188:191], v[132:147]
  v_cvt_pk_bf16_f32 v201, v206, v207
  v_cvt_pk_bf16_f32 v202, v208, v209
  v_cvt_pk_bf16_f32 v203, v210, v211
  s_nop 1
  v_mfma_f32_32x32x16_bf16 v[132:147], v[200:203], v[192:195], v[132:147]
  s_nop 0
  v_rcp_f32 v68, v68
  v_rcp_f32 v69, v69
  v_rcp_f32 v70, v70
  v_rcp_f32 v71, v71
  v_rcp_f32 v72, v72
  v_rcp_f32 v73, v73
  v_rcp_f32 v74, v74
  v_rcp_f32 v75, v75
  v_rcp_f32 v76, v76
  v_rcp_f32 v77, v77
  v_rcp_f32 v78, v78
  v_rcp_f32 v79, v79
  v_rcp_f32 v80, v80
  v_rcp_f32 v81, v81
  v_rcp_f32 v82, v82
  v_rcp_f32 v83, v83
  v_pk_mul_f32 v[68:69], v[68:69], v[84:85]
  v_pk_mul_f32 v[70:71], v[70:71], v[86:87]
  v_pk_mul_f32 v[72:73], v[72:73], v[88:89]
  v_pk_mul_f32 v[74:75], v[74:75], v[90:91]
  v_pk_mul_f32 v[76:77], v[76:77], v[92:93]
  v_pk_mul_f32 v[78:79], v[78:79], v[94:95]
  v_pk_mul_f32 v[80:81], v[80:81], v[96:97]
  v_pk_mul_f32 v[82:83], v[82:83], v[98:99]
  v_cvt_pk_bf16_f32 v68, v68, v69
  v_cvt_pk_bf16_f32 v69, v70, v71
  v_cvt_pk_bf16_f32 v70, v72, v73
  v_cvt_pk_bf16_f32 v71, v74, v75
  v_cvt_pk_bf16_f32 v72, v76, v77
  v_cvt_pk_bf16_f32 v73, v78, v79
  v_mfma_f32_32x32x16_bf16 v[148:163], v[68:71], v[188:191], v[148:163]
  v_cvt_pk_bf16_f32 v74, v80, v81
  v_cvt_pk_bf16_f32 v75, v82, v83
  s_nop 1
  v_mfma_f32_32x32x16_bf16 v[148:163], v[72:75], v[192:195], v[148:163]
  s_branch K2_exit2
K2_tfulA2:
  s_mov_b32 s62, 1
  s_branch K2_flushA2
K2_preA2:
  s_setprio 2
  s_waitcnt vmcnt(2)
  ds_read_b128 v[164:167], v64
  ds_read_b128 v[168:171], v65
  ds_read_b128 v[172:175], v66
  ds_read_b128 v[176:179], v67
  ds_read_b64 v[214:215], v252 offset:768
  s_and_b64 exec, s[74:75], s[66:67]
  ds_write_b64 v237, v[226:227]
  s_mov_b64 exec, -1
  ds_read_b64_tr_b16 v[188:189], v244 offset:0
  ds_read_b64_tr_b16 v[190:191], v244 offset:512
  ds_read_b64_tr_b16 v[192:193], v244 offset:1024
  ds_read_b64_tr_b16 v[194:195], v244 offset:1536
  ds_write_b64 v237, v[52:53]
  s_and_b32 s48, s43, 0xffffffe0
  s_sub_u32 s49, 0, s48
  v_lshl_add_u32 v242, s48, 4, v246
  ds_read_b64 v[180:181], v242
  ds_read_b64 v[184:185], v242 offset:256
  s_waitcnt lgkmcnt(8)
  v_add3_u32 v241, v214, v247, s49
  ds_read_b64 v[212:213], v241 offset:32
  s_mov_b64 exec, s[74:75]
  ds_read_b64 v[214:215], v241 offset:0
  ds_read_b64 v[182:183], v242 offset:512
  ds_read_b64 v[186:187], v242 offset:768
  s_mov_b64 exec, -1
  s_cmp_ge_u32 s46, s50
  s_cbranch_scc1 K2_pfulA2
K2_backPA2:
  s_setprio 0
  v_mfma_f32_32x32x16_bf16 v[100:115], v[164:167], v[4:7], 0
  v_rcp_f32 v196, v196
  v_rcp_f32 v197, v197
  v_rcp_f32 v198, v198
  v_rcp_f32 v199, v199
  v_mfma_f32_32x32x16_bf16 v[116:131], v[164:167], v[8:11], 0
  v_rcp_f32 v200, v200
  v_rcp_f32 v201, v201
  v_rcp_f32 v202, v202
  v_rcp_f32 v203, v203
  v_mfma_f32_32x32x16_bf16 v[100:115], v[168:171], v[12:15], v[100:115]
  v_rcp_f32 v204, v204
  v_rcp_f32 v205, v205
  v_rcp_f32 v206, v206
  v_rcp_f32 v207, v207
  v_rcp_f32 v208, v208
  v_rcp_f32 v209, v209
  v_rcp_f32 v210, v210
  v_rcp_f32 v211, v211
  s_setprio 1
  v_pk_mul_f32 v[196:197], v[196:197], v[68:69]
  v_pk_mul_f32 v[198:199], v[198:199], v[70:71]
  v_pk_mul_f32 v[200:201], v[200:201], v[72:73]
  v_pk_mul_f32 v[202:203], v[202:203], v[74:75]
  v_pk_mul_f32 v[204:205], v[204:205], v[76:77]
  v_pk_mul_f32 v[206:207], v[206:207], v[78:79]
  v_pk_mul_f32 v[208:209], v[208:209], v[80:81]
  v_pk_mul_f32 v[210:211], v[210:211], v[82:83]
  v_mfma_f32_32x32x16_bf16 v[116:131], v[168:171], v[16:19], v[116:131]
  v_exp_f32 v68, v84
  v_exp_f32 v69, v85
  v_exp_f32 v70, v86
  v_mfma_f32_32x32x16_bf16 v[100:115], v[172:175], v[20:23], v[100:115]
  v_exp_f32 v71, v87
  v_exp_f32 v72, v88
  v_exp_f32 v73, v89
  v_mfma_f32_32x32x16_bf16 v[116:131], v[172:175], v[24:27], v[116:131]
  v_exp_f32 v74, v90
  v_exp_f32 v75, v91
  v_exp_f32 v76, v92
  v_mfma_f32_32x32x16_bf16 v[100:115], v[176:179], v[28:31], v[100:115]
  v_exp_f32 v77, v93
  v_exp_f32 v78, v94
  v_exp_f32 v79, v95
  v_exp_f32 v80, v96
  v_exp_f32 v81, v97
  v_exp_f32 v82, v98
  v_exp_f32 v83, v99
  s_nop 1
  v_mfma_f32_32x32x8_bf16 v[68:83], v[54:55], v[54:55], v[68:83]
  v_cvt_pk_bf16_f32 v196, v196, v197
  v_cvt_pk_bf16_f32 v197, v198, v199
  v_cvt_pk_bf16_f32 v198, v200, v201
  v_cvt_pk_bf16_f32 v199, v202, v203
  v_cvt_pk_bf16_f32 v200, v204, v205
  s_waitcnt lgkmcnt(0)
  v_mfma_f32_32x32x16_bf16 v[132:147], v[196:199], v[188:191], v[132:147]
  v_cvt_pk_bf16_f32 v201, v206, v207
  v_cvt_pk_bf16_f32 v202, v208, v209
  v_cvt_pk_bf16_f32 v203, v210, v211
  s_nop 1
  v_mfma_f32_32x32x16_bf16 v[132:147], v[200:203], v[192:195], v[132:147]
  s_nop 0
  v_rcp_f32 v68, v68
  v_rcp_f32 v69, v69
  v_rcp_f32 v70, v70
  v_rcp_f32 v71, v71
  v_rcp_f32 v72, v72
  v_rcp_f32 v73, v73
  v_mfma_f32_32x32x16_bf16 v[100:115], v[212:215], v[180:183], v[100:115]
  v_rcp_f32 v74, v74
  v_rcp_f32 v75, v75
  v_rcp_f32 v76, v76
  v_rcp_f32 v77, v77
  v_mfma_f32_32x32x16_bf16 v[116:131], v[176:179], v[32:35], v[116:131]
  v_rcp_f32 v78, v78
  v_rcp_f32 v79, v79
  v_rcp_f32 v80, v80
  v_rcp_f32 v81, v81
  v_rcp_f32 v82, v82
  v_rcp_f32 v83, v83
  v_pk_mul_f32 v[68:69], v[68:69], v[84:85]
  v_pk_mul_f32 v[70:71], v[70:71], v[86:87]
  v_pk_mul_f32 v[72:73], v[72:73], v[88:89]
  v_pk_mul_f32 v[74:75], v[74:75], v[90:91]
  v_pk_mul_f32 v[76:77], v[76:77], v[92:93]
  v_pk_mul_f32 v[78:79], v[78:79], v[94:95]
  v_pk_mul_f32 v[80:81], v[80:81], v[96:97]
  v_pk_mul_f32 v[82:83], v[82:83], v[98:99]
  v_exp_f32 v196, v100
  v_exp_f32 v197, v101
  v_exp_f32 v198, v102
  v_exp_f32 v199, v103
  v_mfma_f32_32x32x16_bf16 v[116:131], v[212:215], v[184:187], v[116:131]
  v_exp_f32 v200, v104
  v_exp_f32 v201, v105
  v_exp_f32 v202, v106
  v_exp_f32 v203, v107
  v_exp_f32 v204, v108
  v_exp_f32 v205, v109
  v_exp_f32 v206, v110
  v_exp_f32 v207, v111
  v_exp_f32 v208, v112
  v_exp_f32 v209, v113
  v_exp_f32 v210, v114
  v_exp_f32 v211, v115
  s_nop 1
  v_mfma_f32_32x32x8_bf16 v[196:211], v[54:55], v[54:55], v[196:211]
  v_cvt_pk_bf16_f32 v68, v68, v69
  v_cvt_pk_bf16_f32 v69, v70, v71
  v_cvt_pk_bf16_f32 v70, v72, v73
  v_cvt_pk_bf16_f32 v71, v74, v75
  v_cvt_pk_bf16_f32 v72, v76, v77
  v_cvt_pk_bf16_f32 v73, v78, v79
  v_mfma_f32_32x32x16_bf16 v[148:163], v[68:71], v[188:191], v[148:163]
  v_cvt_pk_bf16_f32 v74, v80, v81
  v_cvt_pk_bf16_f32 v75, v82, v83
  s_nop 1
  v_mfma_f32_32x32x16_bf16 v[148:163], v[72:75], v[192:195], v[148:163]
  s_branch K2_tailA3
K2_pfulA2:
  s_mov_b32 s62, 2
  s_branch K2_flushA2
K2_tailA3:
  s_setprio 0
  s_and_b64 exec, s[76:77], s[66:67]
  ds_write_b64 v237, v[226:227]
  s_mov_b64 exec, -1
  ds_read_b64_tr_b16 v[188:189], v244 offset:0
  ds_read_b64_tr_b16 v[190:191], v244 offset:512
  ds_read_b64_tr_b16 v[192:193], v244 offset:1024
  ds_read_b64_tr_b16 v[194:195], v244 offset:1536
  ds_write_b64 v237, v[52:53]
  s_cmp_ge_u32 s47, s50
  s_cbranch_scc1 K2_tfulA3
K2_backTA3:
  s_nop 3
  v_rcp_f32 v196, v196
  v_rcp_f32 v197, v197
  v_rcp_f32 v198, v198
  v_rcp_f32 v199, v199
  v_rcp_f32 v200, v200
  v_rcp_f32 v201, v201
  v_rcp_f32 v202, v202
  v_rcp_f32 v203, v203
  v_rcp_f32 v204, v204
  v_rcp_f32 v205, v205
  v_rcp_f32 v206, v206
  v_rcp_f32 v207, v207
  v_rcp_f32 v208, v208
  v_rcp_f32 v209, v209
  v_rcp_f32 v210, v210
  v_rcp_f32 v211, v211
  s_setprio 1
  v_pk_mul_f32 v[196:197], v[196:197], v[100:101]
  v_pk_mul_f32 v[198:199], v[198:199], v[102:103]
  v_pk_mul_f32 v[200:201], v[200:201], v[104:105]
  v_pk_mul_f32 v[202:203], v[202:203], v[106:107]
  v_pk_mul_f32 v[204:205], v[204:205], v[108:109]
  v_pk_mul_f32 v[206:207], v[206:207], v[110:111]
  v_pk_mul_f32 v[208:209], v[208:209], v[112:113]
  v_pk_mul_f32 v[210:211], v[210:211], v[114:115]
  v_exp_f32 v100, v116
  v_exp_f32 v101, v117
  v_exp_f32 v102, v118
  v_exp_f32 v103, v119
  v_exp_f32 v104, v120
  v_exp_f32 v105, v121
  v_exp_f32 v106, v122
  v_exp_f32 v107, v123
  v_exp_f32 v108, v124
  v_exp_f32 v109, v125
  v_exp_f32 v110, v126
  v_exp_f32 v111, v127
  v_exp_f32 v112, v128
  v_exp_f32 v113, v129
  v_exp_f32 v114, v130
  v_exp_f32 v115, v131
  s_nop 1
  v_mfma_f32_32x32x8_bf16 v[100:115], v[54:55], v[54:55], v[100:115]
  v_cvt_pk_bf16_f32 v196, v196, v197
  v_cvt_pk_bf16_f32 v197, v198, v199
  v_cvt_pk_bf16_f32 v198, v200, v201
  v_cvt_pk_bf16_f32 v199, v202, v203
  v_cvt_pk_bf16_f32 v200, v204, v205
  s_waitcnt lgkmcnt(0)
  v_mfma_f32_32x32x16_bf16 v[132:147], v[196:199], v[188:191], v[132:147]
  v_cvt_pk_bf16_f32 v201, v206, v207
  v_cvt_pk_bf16_f32 v202, v208, v209
  v_cvt_pk_bf16_f32 v203, v210, v211
  s_nop 1
  v_mfma_f32_32x32x16_bf16 v[132:147], v[200:203], v[192:195], v[132:147]
  s_nop 0
  v_rcp_f32 v100, v100
  v_rcp_f32 v101, v101
  v_rcp_f32 v102, v102
  v_rcp_f32 v103, v103
  v_rcp_f32 v104, v104
  v_rcp_f32 v105, v105
  v_rcp_f32 v106, v106
  v_rcp_f32 v107, v107
  v_rcp_f32 v108, v108
  v_rcp_f32 v109, v109
  v_rcp_f32 v110, v110
  v_rcp_f32 v111, v111
  v_rcp_f32 v112, v112
  v_rcp_f32 v113, v113
  v_rcp_f32 v114, v114
  v_rcp_f32 v115, v115
  v_pk_mul_f32 v[100:101], v[100:101], v[116:117]
  v_pk_mul_f32 v[102:103], v[102:103], v[118:119]
  v_pk_mul_f32 v[104:105], v[104:105], v[120:121]
  v_pk_mul_f32 v[106:107], v[106:107], v[122:123]
  v_pk_mul_f32 v[108:109], v[108:109], v[124:125]
  v_pk_mul_f32 v[110:111], v[110:111], v[126:127]
  v_pk_mul_f32 v[112:113], v[112:113], v[128:129]
  v_pk_mul_f32 v[114:115], v[114:115], v[130:131]
  v_cvt_pk_bf16_f32 v100, v100, v101
  v_cvt_pk_bf16_f32 v101, v102, v103
  v_cvt_pk_bf16_f32 v102, v104, v105
  v_cvt_pk_bf16_f32 v103, v106, v107
  v_cvt_pk_bf16_f32 v104, v108, v109
  v_cvt_pk_bf16_f32 v105, v110, v111
  v_mfma_f32_32x32x16_bf16 v[148:163], v[100:103], v[188:191], v[148:163]
  v_cvt_pk_bf16_f32 v106, v112, v113
  v_cvt_pk_bf16_f32 v107, v114, v115
  s_nop 1
  v_mfma_f32_32x32x16_bf16 v[148:163], v[104:107], v[192:195], v[148:163]
  s_branch K2_exit3
K2_tfulA3:
  s_mov_b32 s62, 1
  s_branch K2_flushA3
K2_preA3:
  s_setprio 2
  s_waitcnt vmcnt(0)
  ds_read_b128 v[164:167], v64
  ds_read_b128 v[168:171], v65
  ds_read_b128 v[172:175], v66
  ds_read_b128 v[176:179], v67
  ds_read_b64 v[214:215], v252 offset:0
  s_and_b64 exec, s[76:77], s[66:67]
  ds_write_b64 v237, v[226:227]
  s_mov_b64 exec, -1
  ds_read_b64_tr_b16 v[188:189], v244 offset:0
  ds_read_b64_tr_b16 v[190:191], v244 offset:512
  ds_read_b64_tr_b16 v[192:193], v244 offset:1024
  ds_read_b64_tr_b16 v[194:195], v244 offset:1536
  ds_write_b64 v237, v[52:53]
  s_and_b32 s48, s40, 0xffffffe0
  s_sub_u32 s49, 0, s48
  v_lshl_add_u32 v242, s48, 4, v246
  ds_read_b64 v[180:181], v242
  ds_read_b64 v[184:185], v242 offset:256
  s_waitcnt lgkmcnt(8)
  v_add3_u32 v241, v214, v247, s49
  ds_read_b64 v[212:213], v241 offset:32
  s_mov_b64 exec, s[74:75]
  ds_read_b64 v[214:215], v241 offset:0
  ds_read_b64 v[182:183], v242 offset:512
  ds_read_b64 v[186:187], v242 offset:768
  s_mov_b64 exec, -1
  s_cmp_ge_u32 s47, s50
  s_cbranch_scc1 K2_pfulA3
K2_backPA3:
  s_setprio 0
  v_mfma_f32_32x32x16_bf16 v[68:83], v[164:167], v[4:7], 0
  v_rcp_f32 v196, v196
  v_rcp_f32 v197, v197
  v_rcp_f32 v198, v198
  v_rcp_f32 v199, v199
  v_mfma_f32_32x32x16_bf16 v[84:99], v[164:167], v[8:11], 0
  v_rcp_f32 v200, v200
  v_rcp_f32 v201, v201
  v_rcp_f32 v202, v202
  v_rcp_f32 v203, v203
  v_mfma_f32_32x32x16_bf16 v[68:83], v[168:171], v[12:15], v[68:83]
  v_rcp_f32 v204, v204
  v_rcp_f32 v205, v205
  v_rcp_f32 v206, v206
  v_rcp_f32 v207, v207
  v_rcp_f32 v208, v208
  v_rcp_f32 v209, v209
  v_rcp_f32 v210, v210
  v_rcp_f32 v211, v211
  s_setprio 1
  v_pk_mul_f32 v[196:197], v[196:197], v[100:101]
  v_pk_mul_f32 v[198:199], v[198:199], v[102:103]
  v_pk_mul_f32 v[200:201], v[200:201], v[104:105]
  v_pk_mul_f32 v[202:203], v[202:203], v[106:107]
  v_pk_mul_f32 v[204:205], v[204:205], v[108:109]
  v_pk_mul_f32 v[206:207], v[206:207], v[110:111]
  v_pk_mul_f32 v[208:209], v[208:209], v[112:113]
  v_pk_mul_f32 v[210:211], v[210:211], v[114:115]
  v_mfma_f32_32x32x16_bf16 v[84:99], v[168:171], v[16:19], v[84:99]
  v_exp_f32 v100, v116
  v_exp_f32 v101, v117
  v_exp_f32 v102, v118
  v_mfma_f32_32x32x16_bf16 v[68:83], v[172:175], v[20:23], v[68:83]
  v_exp_f32 v103, v119
  v_exp_f32 v104, v120
  v_exp_f32 v105, v121
  v_mfma_f32_32x32x16_bf16 v[84:99], v[172:175], v[24:27], v[84:99]
  v_exp_f32 v106, v122
  v_exp_f32 v107, v123
  v_exp_f32 v108, v124
  v_mfma_f32_32x32x16_bf16 v[68:83], v[176:179], v[28:31], v[68:83]
  v_exp_f32 v109, v125
  v_exp_f32 v110, v126
  v_exp_f32 v111, v127
  v_exp_f32 v112, v128
  v_exp_f32 v113, v129
  v_exp_f32 v114, v130
  v_exp_f32 v115, v131
  s_nop 1
  v_mfma_f32_32x32x8_bf16 v[100:115], v[54:55], v[54:55], v[100:115]
  v_cvt_pk_bf16_f32 v196, v196, v197
  v_cvt_pk_bf16_f32 v197, v198, v199
  v_cvt_pk_bf16_f32 v198, v200, v201
  v_cvt_pk_bf16_f32 v199, v202, v203
  v_cvt_pk_bf16_f32 v200, v204, v205
  s_waitcnt lgkmcnt(0)
  v_mfma_f32_32x32x16_bf16 v[132:147], v[196:199], v[188:191], v[132:147]
  v_cvt_pk_bf16_f32 v201, v206, v207
  v_cvt_pk_bf16_f32 v202, v208, v209
  v_cvt_pk_bf16_f32 v203, v210, v211
  s_nop 1
  v_mfma_f32_32x32x16_bf16 v[132:147], v[200:203], v[192:195], v[132:147]
  s_nop 0
  v_rcp_f32 v100, v100
  v_rcp_f32 v101, v101
  v_rcp_f32 v102, v102
  v_rcp_f32 v103, v103
  v_rcp_f32 v104, v104
  v_rcp_f32 v105, v105
  v_mfma_f32_32x32x16_bf16 v[68:83], v[212:215], v[180:183], v[68:83]
  v_rcp_f32 v106, v106
  v_rcp_f32 v107, v107
  v_rcp_f32 v108, v108
  v_rcp_f32 v109, v109
  v_mfma_f32_32x32x16_bf16 v[84:99], v[176:179], v[32:35], v[84:99]
  v_rcp_f32 v110, v110
  v_rcp_f32 v111, v111
  v_rcp_f32 v112, v112
  v_rcp_f32 v113, v113
  v_rcp_f32 v114, v114
  v_rcp_f32 v115, v115
  v_pk_mul_f32 v[100:101], v[100:101], v[116:117]
  v_pk_mul_f32 v[102:103], v[102:103], v[118:119]
  v_pk_mul_f32 v[104:105], v[104:105], v[120:121]
  v_pk_mul_f32 v[106:107], v[106:107], v[122:123]
  v_pk_mul_f32 v[108:109], v[108:109], v[124:125]
  v_pk_mul_f32 v[110:111], v[110:111], v[126:127]
  v_pk_mul_f32 v[112:113], v[112:113], v[128:129]
  v_pk_mul_f32 v[114:115], v[114:115], v[130:131]
  v_exp_f32 v196, v68
  v_exp_f32 v197, v69
  v_exp_f32 v198, v70
  v_exp_f32 v199, v71
  v_mfma_f32_32x32x16_bf16 v[84:99], v[212:215], v[184:187], v[84:99]
  v_exp_f32 v200, v72
  v_exp_f32 v201, v73
  v_exp_f32 v202, v74
  v_exp_f32 v203, v75
  v_exp_f32 v204, v76
  v_exp_f32 v205, v77
  v_exp_f32 v206, v78
  v_exp_f32 v207, v79
  v_exp_f32 v208, v80
  v_exp_f32 v209, v81
  v_exp_f32 v210, v82
  v_exp_f32 v211, v83
  s_nop 1
  v_mfma_f32_32x32x8_bf16 v[196:211], v[54:55], v[54:55], v[196:211]
  v_cvt_pk_bf16_f32 v100, v100, v101
  v_cvt_pk_bf16_f32 v101, v102, v103
  v_cvt_pk_bf16_f32 v102, v104, v105
  v_cvt_pk_bf16_f32 v103, v106, v107
  v_cvt_pk_bf16_f32 v104, v108, v109
  v_cvt_pk_bf16_f32 v105, v110, v111
  v_mfma_f32_32x32x16_bf16 v[148:163], v[100:103], v[188:191], v[148:163]
  v_cvt_pk_bf16_f32 v106, v112, v113
  v_cvt_pk_bf16_f32 v107, v114, v115
  s_nop 1
  v_mfma_f32_32x32x16_bf16 v[148:163], v[104:107], v[192:195], v[148:163]
  s_branch K2_tailA0
K2_pfulA3:
  s_mov_b32 s62, 2
  s_branch K2_flushA3
K2_tailB0:
  s_setprio 0
  s_and_b64 exec, s[74:75], s[64:65]
  ds_write_b64 v236, v[224:225]
  s_mov_b64 exec, -1
  ds_read_b64_tr_b16 v[188:189], v244 offset:0
  ds_read_b64_tr_b16 v[190:191], v244 offset:512
  ds_read_b64_tr_b16 v[192:193], v244 offset:1024
  ds_read_b64_tr_b16 v[194:195], v244 offset:1536
  ds_write_b64 v236, v[52:53]
  s_cmp_ge_u32 s44, s50
  s_cbranch_scc1 K2_tfulB0
K2_backTB0:
  s_nop 3
  v_rcp_f32 v196, v196
  v_rcp_f32 v197, v197
  v_rcp_f32 v198, v198
  v_rcp_f32 v199, v199
  v_rcp_f32 v200, v200
  v_rcp_f32 v201, v201
  v_rcp_f32 v202, v202
  v_rcp_f32 v203, v203
  v_rcp_f32 v204, v204
  v_rcp_f32 v205, v205
  v_rcp_f32 v206, v206
  v_rcp_f32 v207, v207
  v_rcp_f32 v208, v208
  v_rcp_f32 v209, v209
  v_rcp_f32 v210, v210
  v_rcp_f32 v211, v211
  s_setprio 2
  v_pk_mul_f32 v[196:197], v[196:197], v[68:69]
  v_pk_mul_f32 v[198:199], v[198:199], v[70:71]
  v_pk_mul_f32 v[200:201], v[200:201], v[72:73]
  v_pk_mul_f32 v[202:203], v[202:203], v[74:75]
  v_pk_mul_f32 v[204:205], v[204:205], v[76:77]
  v_pk_mul_f32 v[206:207], v[206:207], v[78:79]
  v_pk_mul_f32 v[208:209], v[208:209], v[80:81]
  v_pk_mul_f32 v[210:211], v[210:211], v[82:83]
  v_exp_f32 v68, v84
  v_exp_f32 v69, v85
  v_exp_f32 v70, v86
  v_exp_f32 v71, v87
  v_exp_f32 v72, v88
  v_exp_f32 v73, v89
  v_exp_f32 v74, v90
  v_exp_f32 v75, v91
  v_exp_f32 v76, v92
  v_exp_f32 v77, v93
  v_exp_f32 v78, v94
  v_exp_f32 v79, v95
  v_exp_f32 v80, v96
  v_exp_f32 v81, v97
  v_exp_f32 v82, v98
  v_exp_f32 v83, v99
  s_nop 1
  v_mfma_f32_32x32x8_bf16 v[68:83], v[54:55], v[54:55], v[68:83]
  v_cvt_pk_bf16_f32 v196, v196, v197
  v_cvt_pk_bf16_f32 v197, v198, v199
  v_cvt_pk_bf16_f32 v198, v200, v201
  v_cvt_pk_bf16_f32 v199, v202, v203
  v_cvt_pk_bf16_f32 v200, v204, v205
  s_waitcnt lgkmcnt(0)
  v_mfma_f32_32x32x16_bf16 v[132:147], v[196:199], v[188:191], v[132:147]
  v_cvt_pk_bf16_f32 v201, v206, v207
  v_cvt_pk_bf16_f32 v202, v208, v209
  v_cvt_pk_bf16_f32 v203, v210, v211
  s_nop 1
  v_mfma_f32_32x32x16_bf16 v[132:147], v[200:203], v[192:195], v[132:147]
  s_nop 0
  v_rcp_f32 v68, v68
  v_rcp_f32 v69, v69
  v_rcp_f32 v70, v70
  v_rcp_f32 v71, v71
  v_rcp_f32 v72, v72
  v_rcp_f32 v73, v73
  v_rcp_f32 v74, v74
  v_rcp_f32 v75, v75
  v_rcp_f32 v76, v76
  v_rcp_f32 v77, v77
  v_rcp_f32 v78, v78
  v_rcp_f32 v79, v79
  v_rcp_f32 v80, v80
  v_rcp_f32 v81, v81
  v_rcp_f32 v82, v82
  v_rcp_f32 v83, v83
  v_pk_mul_f32 v[68:69], v[68:69], v[84:85]
  v_pk_mul_f32 v[70:71], v[70:71], v[86:87]
  v_pk_mul_f32 v[72:73], v[72:73], v[88:89]
  v_pk_mul_f32 v[74:75], v[74:75], v[90:91]
  v_pk_mul_f32 v[76:77], v[76:77], v[92:93]
  v_pk_mul_f32 v[78:79], v[78:79], v[94:95]
  v_pk_mul_f32 v[80:81], v[80:81], v[96:97]
  v_pk_mul_f32 v[82:83], v[82:83], v[98:99]
  v_cvt_pk_bf16_f32 v68, v68, v69
  v_cvt_pk_bf16_f32 v69, v70, v71
  v_cvt_pk_bf16_f32 v70, v72, v73
  v_cvt_pk_bf16_f32 v71, v74, v75
  v_cvt_pk_bf16_f32 v72, v76, v77
  v_cvt_pk_bf16_f32 v73, v78, v79
  v_mfma_f32_32x32x16_bf16 v[148:163], v[68:71], v[188:191], v[148:163]
  v_cvt_pk_bf16_f32 v74, v80, v81
  v_cvt_pk_bf16_f32 v75, v82, v83
  s_nop 1
  v_mfma_f32_32x32x16_bf16 v[148:163], v[72:75], v[192:195], v[148:163]
  s_branch K2_exit0
K2_tfulB0:
  s_mov_b32 s62, 1
  s_branch K2_flushB0
K2_preB0:
  s_setprio 3
  s_waitcnt vmcnt(2)
  ds_read_b128 v[164:167], v64
  ds_read_b128 v[168:171], v65
  ds_read_b128 v[172:175], v66
  ds_read_b128 v[176:179], v67
  ds_read_b64 v[214:215], v252 offset:256
  s_and_b64 exec, s[74:75], s[64:65]
  ds_write_b64 v236, v[224:225]
  s_mov_b64 exec, -1
  ds_read_b64_tr_b16 v[188:189], v244 offset:0
  ds_read_b64_tr_b16 v[190:191], v244 offset:512
  ds_read_b64_tr_b16 v[192:193], v244 offset:1024
  ds_read_b64_tr_b16 v[194:195], v244 offset:1536
  ds_write_b64 v236, v[52:53]
  s_and_b32 s48, s41, 0xffffffe0
  s_sub_u32 s49, 0, s48
  v_lshl_add_u32 v242, s48, 4, v246
  ds_read_b64 v[180:181], v242
  ds_read_b64 v[184:185], v242 offset:256
  s_waitcnt lgkmcnt(8)
  v_add3_u32 v241, v214, v247, s49
  ds_read_b64 v[212:213], v241 offset:32
  s_mov_b64 exec, s[74:75]
  ds_read_b64 v[214:215], v241 offset:0
  ds_read_b64 v[182:183], v242 offset:512
  ds_read_b64 v[186:187], v242 offset:768
  s_mov_b64 exec, -1
  s_cmp_ge_u32 s44, s50
  s_cbranch_scc1 K2_pfulB0
K2_backPB0:
  s_setprio 0
  v_mfma_f32_32x32x16_bf16 v[100:115], v[164:167], v[4:7], 0
  v_rcp_f32 v196, v196
  v_rcp_f32 v197, v197
  v_rcp_f32 v198, v198
  v_rcp_f32 v199, v199
  v_mfma_f32_32x32x16_bf16 v[116:131], v[164:167], v[8:11], 0
  v_rcp_f32 v200, v200
  v_rcp_f32 v201, v201
  v_rcp_f32 v202, v202
  v_rcp_f32 v203, v203
  v_mfma_f32_32x32x16_bf16 v[100:115], v[168:171], v[12:15], v[100:115]
  v_rcp_f32 v204, v204
  v_rcp_f32 v205, v205
  v_rcp_f32 v206, v206
  v_rcp_f32 v207, v207
  v_rcp_f32 v208, v208
  v_rcp_f32 v209, v209
  v_rcp_f32 v210, v210
  v_rcp_f32 v211, v211
  s_setprio 2
  v_pk_mul_f32 v[196:197], v[196:197], v[68:69]
  v_pk_mul_f32 v[198:199], v[198:199], v[70:71]
  v_pk_mul_f32 v[200:201], v[200:201], v[72:73]
  v_pk_mul_f32 v[202:203], v[202:203], v[74:75]
  v_pk_mul_f32 v[204:205], v[204:205], v[76:77]
  v_pk_mul_f32 v[206:207], v[206:207], v[78:79]
  v_pk_mul_f32 v[208:209], v[208:209], v[80:81]
  v_pk_mul_f32 v[210:211], v[210:211], v[82:83]
  v_mfma_f32_32x32x16_bf16 v[116:131], v[168:171], v[16:19], v[116:131]
  v_exp_f32 v68, v84
  v_exp_f32 v69, v85
  v_exp_f32 v70, v86
  v_mfma_f32_32x32x16_bf16 v[100:115], v[172:175], v[20:23], v[100:115]
  v_exp_f32 v71, v87
  v_exp_f32 v72, v88
  v_exp_f32 v73, v89
  v_mfma_f32_32x32x16_bf16 v[116:131], v[172:175], v[24:27], v[116:131]
  v_exp_f32 v74, v90
  v_exp_f32 v75, v91
  v_exp_f32 v76, v92
  v_mfma_f32_32x32x16_bf16 v[100:115], v[176:179], v[28:31], v[100:115]
  v_exp_f32 v77, v93
  v_exp_f32 v78, v94
  v_exp_f32 v79, v95
  v_exp_f32 v80, v96
  v_exp_f32 v81, v97
  v_exp_f32 v82, v98
  v_exp_f32 v83, v99
  s_nop 1
  v_mfma_f32_32x32x8_bf16 v[68:83], v[54:55], v[54:55], v[68:83]
  v_cvt_pk_bf16_f32 v196, v196, v197
  v_cvt_pk_bf16_f32 v197, v198, v199
  v_cvt_pk_bf16_f32 v198, v200, v201
  v_cvt_pk_bf16_f32 v199, v202, v203
  v_cvt_pk_bf16_f32 v200, v204, v205
  s_waitcnt lgkmcnt(0)
  v_mfma_f32_32x32x16_bf16 v[132:147], v[196:199], v[188:191], v[132:147]
  v_cvt_pk_bf16_f32 v201, v206, v207
  v_cvt_pk_bf16_f32 v202, v208, v209
  v_cvt_pk_bf16_f32 v203, v210, v211
  s_nop 1
  v_mfma_f32_32x32x16_bf16 v[132:147], v[200:203], v[192:195], v[132:147]
  s_nop 0
  v_rcp_f32 v68, v68
  v_rcp_f32 v69, v69
  v_rcp_f32 v70, v70
  v_rcp_f32 v71, v71
  v_rcp_f32 v72, v72
  v_rcp_f32 v73, v73
  v_mfma_f32_32x32x16_bf16 v[100:115], v[212:215], v[180:183], v[100:115]
  v_rcp_f32 v74, v74
  v_rcp_f32 v75, v75
  v_rcp_f32 v76, v76
  v_rcp_f32 v77, v77
  v_mfma_f32_32x32x16_bf16 v[116:131], v[176:179], v[32:35], v[116:131]
  v_rcp_f32 v78, v78
  v_rcp_f32 v79, v79
  v_rcp_f32 v80, v80
  v_rcp_f32 v81, v81
  v_rcp_f32 v82, v82
  v_rcp_f32 v83, v83
  v_pk_mul_f32 v[68:69], v[68:69], v[84:85]
  v_pk_mul_f32 v[70:71], v[70:71], v[86:87]
  v_pk_mul_f32 v[72:73], v[72:73], v[88:89]
  v_pk_mul_f32 v[74:75], v[74:75], v[90:91]
  v_pk_mul_f32 v[76:77], v[76:77], v[92:93]
  v_pk_mul_f32 v[78:79], v[78:79], v[94:95]
  v_pk_mul_f32 v[80:81], v[80:81], v[96:97]
  v_pk_mul_f32 v[82:83], v[82:83], v[98:99]
  v_exp_f32 v196, v100
  v_exp_f32 v197, v101
  v_exp_f32 v198, v102
  v_exp_f32 v199, v103
  v_mfma_f32_32x32x16_bf16 v[116:131], v[212:215], v[184:187], v[116:131]
  v_exp_f32 v200, v104
  v_exp_f32 v201, v105
  v_exp_f32 v202, v106
  v_exp_f32 v203, v107
  v_exp_f32 v204, v108
  v_exp_f32 v205, v109
  v_exp_f32 v206, v110
  v_exp_f32 v207, v111
  v_exp_f32 v208, v112
  v_exp_f32 v209, v113
  v_exp_f32 v210, v114
  v_exp_f32 v211, v115
  s_nop 1
  v_mfma_f32_32x32x8_bf16 v[196:211], v[54:55], v[54:55], v[196:211]
  v_cvt_pk_bf16_f32 v68, v68, v69
  v_cvt_pk_bf16_f32 v69, v70, v71
  v_cvt_pk_bf16_f32 v70, v72, v73
  v_cvt_pk_bf16_f32 v71, v74, v75
  v_cvt_pk_bf16_f32 v72, v76, v77
  v_cvt_pk_bf16_f32 v73, v78, v79
  v_mfma_f32_32x32x16_bf16 v[148:163], v[68:71], v[188:191], v[148:163]
  v_cvt_pk_bf16_f32 v74, v80, v81
  v_cvt_pk_bf16_f32 v75, v82, v83
  s_nop 1
  v_mfma_f32_32x32x16_bf16 v[148:163], v[72:75], v[192:195], v[148:163]
  s_branch K2_tailB1
K2_pfulB0:
  s_mov_b32 s62, 2
  s_branch K2_flushB0
K2_tailB1:
  s_setprio 0
  s_and_b64 exec, s[76:77], s[64:65]
  ds_write_b64 v236, v[224:225]
  s_mov_b64 exec, -1
  ds_read_b64_tr_b16 v[188:189], v244 offset:0
  ds_read_b64_tr_b16 v[190:191], v244 offset:512
  ds_read_b64_tr_b16 v[192:193], v244 offset:1024
  ds_read_b64_tr_b16 v[194:195], v244 offset:1536
  ds_write_b64 v236, v[52:53]
  s_cmp_ge_u32 s45, s50
  s_cbranch_scc1 K2_tfulB1
K2_backTB1:
  s_nop 3
  v_rcp_f32 v196, v196
  v_rcp_f32 v197, v197
  v_rcp_f32 v198, v198
  v_rcp_f32 v199, v199
  v_rcp_f32 v200, v200
  v_rcp_f32 v201, v201
  v_rcp_f32 v202, v202
  v_rcp_f32 v203, v203
  v_rcp_f32 v204, v204
  v_rcp_f32 v205, v205
  v_rcp_f32 v206, v206
  v_rcp_f32 v207, v207
  v_rcp_f32 v208, v208
  v_rcp_f32 v209, v209
  v_rcp_f32 v210, v210
  v_rcp_f32 v211, v211
  s_setprio 2
  v_pk_mul_f32 v[196:197], v[196:197], v[100:101]
  v_pk_mul_f32 v[198:199], v[198:199], v[102:103]
  v_pk_mul_f32 v[200:201], v[200:201], v[104:105]
  v_pk_mul_f32 v[202:203], v[202:203], v[106:107]
  v_pk_mul_f32 v[204:205], v[204:205], v[108:109]
  v_pk_mul_f32 v[206:207], v[206:207], v[110:111]
  v_pk_mul_f32 v[208:209], v[208:209], v[112:113]
  v_pk_mul_f32 v[210:211], v[210:211], v[114:115]
  v_exp_f32 v100, v116
  v_exp_f32 v101, v117
  v_exp_f32 v102, v118
  v_exp_f32 v103, v119
  v_exp_f32 v104, v120
  v_exp_f32 v105, v121
  v_exp_f32 v106, v122
  v_exp_f32 v107, v123
  v_exp_f32 v108, v124
  v_exp_f32 v109, v125
  v_exp_f32 v110, v126
  v_exp_f32 v111, v127
  v_exp_f32 v112, v128
  v_exp_f32 v113, v129
  v_exp_f32 v114, v130
  v_exp_f32 v115, v131
  s_nop 1
  v_mfma_f32_32x32x8_bf16 v[100:115], v[54:55], v[54:55], v[100:115]
  v_cvt_pk_bf16_f32 v196, v196, v197
  v_cvt_pk_bf16_f32 v197, v198, v199
  v_cvt_pk_bf16_f32 v198, v200, v201
  v_cvt_pk_bf16_f32 v199, v202, v203
  v_cvt_pk_bf16_f32 v200, v204, v205
  s_waitcnt lgkmcnt(0)
  v_mfma_f32_32x32x16_bf16 v[132:147], v[196:199], v[188:191], v[132:147]
  v_cvt_pk_bf16_f32 v201, v206, v207
  v_cvt_pk_bf16_f32 v202, v208, v209
  v_cvt_pk_bf16_f32 v203, v210, v211
  s_nop 1
  v_mfma_f32_32x32x16_bf16 v[132:147], v[200:203], v[192:195], v[132:147]
  s_nop 0
  v_rcp_f32 v100, v100
  v_rcp_f32 v101, v101
  v_rcp_f32 v102, v102
  v_rcp_f32 v103, v103
  v_rcp_f32 v104, v104
  v_rcp_f32 v105, v105
  v_rcp_f32 v106, v106
  v_rcp_f32 v107, v107
  v_rcp_f32 v108, v108
  v_rcp_f32 v109, v109
  v_rcp_f32 v110, v110
  v_rcp_f32 v111, v111
  v_rcp_f32 v112, v112
  v_rcp_f32 v113, v113
  v_rcp_f32 v114, v114
  v_rcp_f32 v115, v115
  v_pk_mul_f32 v[100:101], v[100:101], v[116:117]
  v_pk_mul_f32 v[102:103], v[102:103], v[118:119]
  v_pk_mul_f32 v[104:105], v[104:105], v[120:121]
  v_pk_mul_f32 v[106:107], v[106:107], v[122:123]
  v_pk_mul_f32 v[108:109], v[108:109], v[124:125]
  v_pk_mul_f32 v[110:111], v[110:111], v[126:127]
  v_pk_mul_f32 v[112:113], v[112:113], v[128:129]
  v_pk_mul_f32 v[114:115], v[114:115], v[130:131]
  v_cvt_pk_bf16_f32 v100, v100, v101
  v_cvt_pk_bf16_f32 v101, v102, v103
  v_cvt_pk_bf16_f32 v102, v104, v105
  v_cvt_pk_bf16_f32 v103, v106, v107
  v_cvt_pk_bf16_f32 v104, v108, v109
  v_cvt_pk_bf16_f32 v105, v110, v111
  v_mfma_f32_32x32x16_bf16 v[148:163], v[100:103], v[188:191], v[148:163]
  v_cvt_pk_bf16_f32 v106, v112, v113
  v_cvt_pk_bf16_f32 v107, v114, v115
  s_nop 1
  v_mfma_f32_32x32x16_bf16 v[148:163], v[104:107], v[192:195], v[148:163]
  s_branch K2_exit1
K2_tfulB1:
  s_mov_b32 s62, 1
  s_branch K2_flushB1
K2_preB1:
  s_setprio 3
  s_waitcnt vmcnt(0)
  ds_read_b128 v[164:167], v64
  ds_read_b128 v[168:171], v65
  ds_read_b128 v[172:175], v66
  ds_read_b128 v[176:179], v67
  ds_read_b64 v[214:215], v252 offset:512
  s_and_b64 exec, s[76:77], s[64:65]
  ds_write_b64 v236, v[224:225]
  s_mov_b64 exec, -1
  ds_read_b64_tr_b16 v[188:189], v244 offset:0
  ds_read_b64_tr_b16 v[190:191], v244 offset:512
  ds_read_b64_tr_b16 v[192:193], v244 offset:1024
  ds_read_b64_tr_b16 v[194:195], v244 offset:1536
  ds_write_b64 v236, v[52:53]
  s_and_b32 s48, s42, 0xffffffe0
  s_sub_u32 s49, 0, s48
  v_lshl_add_u32 v242, s48, 4, v246
  ds_read_b64 v[180:181], v242
  ds_read_b64 v[184:185], v242 offset:256
  s_waitcnt lgkmcnt(8)
  v_add3_u32 v241, v214, v247, s49
  ds_read_b64 v[212:213], v241 offset:32
  s_mov_b64 exec, s[74:75]
  ds_read_b64 v[214:215], v241 offset:0
  ds_read_b64 v[182:183], v242 offset:512
  ds_read_b64 v[186:187], v242 offset:768
  s_mov_b64 exec, -1
  s_cmp_ge_u32 s45, s50
  s_cbranch_scc1 K2_pfulB1
K2_backPB1:
  s_setprio 0
  v_mfma_f32_32x32x16_bf16 v[68:83], v[164:167], v[4:7], 0
  v_rcp_f32 v196, v196
  v_rcp_f32 v197, v197
  v_rcp_f32 v198, v198
  v_rcp_f32 v199, v199
  v_mfma_f32_32x32x16_bf16 v[84:99], v[164:167], v[8:11], 0
  v_rcp_f32 v200, v200
  v_rcp_f32 v201, v201
  v_rcp_f32 v202, v202
  v_rcp_f32 v203, v203
  v_mfma_f32_32x32x16_bf16 v[68:83], v[168:171], v[12:15], v[68:83]
  v_rcp_f32 v204, v204
  v_rcp_f32 v205, v205
  v_rcp_f32 v206, v206
  v_rcp_f32 v207, v207
  v_rcp_f32 v208, v208
  v_rcp_f32 v209, v209
  v_rcp_f32 v210, v210
  v_rcp_f32 v211, v211
  s_setprio 2
  v_pk_mul_f32 v[196:197], v[196:197], v[100:101]
  v_pk_mul_f32 v[198:199], v[198:199], v[102:103]
  v_pk_mul_f32 v[200:201], v[200:201], v[104:105]
  v_pk_mul_f32 v[202:203], v[202:203], v[106:107]
  v_pk_mul_f32 v[204:205], v[204:205], v[108:109]
  v_pk_mul_f32 v[206:207], v[206:207], v[110:111]
  v_pk_mul_f32 v[208:209], v[208:209], v[112:113]
  v_pk_mul_f32 v[210:211], v[210:211], v[114:115]
  v_mfma_f32_32x32x16_bf16 v[84:99], v[168:171], v[16:19], v[84:99]
  v_exp_f32 v100, v116
  v_exp_f32 v101, v117
  v_exp_f32 v102, v118
  v_mfma_f32_32x32x16_bf16 v[68:83], v[172:175], v[20:23], v[68:83]
  v_exp_f32 v103, v119
  v_exp_f32 v104, v120
  v_exp_f32 v105, v121
  v_mfma_f32_32x32x16_bf16 v[84:99], v[172:175], v[24:27], v[84:99]
  v_exp_f32 v106, v122
  v_exp_f32 v107, v123
  v_exp_f32 v108, v124
  v_mfma_f32_32x32x16_bf16 v[68:83], v[176:179], v[28:31], v[68:83]
  v_exp_f32 v109, v125
  v_exp_f32 v110, v126
  v_exp_f32 v111, v127
  v_exp_f32 v112, v128
  v_exp_f32 v113, v129
  v_exp_f32 v114, v130
  v_exp_f32 v115, v131
  s_nop 1
  v_mfma_f32_32x32x8_bf16 v[100:115], v[54:55], v[54:55], v[100:115]
  v_cvt_pk_bf16_f32 v196, v196, v197
  v_cvt_pk_bf16_f32 v197, v198, v199
  v_cvt_pk_bf16_f32 v198, v200, v201
  v_cvt_pk_bf16_f32 v199, v202, v203
  v_cvt_pk_bf16_f32 v200, v204, v205
  s_waitcnt lgkmcnt(0)
  v_mfma_f32_32x32x16_bf16 v[132:147], v[196:199], v[188:191], v[132:147]
  v_cvt_pk_bf16_f32 v201, v206, v207
  v_cvt_pk_bf16_f32 v202, v208, v209
  v_cvt_pk_bf16_f32 v203, v210, v211
  s_nop 1
  v_mfma_f32_32x32x16_bf16 v[132:147], v[200:203], v[192:195], v[132:147]
  s_nop 0
  v_rcp_f32 v100, v100
  v_rcp_f32 v101, v101
  v_rcp_f32 v102, v102
  v_rcp_f32 v103, v103
  v_rcp_f32 v104, v104
  v_rcp_f32 v105, v105
  v_mfma_f32_32x32x16_bf16 v[68:83], v[212:215], v[180:183], v[68:83]
  v_rcp_f32 v106, v106
  v_rcp_f32 v107, v107
  v_rcp_f32 v108, v108
  v_rcp_f32 v109, v109
  v_mfma_f32_32x32x16_bf16 v[84:99], v[176:179], v[32:35], v[84:99]
  v_rcp_f32 v110, v110
  v_rcp_f32 v111, v111
  v_rcp_f32 v112, v112
  v_rcp_f32 v113, v113
  v_rcp_f32 v114, v114
  v_rcp_f32 v115, v115
  v_pk_mul_f32 v[100:101], v[100:101], v[116:117]
  v_pk_mul_f32 v[102:103], v[102:103], v[118:119]
  v_pk_mul_f32 v[104:105], v[104:105], v[120:121]
  v_pk_mul_f32 v[106:107], v[106:107], v[122:123]
  v_pk_mul_f32 v[108:109], v[108:109], v[124:125]
  v_pk_mul_f32 v[110:111], v[110:111], v[126:127]
  v_pk_mul_f32 v[112:113], v[112:113], v[128:129]
  v_pk_mul_f32 v[114:115], v[114:115], v[130:131]
  v_exp_f32 v196, v68
  v_exp_f32 v197, v69
  v_exp_f32 v198, v70
  v_exp_f32 v199, v71
  v_mfma_f32_32x32x16_bf16 v[84:99], v[212:215], v[184:187], v[84:99]
  v_exp_f32 v200, v72
  v_exp_f32 v201, v73
  v_exp_f32 v202, v74
  v_exp_f32 v203, v75
  v_exp_f32 v204, v76
  v_exp_f32 v205, v77
  v_exp_f32 v206, v78
  v_exp_f32 v207, v79
  v_exp_f32 v208, v80
  v_exp_f32 v209, v81
  v_exp_f32 v210, v82
  v_exp_f32 v211, v83
  s_nop 1
  v_mfma_f32_32x32x8_bf16 v[196:211], v[54:55], v[54:55], v[196:211]
  v_cvt_pk_bf16_f32 v100, v100, v101
  v_cvt_pk_bf16_f32 v101, v102, v103
  v_cvt_pk_bf16_f32 v102, v104, v105
  v_cvt_pk_bf16_f32 v103, v106, v107
  v_cvt_pk_bf16_f32 v104, v108, v109
  v_cvt_pk_bf16_f32 v105, v110, v111
  v_mfma_f32_32x32x16_bf16 v[148:163], v[100:103], v[188:191], v[148:163]
  v_cvt_pk_bf16_f32 v106, v112, v113
  v_cvt_pk_bf16_f32 v107, v114, v115
  s_nop 1
  v_mfma_f32_32x32x16_bf16 v[148:163], v[104:107], v[192:195], v[148:163]
  s_branch K2_tailB2
K2_pfulB1:
  s_mov_b32 s62, 2
  s_branch K2_flushB1
K2_tailB2:
  s_setprio 0
  s_and_b64 exec, s[74:75], s[66:67]
  ds_write_b64 v237, v[226:227]
  s_mov_b64 exec, -1
  ds_read_b64_tr_b16 v[188:189], v244 offset:0
  ds_read_b64_tr_b16 v[190:191], v244 offset:512
  ds_read_b64_tr_b16 v[192:193], v244 offset:1024
  ds_read_b64_tr_b16 v[194:195], v244 offset:1536
  ds_write_b64 v237, v[52:53]
  s_cmp_ge_u32 s46, s50
  s_cbranch_scc1 K2_tfulB2
K2_backTB2:
  s_nop 3
  v_rcp_f32 v196, v196
  v_rcp_f32 v197, v197
  v_rcp_f32 v198, v198
  v_rcp_f32 v199, v199
  v_rcp_f32 v200, v200
  v_rcp_f32 v201, v201
  v_rcp_f32 v202, v202
  v_rcp_f32 v203, v203
  v_rcp_f32 v204, v204
  v_rcp_f32 v205, v205
  v_rcp_f32 v206, v206
  v_rcp_f32 v207, v207
  v_rcp_f32 v208, v208
  v_rcp_f32 v209, v209
  v_rcp_f32 v210, v210
  v_rcp_f32 v211, v211
  s_setprio 2
  v_pk_mul_f32 v[196:197], v[196:197], v[68:69]
  v_pk_mul_f32 v[198:199], v[198:199], v[70:71]
  v_pk_mul_f32 v[200:201], v[200:201], v[72:73]
  v_pk_mul_f32 v[202:203], v[202:203], v[74:75]
  v_pk_mul_f32 v[204:205], v[204:205], v[76:77]
  v_pk_mul_f32 v[206:207], v[206:207], v[78:79]
  v_pk_mul_f32 v[208:209], v[208:209], v[80:81]
  v_pk_mul_f32 v[210:211], v[210:211], v[82:83]
  v_exp_f32 v68, v84
  v_exp_f32 v69, v85
  v_exp_f32 v70, v86
  v_exp_f32 v71, v87
  v_exp_f32 v72, v88
  v_exp_f32 v73, v89
  v_exp_f32 v74, v90
  v_exp_f32 v75, v91
  v_exp_f32 v76, v92
  v_exp_f32 v77, v93
  v_exp_f32 v78, v94
  v_exp_f32 v79, v95
  v_exp_f32 v80, v96
  v_exp_f32 v81, v97
  v_exp_f32 v82, v98
  v_exp_f32 v83, v99
  s_nop 1
  v_mfma_f32_32x32x8_bf16 v[68:83], v[54:55], v[54:55], v[68:83]
  v_cvt_pk_bf16_f32 v196, v196, v197
  v_cvt_pk_bf16_f32 v197, v198, v199
  v_cvt_pk_bf16_f32 v198, v200, v201
  v_cvt_pk_bf16_f32 v199, v202, v203
  v_cvt_pk_bf16_f32 v200, v204, v205
  s_waitcnt lgkmcnt(0)
  v_mfma_f32_32x32x16_bf16 v[132:147], v[196:199], v[188:191], v[132:147]
  v_cvt_pk_bf16_f32 v201, v206, v207
  v_cvt_pk_bf16_f32 v202, v208, v209
  v_cvt_pk_bf16_f32 v203, v210, v211
  s_nop 1
  v_mfma_f32_32x32x16_bf16 v[132:147], v[200:203], v[192:195], v[132:147]
  s_nop 0
  v_rcp_f32 v68, v68
  v_rcp_f32 v69, v69
  v_rcp_f32 v70, v70
  v_rcp_f32 v71, v71
  v_rcp_f32 v72, v72
  v_rcp_f32 v73, v73
  v_rcp_f32 v74, v74
  v_rcp_f32 v75, v75
  v_rcp_f32 v76, v76
  v_rcp_f32 v77, v77
  v_rcp_f32 v78, v78
  v_rcp_f32 v79, v79
  v_rcp_f32 v80, v80
  v_rcp_f32 v81, v81
  v_rcp_f32 v82, v82
  v_rcp_f32 v83, v83
  v_pk_mul_f32 v[68:69], v[68:69], v[84:85]
  v_pk_mul_f32 v[70:71], v[70:71], v[86:87]
  v_pk_mul_f32 v[72:73], v[72:73], v[88:89]
  v_pk_mul_f32 v[74:75], v[74:75], v[90:91]
  v_pk_mul_f32 v[76:77], v[76:77], v[92:93]
  v_pk_mul_f32 v[78:79], v[78:79], v[94:95]
  v_pk_mul_f32 v[80:81], v[80:81], v[96:97]
  v_pk_mul_f32 v[82:83], v[82:83], v[98:99]
  v_cvt_pk_bf16_f32 v68, v68, v69
  v_cvt_pk_bf16_f32 v69, v70, v71
  v_cvt_pk_bf16_f32 v70, v72, v73
  v_cvt_pk_bf16_f32 v71, v74, v75
  v_cvt_pk_bf16_f32 v72, v76, v77
  v_cvt_pk_bf16_f32 v73, v78, v79
  v_mfma_f32_32x32x16_bf16 v[148:163], v[68:71], v[188:191], v[148:163]
  v_cvt_pk_bf16_f32 v74, v80, v81
  v_cvt_pk_bf16_f32 v75, v82, v83
  s_nop 1
  v_mfma_f32_32x32x16_bf16 v[148:163], v[72:75], v[192:195], v[148:163]
  s_branch K2_exit2
K2_tfulB2:
  s_mov_b32 s62, 1
  s_branch K2_flushB2
K2_preB2:
  s_setprio 3
  s_waitcnt vmcnt(2)
  ds_read_b128 v[164:167], v64
  ds_read_b128 v[168:171], v65
  ds_read_b128 v[172:175], v66
  ds_read_b128 v[176:179], v67
  ds_read_b64 v[214:215], v252 offset:768
  s_and_b64 exec, s[74:75], s[66:67]
  ds_write_b64 v237, v[226:227]
  s_mov_b64 exec, -1
  ds_read_b64_tr_b16 v[188:189], v244 offset:0
  ds_read_b64_tr_b16 v[190:191], v244 offset:512
  ds_read_b64_tr_b16 v[192:193], v244 offset:1024
  ds_read_b64_tr_b16 v[194:195], v244 offset:1536
  ds_write_b64 v237, v[52:53]
  s_and_b32 s48, s43, 0xffffffe0
  s_sub_u32 s49, 0, s48
  v_lshl_add_u32 v242, s48, 4, v246
  ds_read_b64 v[180:181], v242
  ds_read_b64 v[184:185], v242 offset:256
  s_waitcnt lgkmcnt(8)
  v_add3_u32 v241, v214, v247, s49
  ds_read_b64 v[212:213], v241 offset:32
  s_mov_b64 exec, s[74:75]
  ds_read_b64 v[214:215], v241 offset:0
  ds_read_b64 v[182:183], v242 offset:512
  ds_read_b64 v[186:187], v242 offset:768
  s_mov_b64 exec, -1
  s_cmp_ge_u32 s46, s50
  s_cbranch_scc1 K2_pfulB2
K2_backPB2:
  s_setprio 0
  v_mfma_f32_32x32x16_bf16 v[100:115], v[164:167], v[4:7], 0
  v_rcp_f32 v196, v196
  v_rcp_f32 v197, v197
  v_rcp_f32 v198, v198
  v_rcp_f32 v199, v199
  v_mfma_f32_32x32x16_bf16 v[116:131], v[164:167], v[8:11], 0
  v_rcp_f32 v200, v200
  v_rcp_f32 v201, v201
  v_rcp_f32 v202, v202
  v_rcp_f32 v203, v203
  v_mfma_f32_32x32x16_bf16 v[100:115], v[168:171], v[12:15], v[100:115]
  v_rcp_f32 v204, v204
  v_rcp_f32 v205, v205
  v_rcp_f32 v206, v206
  v_rcp_f32 v207, v207
  v_rcp_f32 v208, v208
  v_rcp_f32 v209, v209
  v_rcp_f32 v210, v210
  v_rcp_f32 v211, v211
  s_setprio 2
  v_pk_mul_f32 v[196:197], v[196:197], v[68:69]
  v_pk_mul_f32 v[198:199], v[198:199], v[70:71]
  v_pk_mul_f32 v[200:201], v[200:201], v[72:73]
  v_pk_mul_f32 v[202:203], v[202:203], v[74:75]
  v_pk_mul_f32 v[204:205], v[204:205], v[76:77]
  v_pk_mul_f32 v[206:207], v[206:207], v[78:79]
  v_pk_mul_f32 v[208:209], v[208:209], v[80:81]
  v_pk_mul_f32 v[210:211], v[210:211], v[82:83]
  v_mfma_f32_32x32x16_bf16 v[116:131], v[168:171], v[16:19], v[116:131]
  v_exp_f32 v68, v84
  v_exp_f32 v69, v85
  v_exp_f32 v70, v86
  v_mfma_f32_32x32x16_bf16 v[100:115], v[172:175], v[20:23], v[100:115]
  v_exp_f32 v71, v87
  v_exp_f32 v72, v88
  v_exp_f32 v73, v89
  v_mfma_f32_32x32x16_bf16 v[116:131], v[172:175], v[24:27], v[116:131]
  v_exp_f32 v74, v90
  v_exp_f32 v75, v91
  v_exp_f32 v76, v92
  v_mfma_f32_32x32x16_bf16 v[100:115], v[176:179], v[28:31], v[100:115]
  v_exp_f32 v77, v93
  v_exp_f32 v78, v94
  v_exp_f32 v79, v95
  v_exp_f32 v80, v96
  v_exp_f32 v81, v97
  v_exp_f32 v82, v98
  v_exp_f32 v83, v99
  s_nop 1
  v_mfma_f32_32x32x8_bf16 v[68:83], v[54:55], v[54:55], v[68:83]
  v_cvt_pk_bf16_f32 v196, v196, v197
  v_cvt_pk_bf16_f32 v197, v198, v199
  v_cvt_pk_bf16_f32 v198, v200, v201
  v_cvt_pk_bf16_f32 v199, v202, v203
  v_cvt_pk_bf16_f32 v200, v204, v205
  s_waitcnt lgkmcnt(0)
  v_mfma_f32_32x32x16_bf16 v[132:147], v[196:199], v[188:191], v[132:147]
  v_cvt_pk_bf16_f32 v201, v206, v207
  v_cvt_pk_bf16_f32 v202, v208, v209
  v_cvt_pk_bf16_f32 v203, v210, v211
  s_nop 1
  v_mfma_f32_32x32x16_bf16 v[132:147], v[200:203], v[192:195], v[132:147]
  s_nop 0
  v_rcp_f32 v68, v68
  v_rcp_f32 v69, v69
  v_rcp_f32 v70, v70
  v_rcp_f32 v71, v71
  v_rcp_f32 v72, v72
  v_rcp_f32 v73, v73
  v_mfma_f32_32x32x16_bf16 v[100:115], v[212:215], v[180:183], v[100:115]
  v_rcp_f32 v74, v74
  v_rcp_f32 v75, v75
  v_rcp_f32 v76, v76
  v_rcp_f32 v77, v77
  v_mfma_f32_32x32x16_bf16 v[116:131], v[176:179], v[32:35], v[116:131]
  v_rcp_f32 v78, v78
  v_rcp_f32 v79, v79
  v_rcp_f32 v80, v80
  v_rcp_f32 v81, v81
  v_rcp_f32 v82, v82
  v_rcp_f32 v83, v83
  v_pk_mul_f32 v[68:69], v[68:69], v[84:85]
  v_pk_mul_f32 v[70:71], v[70:71], v[86:87]
  v_pk_mul_f32 v[72:73], v[72:73], v[88:89]
  v_pk_mul_f32 v[74:75], v[74:75], v[90:91]
  v_pk_mul_f32 v[76:77], v[76:77], v[92:93]
  v_pk_mul_f32 v[78:79], v[78:79], v[94:95]
  v_pk_mul_f32 v[80:81], v[80:81], v[96:97]
  v_pk_mul_f32 v[82:83], v[82:83], v[98:99]
  v_exp_f32 v196, v100
  v_exp_f32 v197, v101
  v_exp_f32 v198, v102
  v_exp_f32 v199, v103
  v_mfma_f32_32x32x16_bf16 v[116:131], v[212:215], v[184:187], v[116:131]
  v_exp_f32 v200, v104
  v_exp_f32 v201, v105
  v_exp_f32 v202, v106
  v_exp_f32 v203, v107
  v_exp_f32 v204, v108
  v_exp_f32 v205, v109
  v_exp_f32 v206, v110
  v_exp_f32 v207, v111
  v_exp_f32 v208, v112
  v_exp_f32 v209, v113
  v_exp_f32 v210, v114
  v_exp_f32 v211, v115
  s_nop 1
  v_mfma_f32_32x32x8_bf16 v[196:211], v[54:55], v[54:55], v[196:211]
  v_cvt_pk_bf16_f32 v68, v68, v69
  v_cvt_pk_bf16_f32 v69, v70, v71
  v_cvt_pk_bf16_f32 v70, v72, v73
  v_cvt_pk_bf16_f32 v71, v74, v75
  v_cvt_pk_bf16_f32 v72, v76, v77
  v_cvt_pk_bf16_f32 v73, v78, v79
  v_mfma_f32_32x32x16_bf16 v[148:163], v[68:71], v[188:191], v[148:163]
  v_cvt_pk_bf16_f32 v74, v80, v81
  v_cvt_pk_bf16_f32 v75, v82, v83
  s_nop 1
  v_mfma_f32_32x32x16_bf16 v[148:163], v[72:75], v[192:195], v[148:163]
  s_branch K2_tailB3
K2_pfulB2:
  s_mov_b32 s62, 2
  s_branch K2_flushB2
K2_tailB3:
  s_setprio 0
  s_and_b64 exec, s[76:77], s[66:67]
  ds_write_b64 v237, v[226:227]
  s_mov_b64 exec, -1
  ds_read_b64_tr_b16 v[188:189], v244 offset:0
  ds_read_b64_tr_b16 v[190:191], v244 offset:512
  ds_read_b64_tr_b16 v[192:193], v244 offset:1024
  ds_read_b64_tr_b16 v[194:195], v244 offset:1536
  ds_write_b64 v237, v[52:53]
  s_cmp_ge_u32 s47, s50
  s_cbranch_scc1 K2_tfulB3
K2_backTB3:
  s_nop 3
  v_rcp_f32 v196, v196
  v_rcp_f32 v197, v197
  v_rcp_f32 v198, v198
  v_rcp_f32 v199, v199
  v_rcp_f32 v200, v200
  v_rcp_f32 v201, v201
  v_rcp_f32 v202, v202
  v_rcp_f32 v203, v203
  v_rcp_f32 v204, v204
  v_rcp_f32 v205, v205
  v_rcp_f32 v206, v206
  v_rcp_f32 v207, v207
  v_rcp_f32 v208, v208
  v_rcp_f32 v209, v209
  v_rcp_f32 v210, v210
  v_rcp_f32 v211, v211
  s_setprio 2
  v_pk_mul_f32 v[196:197], v[196:197], v[100:101]
  v_pk_mul_f32 v[198:199], v[198:199], v[102:103]
  v_pk_mul_f32 v[200:201], v[200:201], v[104:105]
  v_pk_mul_f32 v[202:203], v[202:203], v[106:107]
  v_pk_mul_f32 v[204:205], v[204:205], v[108:109]
  v_pk_mul_f32 v[206:207], v[206:207], v[110:111]
  v_pk_mul_f32 v[208:209], v[208:209], v[112:113]
  v_pk_mul_f32 v[210:211], v[210:211], v[114:115]
  v_exp_f32 v100, v116
  v_exp_f32 v101, v117
  v_exp_f32 v102, v118
  v_exp_f32 v103, v119
  v_exp_f32 v104, v120
  v_exp_f32 v105, v121
  v_exp_f32 v106, v122
  v_exp_f32 v107, v123
  v_exp_f32 v108, v124
  v_exp_f32 v109, v125
  v_exp_f32 v110, v126
  v_exp_f32 v111, v127
  v_exp_f32 v112, v128
  v_exp_f32 v113, v129
  v_exp_f32 v114, v130
  v_exp_f32 v115, v131
  s_nop 1
  v_mfma_f32_32x32x8_bf16 v[100:115], v[54:55], v[54:55], v[100:115]
  v_cvt_pk_bf16_f32 v196, v196, v197
  v_cvt_pk_bf16_f32 v197, v198, v199
  v_cvt_pk_bf16_f32 v198, v200, v201
  v_cvt_pk_bf16_f32 v199, v202, v203
  v_cvt_pk_bf16_f32 v200, v204, v205
  s_waitcnt lgkmcnt(0)
  v_mfma_f32_32x32x16_bf16 v[132:147], v[196:199], v[188:191], v[132:147]
  v_cvt_pk_bf16_f32 v201, v206, v207
  v_cvt_pk_bf16_f32 v202, v208, v209
  v_cvt_pk_bf16_f32 v203, v210, v211
  s_nop 1
  v_mfma_f32_32x32x16_bf16 v[132:147], v[200:203], v[192:195], v[132:147]
  s_nop 0
  v_rcp_f32 v100, v100
  v_rcp_f32 v101, v101
  v_rcp_f32 v102, v102
  v_rcp_f32 v103, v103
  v_rcp_f32 v104, v104
  v_rcp_f32 v105, v105
  v_rcp_f32 v106, v106
  v_rcp_f32 v107, v107
  v_rcp_f32 v108, v108
  v_rcp_f32 v109, v109
  v_rcp_f32 v110, v110
  v_rcp_f32 v111, v111
  v_rcp_f32 v112, v112
  v_rcp_f32 v113, v113
  v_rcp_f32 v114, v114
  v_rcp_f32 v115, v115
  v_pk_mul_f32 v[100:101], v[100:101], v[116:117]
  v_pk_mul_f32 v[102:103], v[102:103], v[118:119]
  v_pk_mul_f32 v[104:105], v[104:105], v[120:121]
  v_pk_mul_f32 v[106:107], v[106:107], v[122:123]
  v_pk_mul_f32 v[108:109], v[108:109], v[124:125]
  v_pk_mul_f32 v[110:111], v[110:111], v[126:127]
  v_pk_mul_f32 v[112:113], v[112:113], v[128:129]
  v_pk_mul_f32 v[114:115], v[114:115], v[130:131]
  v_cvt_pk_bf16_f32 v100, v100, v101
  v_cvt_pk_bf16_f32 v101, v102, v103
  v_cvt_pk_bf16_f32 v102, v104, v105
  v_cvt_pk_bf16_f32 v103, v106, v107
  v_cvt_pk_bf16_f32 v104, v108, v109
  v_cvt_pk_bf16_f32 v105, v110, v111
  v_mfma_f32_32x32x16_bf16 v[148:163], v[100:103], v[188:191], v[148:163]
  v_cvt_pk_bf16_f32 v106, v112, v113
  v_cvt_pk_bf16_f32 v107, v114, v115
  s_nop 1
  v_mfma_f32_32x32x16_bf16 v[148:163], v[104:107], v[192:195], v[148:163]
  s_branch K2_exit3
K2_tfulB3:
  s_mov_b32 s62, 1
  s_branch K2_flushB3
K2_preB3:
  s_setprio 3
  s_waitcnt vmcnt(0)
  ds_read_b128 v[164:167], v64
  ds_read_b128 v[168:171], v65
  ds_read_b128 v[172:175], v66
  ds_read_b128 v[176:179], v67
  ds_read_b64 v[214:215], v252 offset:0
  s_and_b64 exec, s[76:77], s[66:67]
  ds_write_b64 v237, v[226:227]
  s_mov_b64 exec, -1
  ds_read_b64_tr_b16 v[188:189], v244 offset:0
  ds_read_b64_tr_b16 v[190:191], v244 offset:512
  ds_read_b64_tr_b16 v[192:193], v244 offset:1024
  ds_read_b64_tr_b16 v[194:195], v244 offset:1536
  ds_write_b64 v237, v[52:53]
  s_and_b32 s48, s40, 0xffffffe0
  s_sub_u32 s49, 0, s48
  v_lshl_add_u32 v242, s48, 4, v246
  ds_read_b64 v[180:181], v242
  ds_read_b64 v[184:185], v242 offset:256
  s_waitcnt lgkmcnt(8)
  v_add3_u32 v241, v214, v247, s49
  ds_read_b64 v[212:213], v241 offset:32
  s_mov_b64 exec, s[74:75]
  ds_read_b64 v[214:215], v241 offset:0
  ds_read_b64 v[182:183], v242 offset:512
  ds_read_b64 v[186:187], v242 offset:768
  s_mov_b64 exec, -1
  s_cmp_ge_u32 s47, s50
  s_cbranch_scc1 K2_pfulB3
K2_backPB3:
  s_setprio 0
  v_mfma_f32_32x32x16_bf16 v[68:83], v[164:167], v[4:7], 0
  v_rcp_f32 v196, v196
  v_rcp_f32 v197, v197
  v_rcp_f32 v198, v198
  v_rcp_f32 v199, v199
  v_mfma_f32_32x32x16_bf16 v[84:99], v[164:167], v[8:11], 0
  v_rcp_f32 v200, v200
  v_rcp_f32 v201, v201
  v_rcp_f32 v202, v202
  v_rcp_f32 v203, v203
  v_mfma_f32_32x32x16_bf16 v[68:83], v[168:171], v[12:15], v[68:83]
  v_rcp_f32 v204, v204
  v_rcp_f32 v205, v205
  v_rcp_f32 v206, v206
  v_rcp_f32 v207, v207
  v_rcp_f32 v208, v208
  v_rcp_f32 v209, v209
  v_rcp_f32 v210, v210
  v_rcp_f32 v211, v211
  s_setprio 2
  v_pk_mul_f32 v[196:197], v[196:197], v[100:101]
  v_pk_mul_f32 v[198:199], v[198:199], v[102:103]
  v_pk_mul_f32 v[200:201], v[200:201], v[104:105]
  v_pk_mul_f32 v[202:203], v[202:203], v[106:107]
  v_pk_mul_f32 v[204:205], v[204:205], v[108:109]
  v_pk_mul_f32 v[206:207], v[206:207], v[110:111]
  v_pk_mul_f32 v[208:209], v[208:209], v[112:113]
  v_pk_mul_f32 v[210:211], v[210:211], v[114:115]
  v_mfma_f32_32x32x16_bf16 v[84:99], v[168:171], v[16:19], v[84:99]
  v_exp_f32 v100, v116
  v_exp_f32 v101, v117
  v_exp_f32 v102, v118
  v_mfma_f32_32x32x16_bf16 v[68:83], v[172:175], v[20:23], v[68:83]
  v_exp_f32 v103, v119
  v_exp_f32 v104, v120
  v_exp_f32 v105, v121
  v_mfma_f32_32x32x16_bf16 v[84:99], v[172:175], v[24:27], v[84:99]
  v_exp_f32 v106, v122
  v_exp_f32 v107, v123
  v_exp_f32 v108, v124
  v_mfma_f32_32x32x16_bf16 v[68:83], v[176:179], v[28:31], v[68:83]
  v_exp_f32 v109, v125
  v_exp_f32 v110, v126
  v_exp_f32 v111, v127
  v_exp_f32 v112, v128
  v_exp_f32 v113, v129
  v_exp_f32 v114, v130
  v_exp_f32 v115, v131
  s_nop 1
  v_mfma_f32_32x32x8_bf16 v[100:115], v[54:55], v[54:55], v[100:115]
  v_cvt_pk_bf16_f32 v196, v196, v197
  v_cvt_pk_bf16_f32 v197, v198, v199
  v_cvt_pk_bf16_f32 v198, v200, v201
  v_cvt_pk_bf16_f32 v199, v202, v203
  v_cvt_pk_bf16_f32 v200, v204, v205
  s_waitcnt lgkmcnt(0)
  v_mfma_f32_32x32x16_bf16 v[132:147], v[196:199], v[188:191], v[132:147]
  v_cvt_pk_bf16_f32 v201, v206, v207
  v_cvt_pk_bf16_f32 v202, v208, v209
  v_cvt_pk_bf16_f32 v203, v210, v211
  s_nop 1
  v_mfma_f32_32x32x16_bf16 v[132:147], v[200:203], v[192:195], v[132:147]
  s_nop 0
  v_rcp_f32 v100, v100
  v_rcp_f32 v101, v101
  v_rcp_f32 v102, v102
  v_rcp_f32 v103, v103
  v_rcp_f32 v104, v104
  v_rcp_f32 v105, v105
  v_mfma_f32_32x32x16_bf16 v[68:83], v[212:215], v[180:183], v[68:83]
  v_rcp_f32 v106, v106
  v_rcp_f32 v107, v107
  v_rcp_f32 v108, v108
  v_rcp_f32 v109, v109
  v_mfma_f32_32x32x16_bf16 v[84:99], v[176:179], v[32:35], v[84:99]
  v_rcp_f32 v110, v110
  v_rcp_f32 v111, v111
  v_rcp_f32 v112, v112
  v_rcp_f32 v113, v113
  v_rcp_f32 v114, v114
  v_rcp_f32 v115, v115
  v_pk_mul_f32 v[100:101], v[100:101], v[116:117]
  v_pk_mul_f32 v[102:103], v[102:103], v[118:119]
  v_pk_mul_f32 v[104:105], v[104:105], v[120:121]
  v_pk_mul_f32 v[106:107], v[106:107], v[122:123]
  v_pk_mul_f32 v[108:109], v[108:109], v[124:125]
  v_pk_mul_f32 v[110:111], v[110:111], v[126:127]
  v_pk_mul_f32 v[112:113], v[112:113], v[128:129]
  v_pk_mul_f32 v[114:115], v[114:115], v[130:131]
  v_exp_f32 v196, v68
  v_exp_f32 v197, v69
  v_exp_f32 v198, v70
  v_exp_f32 v199, v71
  v_mfma_f32_32x32x16_bf16 v[84:99], v[212:215], v[184:187], v[84:99]
  v_exp_f32 v200, v72
  v_exp_f32 v201, v73
  v_exp_f32 v202, v74
  v_exp_f32 v203, v75
  v_exp_f32 v204, v76
  v_exp_f32 v205, v77
  v_exp_f32 v206, v78
  v_exp_f32 v207, v79
  v_exp_f32 v208, v80
  v_exp_f32 v209, v81
  v_exp_f32 v210, v82
  v_exp_f32 v211, v83
  s_nop 1
  v_mfma_f32_32x32x8_bf16 v[196:211], v[54:55], v[54:55], v[196:211]
  v_cvt_pk_bf16_f32 v100, v100, v101
  v_cvt_pk_bf16_f32 v101, v102, v103
  v_cvt_pk_bf16_f32 v102, v104, v105
  v_cvt_pk_bf16_f32 v103, v106, v107
  v_cvt_pk_bf16_f32 v104, v108, v109
  v_cvt_pk_bf16_f32 v105, v110, v111
  v_mfma_f32_32x32x16_bf16 v[148:163], v[100:103], v[188:191], v[148:163]
  v_cvt_pk_bf16_f32 v106, v112, v113
  v_cvt_pk_bf16_f32 v107, v114, v115
  s_nop 1
  v_mfma_f32_32x32x16_bf16 v[148:163], v[104:107], v[192:195], v[148:163]
  s_branch K2_tailB0
K2_pfulB3:
  s_mov_b32 s62, 2
  s_branch K2_flushB3
K2_flushA0:
  s_lshr_b32 s51, s40, 3
  s_sub_u32 s58, s44, s40
  s_add_u32 s50, s40, 64
  s_cmp_ge_u32 s58, 64
  s_cselect_b32 s63, 1, s63
  v_subrev_u32 v243, s60, v253
  v_and_b32 v243, 7, v243
  v_add_u32 v243, s60, v243
  v_cmp_gt_u32 s[52:53], s51, v243
  v_cmp_eq_u32 s[54:55], s61, v243
  v_lshl_add_u32 v241, v243, 4, v254
  v_mad_u32_u24 v243, v243, s89, v248
  s_or_b64 s[54:55], s[54:55], s[78:79]
  s_and_b64 s[54:55], s[54:55], s[52:53]
  s_cmp_lg_u64 s[54:55], 0
  s_cbranch_scc1 K2_flushG_7
  v_cvt_pk_bf16_f32 v116, v132, v133
  v_cvt_pk_bf16_f32 v117, v134, v135
  v_cvt_pk_bf16_f32 v118, v136, v137
  v_cvt_pk_bf16_f32 v119, v138, v139
  v_cvt_pk_bf16_f32 v120, v140, v141
  v_cvt_pk_bf16_f32 v121, v142, v143
  v_cvt_pk_bf16_f32 v122, v144, v145
  v_cvt_pk_bf16_f32 v123, v146, v147
  v_cvt_pk_bf16_f32 v124, v148, v149
  v_cvt_pk_bf16_f32 v125, v150, v151
  v_cvt_pk_bf16_f32 v126, v152, v153
  v_cvt_pk_bf16_f32 v127, v154, v155
  v_cvt_pk_bf16_f32 v128, v156, v157
  v_cvt_pk_bf16_f32 v129, v158, v159
  v_cvt_pk_bf16_f32 v130, v160, v161
  v_cvt_pk_bf16_f32 v131, v162, v163
  s_mov_b64 exec, s[52:53]
  v_mfma_f32_32x32x16_bf16 v[100:115], v[36:39], v[116:119], 0
  v_mov_b64 v[132:133], 0
  v_mov_b64 v[134:135], 0
  v_mov_b64 v[136:137], 0
  v_mov_b64 v[138:139], 0
  v_mfma_f32_32x32x16_bf16 v[100:115], v[40:43], v[120:123], v[100:115]
  v_mov_b64 v[140:141], 0
  v_mov_b64 v[142:143], 0
  v_mov_b64 v[144:145], 0
  v_mov_b64 v[146:147], 0
  v_mfma_f32_32x32x16_bf16 v[100:115], v[44:47], v[124:127], v[100:115]
  v_mov_b64 v[148:149], 0
  v_mov_b64 v[150:151], 0
  v_mov_b64 v[152:153], 0
  v_mov_b64 v[154:155], 0
  v_mfma_f32_32x32x16_bf16 v[100:115], v[48:51], v[128:131], v[100:115]
  v_mov_b64 v[156:157], 0
  v_mov_b64 v[158:159], 0
  v_mov_b64 v[160:161], 0
  v_mov_b64 v[162:163], 0
  s_and_b64 exec, s[52:53], s[72:73]
  ds_write_b64 v243, v[116:117] offset:0
  ds_write_b64 v243, v[118:119] offset:16
  ds_write_b64 v243, v[120:121] offset:32
  ds_write_b64 v243, v[122:123] offset:48
  ds_write_b64 v243, v[124:125] offset:64
  ds_write_b64 v243, v[126:127] offset:80
  ds_write_b64 v243, v[128:129] offset:96
  ds_write_b64 v243, v[130:131] offset:112
  s_and_b64 exec, s[52:53], s[74:75]
  ds_write_b32 v241, v100 offset:41408
  s_mov_b64 exec, -1
  s_mov_b32 s60, s51
K2_bkA0:
  s_cmp_eq_u32 s62, 2
  s_cbranch_scc1 K2_backPA0
  s_cmp_lg_u32 s62, 0
  s_cbranch_scc1 K2_backTA0
  s_branch K2_backA0
K2_flushA1:
  s_lshr_b32 s51, s41, 3
  s_sub_u32 s58, s45, s41
  s_add_u32 s50, s41, 64
  s_cmp_ge_u32 s58, 64
  s_cselect_b32 s63, 1, s63
  v_subrev_u32 v243, s60, v253
  v_and_b32 v243, 7, v243
  v_add_u32 v243, s60, v243
  v_cmp_gt_u32 s[52:53], s51, v243
  v_cmp_eq_u32 s[54:55], s61, v243
  v_lshl_add_u32 v241, v243, 4, v254
  v_mad_u32_u24 v243, v243, s89, v248
  s_or_b64 s[54:55], s[54:55], s[78:79]
  s_and_b64 s[54:55], s[54:55], s[52:53]
  s_cmp_lg_u64 s[54:55], 0
  s_cbranch_scc1 K2_flushG_8
  v_cvt_pk_bf16_f32 v84, v132, v133
  v_cvt_pk_bf16_f32 v85, v134, v135
  v_cvt_pk_bf16_f32 v86, v136, v137
  v_cvt_pk_bf16_f32 v87, v138, v139
  v_cvt_pk_bf16_f32 v88, v140, v141
  v_cvt_pk_bf16_f32 v89, v142, v143
  v_cvt_pk_bf16_f32 v90, v144, v145
  v_cvt_pk_bf16_f32 v91, v146, v147
  v_cvt_pk_bf16_f32 v92, v148, v149
  v_cvt_pk_bf16_f32 v93, v150, v151
  v_cvt_pk_bf16_f32 v94, v152, v153
  v_cvt_pk_bf16_f32 v95, v154, v155
  v_cvt_pk_bf16_f32 v96, v156, v157
  v_cvt_pk_bf16_f32 v97, v158, v159
  v_cvt_pk_bf16_f32 v98, v160, v161
  v_cvt_pk_bf16_f32 v99, v162, v163
  s_mov_b64 exec, s[52:53]
  v_mfma_f32_32x32x16_bf16 v[68:83], v[36:39], v[84:87], 0
  v_mov_b64 v[132:133], 0
  v_mov_b64 v[134:135], 0
  v_mov_b64 v[136:137], 0
  v_mov_b64 v[138:139], 0
  v_mfma_f32_32x32x16_bf16 v[68:83], v[40:43], v[88:91], v[68:83]
  v_mov_b64 v[140:141], 0
  v_mov_b64 v[142:143], 0
  v_mov_b64 v[144:145], 0
  v_mov_b64 v[146:147], 0
  v_mfma_f32_32x32x16_bf16 v[68:83], v[44:47], v[92:95], v[68:83]
  v_mov_b64 v[148:149], 0
  v_mov_b64 v[150:151], 0
  v_mov_b64 v[152:153], 0
  v_mov_b64 v[154:155], 0
  v_mfma_f32_32x32x16_bf16 v[68:83], v[48:51], v[96:99], v[68:83]
  v_mov_b64 v[156:157], 0
  v_mov_b64 v[158:159], 0
  v_mov_b64 v[160:161], 0
  v_mov_b64 v[162:163], 0
  s_and_b64 exec, s[52:53], s[72:73]
  ds_write_b64 v243, v[84:85] offset:0
  ds_write_b64 v243, v[86:87] offset:16
  ds_write_b64 v243, v[88:89] offset:32
  ds_write_b64 v243, v[90:91] offset:48
  ds_write_b64 v243, v[92:93] offset:64
  ds_write_b64 v243, v[94:95] offset:80
  ds_write_b64 v243, v[96:97] offset:96
  ds_write_b64 v243, v[98:99] offset:112
  s_and_b64 exec, s[52:53], s[74:75]
  ds_write_b32 v241, v68 offset:41408
  s_mov_b64 exec, -1
  s_mov_b32 s60, s51
K2_bkA1:
  s_cmp_eq_u32 s62, 2
  s_cbranch_scc1 K2_backPA1
  s_cmp_lg_u32 s62, 0
  s_cbranch_scc1 K2_backTA1
  s_branch K2_backA1
K2_flushA2:
  s_lshr_b32 s51, s42, 3
  s_sub_u32 s58, s46, s42
  s_add_u32 s50, s42, 64
  s_cmp_ge_u32 s58, 64
  s_cselect_b32 s63, 1, s63
  v_subrev_u32 v243, s60, v253
  v_and_b32 v243, 7, v243
  v_add_u32 v243, s60, v243
  v_cmp_gt_u32 s[52:53], s51, v243
  v_cmp_eq_u32 s[54:55], s61, v243
  v_lshl_add_u32 v241, v243, 4, v254
  v_mad_u32_u24 v243, v243, s89, v248
  s_or_b64 s[54:55], s[54:55], s[78:79]
  s_and_b64 s[54:55], s[54:55], s[52:53]
  s_cmp_lg_u64 s[54:55], 0
  s_cbranch_scc1 K2_flushG_9
  v_cvt_pk_bf16_f32 v116, v132, v133
  v_cvt_pk_bf16_f32 v117, v134, v135
  v_cvt_pk_bf16_f32 v118, v136, v137
  v_cvt_pk_bf16_f32 v119, v138, v139
  v_cvt_pk_bf16_f32 v120, v140, v141
  v_cvt_pk_bf16_f32 v121, v142, v143
  v_cvt_pk_bf16_f32 v122, v144, v145
  v_cvt_pk_bf16_f32 v123, v146, v147
  v_cvt_pk_bf16_f32 v124, v148, v149
  v_cvt_pk_bf16_f32 v125, v150, v151
  v_cvt_pk_bf16_f32 v126, v152, v153
  v_cvt_pk_bf16_f32 v127, v154, v155
  v_cvt_pk_bf16_f32 v128, v156, v157
  v_cvt_pk_bf16_f32 v129, v158, v159
  v_cvt_pk_bf16_f32 v130, v160, v161
  v_cvt_pk_bf16_f32 v131, v162, v163
  s_mov_b64 exec, s[52:53]
  v_mfma_f32_32x32x16_bf16 v[100:115], v[36:39], v[116:119], 0
  v_mov_b64 v[132:133], 0
  v_mov_b64 v[134:135], 0
  v_mov_b64 v[136:137], 0
  v_mov_b64 v[138:139], 0
  v_mfma_f32_32x32x16_bf16 v[100:115], v[40:43], v[120:123], v[100:115]
  v_mov_b64 v[140:141], 0
  v_mov_b64 v[142:143], 0
  v_mov_b64 v[144:145], 0
  v_mov_b64 v[146:147], 0
  v_mfma_f32_32x32x16_bf16 v[100:115], v[44:47], v[124:127], v[100:115]
  v_mov_b64 v[148:149], 0
  v_mov_b64 v[150:151], 0
  v_mov_b64 v[152:153], 0
  v_mov_b64 v[154:155], 0
  v_mfma_f32_32x32x16_bf16 v[100:115], v[48:51], v[128:131], v[100:115]
  v_mov_b64 v[156:157], 0
  v_mov_b64 v[158:159], 0
  v_mov_b64 v[160:161], 0
  v_mov_b64 v[162:163], 0
  s_and_b64 exec, s[52:53], s[72:73]
  ds_write_b64 v243, v[116:117] offset:0
  ds_write_b64 v243, v[118:119] offset:16
  ds_write_b64 v243, v[120:121] offset:32
  ds_write_b64 v243, v[122:123] offset:48
  ds_write_b64 v243, v[124:125] offset:64
  ds_write_b64 v243, v[126:127] offset:80
  ds_write_b64 v243, v[128:129] offset:96
  ds_write_b64 v243, v[130:131] offset:112
  s_and_b64 exec, s[52:53], s[74:75]
  ds_write_b32 v241, v100 offset:41408
  s_mov_b64 exec, -1
  s_mov_b32 s60, s51
K2_bkA2:
  s_cmp_eq_u32 s62, 2
  s_cbranch_scc1 K2_backPA2
  s_cmp_lg_u32 s62, 0
  s_cbranch_scc1 K2_backTA2
  s_branch K2_backA2
K2_flushA3:
  s_lshr_b32 s51, s43, 3
  s_sub_u32 s58, s47, s43
  s_add_u32 s50, s43, 64
  s_cmp_ge_u32 s58, 64
  s_cselect_b32 s63, 1, s63
  v_subrev_u32 v243, s60, v253
  v_and_b32 v243, 7, v243
  v_add_u32 v243, s60, v243
  v_cmp_gt_u32 s[52:53], s51, v243
  v_cmp_eq_u32 s[54:55], s61, v243
  v_lshl_add_u32 v241, v243, 4, v254
  v_mad_u32_u24 v243, v243, s89, v248
  s_or_b64 s[54:55], s[54:55], s[78:79]
  s_and_b64 s[54:55], s[54:55], s[52:53]
  s_cmp_lg_u64 s[54:55], 0
  s_cbranch_scc1 K2_flushG_10
  v_cvt_pk_bf16_f32 v84, v132, v133
  v_cvt_pk_bf16_f32 v85, v134, v135
  v_cvt_pk_bf16_f32 v86, v136, v137
  v_cvt_pk_bf16_f32 v87, v138, v139
  v_cvt_pk_bf16_f32 v88, v140, v141
  v_cvt_pk_bf16_f32 v89, v142, v143
  v_cvt_pk_bf16_f32 v90, v144, v145
  v_cvt_pk_bf16_f32 v91, v146, v147
  v_cvt_pk_bf16_f32 v92, v148, v149
  v_cvt_pk_bf16_f32 v93, v150, v151
  v_cvt_pk_bf16_f32 v94, v152, v153
  v_cvt_pk_bf16_f32 v95, v154, v155
  v_cvt_pk_bf16_f32 v96, v156, v157
  v_cvt_pk_bf16_f32 v97, v158, v159
  v_cvt_pk_bf16_f32 v98, v160, v161
  v_cvt_pk_bf16_f32 v99, v162, v163
  s_mov_b64 exec, s[52:53]
  v_mfma_f32_32x32x16_bf16 v[68:83], v[36:39], v[84:87], 0
  v_mov_b64 v[132:133], 0
  v_mov_b64 v[134:135], 0
  v_mov_b64 v[136:137], 0
  v_mov_b64 v[138:139], 0
  v_mfma_f32_32x32x16_bf16 v[68:83], v[40:43], v[88:91], v[68:83]
  v_mov_b64 v[140:141], 0
  v_mov_b64 v[142:143], 0
  v_mov_b64 v[144:145], 0
  v_mov_b64 v[146:147], 0
  v_mfma_f32_32x32x16_bf16 v[68:83], v[44:47], v[92:95], v[68:83]
  v_mov_b64 v[148:149], 0
  v_mov_b64 v[150:151], 0
  v_mov_b64 v[152:153], 0
  v_mov_b64 v[154:155], 0
  v_mfma_f32_32x32x16_bf16 v[68:83], v[48:51], v[96:99], v[68:83]
  v_mov_b64 v[156:157], 0
  v_mov_b64 v[158:159], 0
  v_mov_b64 v[160:161], 0
  v_mov_b64 v[162:163], 0
  s_and_b64 exec, s[52:53], s[72:73]
  ds_write_b64 v243, v[84:85] offset:0
  ds_write_b64 v243, v[86:87] offset:16
  ds_write_b64 v243, v[88:89] offset:32
  ds_write_b64 v243, v[90:91] offset:48
  ds_write_b64 v243, v[92:93] offset:64
  ds_write_b64 v243, v[94:95] offset:80
  ds_write_b64 v243, v[96:97] offset:96
  ds_write_b64 v243, v[98:99] offset:112
  s_and_b64 exec, s[52:53], s[74:75]
  ds_write_b32 v241, v68 offset:41408
  s_mov_b64 exec, -1
  s_mov_b32 s60, s51
K2_bkA3:
  s_cmp_eq_u32 s62, 2
  s_cbranch_scc1 K2_backPA3
  s_cmp_lg_u32 s62, 0
  s_cbranch_scc1 K2_backTA3
  s_branch K2_backA3
K2_flushB0:
  s_lshr_b32 s51, s40, 3
  s_sub_u32 s58, s44, s40
  s_add_u32 s50, s40, 64
  s_cmp_ge_u32 s58, 64
  s_cselect_b32 s63, 1, s63
  v_subrev_u32 v243, s60, v253
  v_and_b32 v243, 7, v243
  v_add_u32 v243, s60, v243
  v_cmp_gt_u32 s[52:53], s51, v243
  v_cmp_eq_u32 s[54:55], s61, v243
  v_lshl_add_u32 v241, v243, 4, v254
  v_mad_u32_u24 v243, v243, s89, v248
  s_or_b64 s[54:55], s[54:55], s[78:79]
  s_and_b64 s[54:55], s[54:55], s[52:53]
  s_cmp_lg_u64 s[54:55], 0
  s_cbranch_scc1 K2_flushG_11
  v_cvt_pk_bf16_f32 v116, v132, v133
  v_cvt_pk_bf16_f32 v117, v134, v135
  v_cvt_pk_bf16_f32 v118, v136, v137
  v_cvt_pk_bf16_f32 v119, v138, v139
  v_cvt_pk_bf16_f32 v120, v140, v141
  v_cvt_pk_bf16_f32 v121, v142, v143
  v_cvt_pk_bf16_f32 v122, v144, v145
  v_cvt_pk_bf16_f32 v123, v146, v147
  v_cvt_pk_bf16_f32 v124, v148, v149
  v_cvt_pk_bf16_f32 v125, v150, v151
  v_cvt_pk_bf16_f32 v126, v152, v153
  v_cvt_pk_bf16_f32 v127, v154, v155
  v_cvt_pk_bf16_f32 v128, v156, v157
  v_cvt_pk_bf16_f32 v129, v158, v159
  v_cvt_pk_bf16_f32 v130, v160, v161
  v_cvt_pk_bf16_f32 v131, v162, v163
  s_mov_b64 exec, s[52:53]
  v_mfma_f32_32x32x16_bf16 v[100:115], v[36:39], v[116:119], 0
  v_mov_b64 v[132:133], 0
  v_mov_b64 v[134:135], 0
  v_mov_b64 v[136:137], 0
  v_mov_b64 v[138:139], 0
  v_mfma_f32_32x32x16_bf16 v[100:115], v[40:43], v[120:123], v[100:115]
  v_mov_b64 v[140:141], 0
  v_mov_b64 v[142:143], 0
  v_mov_b64 v[144:145], 0
  v_mov_b64 v[146:147], 0
  v_mfma_f32_32x32x16_bf16 v[100:115], v[44:47], v[124:127], v[100:115]
  v_mov_b64 v[148:149], 0
  v_mov_b64 v[150:151], 0
  v_mov_b64 v[152:153], 0
  v_mov_b64 v[154:155], 0
  v_mfma_f32_32x32x16_bf16 v[100:115], v[48:51], v[128:131], v[100:115]
  v_mov_b64 v[156:157], 0
  v_mov_b64 v[158:159], 0
  v_mov_b64 v[160:161], 0
  v_mov_b64 v[162:163], 0
  s_and_b64 exec, s[52:53], s[72:73]
  ds_write_b64 v243, v[116:117] offset:0
  ds_write_b64 v243, v[118:119] offset:16
  ds_write_b64 v243, v[120:121] offset:32
  ds_write_b64 v243, v[122:123] offset:48
  ds_write_b64 v243, v[124:125] offset:64
  ds_write_b64 v243, v[126:127] offset:80
  ds_write_b64 v243, v[128:129] offset:96
  ds_write_b64 v243, v[130:131] offset:112
  s_and_b64 exec, s[52:53], s[74:75]
  ds_write_b32 v241, v100 offset:41408
  s_mov_b64 exec, -1
  s_mov_b32 s60, s51
K2_bkB0:
  s_cmp_eq_u32 s62, 2
  s_cbranch_scc1 K2_backPB0
  s_cmp_lg_u32 s62, 0
  s_cbranch_scc1 K2_backTB0
  s_branch K2_backB0
K2_flushB1:
  s_lshr_b32 s51, s41, 3
  s_sub_u32 s58, s45, s41
  s_add_u32 s50, s41, 64
  s_cmp_ge_u32 s58, 64
  s_cselect_b32 s63, 1, s63
  v_subrev_u32 v243, s60, v253
  v_and_b32 v243, 7, v243
  v_add_u32 v243, s60, v243
  v_cmp_gt_u32 s[52:53], s51, v243
  v_cmp_eq_u32 s[54:55], s61, v243
  v_lshl_add_u32 v241, v243, 4, v254
  v_mad_u32_u24 v243, v243, s89, v248
  s_or_b64 s[54:55], s[54:55], s[78:79]
  s_and_b64 s[54:55], s[54:55], s[52:53]
  s_cmp_lg_u64 s[54:55], 0
  s_cbranch_scc1 K2_flushG_12
  v_cvt_pk_bf16_f32 v84, v132, v133
  v_cvt_pk_bf16_f32 v85, v134, v135
  v_cvt_pk_bf16_f32 v86, v136, v137
  v_cvt_pk_bf16_f32 v87, v138, v139
  v_cvt_pk_bf16_f32 v88, v140, v141
  v_cvt_pk_bf16_f32 v89, v142, v143
  v_cvt_pk_bf16_f32 v90, v144, v145
  v_cvt_pk_bf16_f32 v91, v146, v147
  v_cvt_pk_bf16_f32 v92, v148, v149
  v_cvt_pk_bf16_f32 v93, v150, v151
  v_cvt_pk_bf16_f32 v94, v152, v153
  v_cvt_pk_bf16_f32 v95, v154, v155
  v_cvt_pk_bf16_f32 v96, v156, v157
  v_cvt_pk_bf16_f32 v97, v158, v159
  v_cvt_pk_bf16_f32 v98, v160, v161
  v_cvt_pk_bf16_f32 v99, v162, v163
  s_mov_b64 exec, s[52:53]
  v_mfma_f32_32x32x16_bf16 v[68:83], v[36:39], v[84:87], 0
  v_mov_b64 v[132:133], 0
  v_mov_b64 v[134:135], 0
  v_mov_b64 v[136:137], 0
  v_mov_b64 v[138:139], 0
  v_mfma_f32_32x32x16_bf16 v[68:83], v[40:43], v[88:91], v[68:83]
  v_mov_b64 v[140:141], 0
  v_mov_b64 v[142:143], 0
  v_mov_b64 v[144:145], 0
  v_mov_b64 v[146:147], 0
  v_mfma_f32_32x32x16_bf16 v[68:83], v[44:47], v[92:95], v[68:83]
  v_mov_b64 v[148:149], 0
  v_mov_b64 v[150:151], 0
  v_mov_b64 v[152:153], 0
  v_mov_b64 v[154:155], 0
  v_mfma_f32_32x32x16_bf16 v[68:83], v[48:51], v[96:99], v[68:83]
  v_mov_b64 v[156:157], 0
  v_mov_b64 v[158:159], 0
  v_mov_b64 v[160:161], 0
  v_mov_b64 v[162:163], 0
  s_and_b64 exec, s[52:53], s[72:73]
  ds_write_b64 v243, v[84:85] offset:0
  ds_write_b64 v243, v[86:87] offset:16
  ds_write_b64 v243, v[88:89] offset:32
  ds_write_b64 v243, v[90:91] offset:48
  ds_write_b64 v243, v[92:93] offset:64
  ds_write_b64 v243, v[94:95] offset:80
  ds_write_b64 v243, v[96:97] offset:96
  ds_write_b64 v243, v[98:99] offset:112
  s_and_b64 exec, s[52:53], s[74:75]
  ds_write_b32 v241, v68 offset:41408
  s_mov_b64 exec, -1
  s_mov_b32 s60, s51
K2_bkB1:
  s_cmp_eq_u32 s62, 2
  s_cbranch_scc1 K2_backPB1
  s_cmp_lg_u32 s62, 0
  s_cbranch_scc1 K2_backTB1
  s_branch K2_backB1
K2_flushB2:
  s_lshr_b32 s51, s42, 3
  s_sub_u32 s58, s46, s42
  s_add_u32 s50, s42, 64
  s_cmp_ge_u32 s58, 64
  s_cselect_b32 s63, 1, s63
  v_subrev_u32 v243, s60, v253
  v_and_b32 v243, 7, v243
  v_add_u32 v243, s60, v243
  v_cmp_gt_u32 s[52:53], s51, v243
  v_cmp_eq_u32 s[54:55], s61, v243
  v_lshl_add_u32 v241, v243, 4, v254
  v_mad_u32_u24 v243, v243, s89, v248
  s_or_b64 s[54:55], s[54:55], s[78:79]
  s_and_b64 s[54:55], s[54:55], s[52:53]
  s_cmp_lg_u64 s[54:55], 0
  s_cbranch_scc1 K2_flushG_13
  v_cvt_pk_bf16_f32 v116, v132, v133
  v_cvt_pk_bf16_f32 v117, v134, v135
  v_cvt_pk_bf16_f32 v118, v136, v137
  v_cvt_pk_bf16_f32 v119, v138, v139
  v_cvt_pk_bf16_f32 v120, v140, v141
  v_cvt_pk_bf16_f32 v121, v142, v143
  v_cvt_pk_bf16_f32 v122, v144, v145
  v_cvt_pk_bf16_f32 v123, v146, v147
  v_cvt_pk_bf16_f32 v124, v148, v149
  v_cvt_pk_bf16_f32 v125, v150, v151
  v_cvt_pk_bf16_f32 v126, v152, v153
  v_cvt_pk_bf16_f32 v127, v154, v155
  v_cvt_pk_bf16_f32 v128, v156, v157
  v_cvt_pk_bf16_f32 v129, v158, v159
  v_cvt_pk_bf16_f32 v130, v160, v161
  v_cvt_pk_bf16_f32 v131, v162, v163
  s_mov_b64 exec, s[52:53]
  v_mfma_f32_32x32x16_bf16 v[100:115], v[36:39], v[116:119], 0
  v_mov_b64 v[132:133], 0
  v_mov_b64 v[134:135], 0
  v_mov_b64 v[136:137], 0
  v_mov_b64 v[138:139], 0
  v_mfma_f32_32x32x16_bf16 v[100:115], v[40:43], v[120:123], v[100:115]
  v_mov_b64 v[140:141], 0
  v_mov_b64 v[142:143], 0
  v_mov_b64 v[144:145], 0
  v_mov_b64 v[146:147], 0
  v_mfma_f32_32x32x16_bf16 v[100:115], v[44:47], v[124:127], v[100:115]
  v_mov_b64 v[148:149], 0
  v_mov_b64 v[150:151], 0
  v_mov_b64 v[152:153], 0
  v_mov_b64 v[154:155], 0
  v_mfma_f32_32x32x16_bf16 v[100:115], v[48:51], v[128:131], v[100:115]
  v_mov_b64 v[156:157], 0
  v_mov_b64 v[158:159], 0
  v_mov_b64 v[160:161], 0
  v_mov_b64 v[162:163], 0
  s_and_b64 exec, s[52:53], s[72:73]
  ds_write_b64 v243, v[116:117] offset:0
  ds_write_b64 v243, v[118:119] offset:16
  ds_write_b64 v243, v[120:121] offset:32
  ds_write_b64 v243, v[122:123] offset:48
  ds_write_b64 v243, v[124:125] offset:64
  ds_write_b64 v243, v[126:127] offset:80
  ds_write_b64 v243, v[128:129] offset:96
  ds_write_b64 v243, v[130:131] offset:112
  s_and_b64 exec, s[52:53], s[74:75]
  ds_write_b32 v241, v100 offset:41408
  s_mov_b64 exec, -1
  s_mov_b32 s60, s51
K2_bkB2:
  s_cmp_eq_u32 s62, 2
  s_cbranch_scc1 K2_backPB2
  s_cmp_lg_u32 s62, 0
  s_cbranch_scc1 K2_backTB2
  s_branch K2_backB2
K2_flushB3:
  s_lshr_b32 s51, s43, 3
  s_sub_u32 s58, s47, s43
  s_add_u32 s50, s43, 64
  s_cmp_ge_u32 s58, 64
  s_cselect_b32 s63, 1, s63
  v_subrev_u32 v243, s60, v253
  v_and_b32 v243, 7, v243
  v_add_u32 v243, s60, v243
  v_cmp_gt_u32 s[52:53], s51, v243
  v_cmp_eq_u32 s[54:55], s61, v243
  v_lshl_add_u32 v241, v243, 4, v254
  v_mad_u32_u24 v243, v243, s89, v248
  s_or_b64 s[54:55], s[54:55], s[78:79]
  s_and_b64 s[54:55], s[54:55], s[52:53]
  s_cmp_lg_u64 s[54:55], 0
  s_cbranch_scc1 K2_flushG_14
  v_cvt_pk_bf16_f32 v84, v132, v133
  v_cvt_pk_bf16_f32 v85, v134, v135
  v_cvt_pk_bf16_f32 v86, v136, v137
  v_cvt_pk_bf16_f32 v87, v138, v139
  v_cvt_pk_bf16_f32 v88, v140, v141
  v_cvt_pk_bf16_f32 v89, v142, v143
  v_cvt_pk_bf16_f32 v90, v144, v145
  v_cvt_pk_bf16_f32 v91, v146, v147
  v_cvt_pk_bf16_f32 v92, v148, v149
  v_cvt_pk_bf16_f32 v93, v150, v151
  v_cvt_pk_bf16_f32 v94, v152, v153
  v_cvt_pk_bf16_f32 v95, v154, v155
  v_cvt_pk_bf16_f32 v96, v156, v157
  v_cvt_pk_bf16_f32 v97, v158, v159
  v_cvt_pk_bf16_f32 v98, v160, v161
  v_cvt_pk_bf16_f32 v99, v162, v163
  s_mov_b64 exec, s[52:53]
  v_mfma_f32_32x32x16_bf16 v[68:83], v[36:39], v[84:87], 0
  v_mov_b64 v[132:133], 0
  v_mov_b64 v[134:135], 0
  v_mov_b64 v[136:137], 0
  v_mov_b64 v[138:139], 0
  v_mfma_f32_32x32x16_bf16 v[68:83], v[40:43], v[88:91], v[68:83]
  v_mov_b64 v[140:141], 0
  v_mov_b64 v[142:143], 0
  v_mov_b64 v[144:145], 0
  v_mov_b64 v[146:147], 0
  v_mfma_f32_32x32x16_bf16 v[68:83], v[44:47], v[92:95], v[68:83]
  v_mov_b64 v[148:149], 0
  v_mov_b64 v[150:151], 0
  v_mov_b64 v[152:153], 0
  v_mov_b64 v[154:155], 0
  v_mfma_f32_32x32x16_bf16 v[68:83], v[48:51], v[96:99], v[68:83]
  v_mov_b64 v[156:157], 0
  v_mov_b64 v[158:159], 0
  v_mov_b64 v[160:161], 0
  v_mov_b64 v[162:163], 0
  s_and_b64 exec, s[52:53], s[72:73]
  ds_write_b64 v243, v[84:85] offset:0
  ds_write_b64 v243, v[86:87] offset:16
  ds_write_b64 v243, v[88:89] offset:32
  ds_write_b64 v243, v[90:91] offset:48
  ds_write_b64 v243, v[92:93] offset:64
  ds_write_b64 v243, v[94:95] offset:80
  ds_write_b64 v243, v[96:97] offset:96
  ds_write_b64 v243, v[98:99] offset:112
  s_and_b64 exec, s[52:53], s[74:75]
  ds_write_b32 v241, v68 offset:41408
  s_mov_b64 exec, -1
  s_mov_b32 s60, s51
K2_bkB3:
  s_cmp_eq_u32 s62, 2
  s_cbranch_scc1 K2_backPB3
  s_cmp_lg_u32 s62, 0
  s_cbranch_scc1 K2_backTB3
  s_branch K2_backB3
K2_flushG_7:
  s_andn2_b64 s[56:57], s[52:53], s[54:55]
  v_cvt_pk_bf16_f32 v116, v132, v133
  v_cvt_pk_bf16_f32 v117, v134, v135
  v_cvt_pk_bf16_f32 v118, v136, v137
  v_cvt_pk_bf16_f32 v119, v138, v139
  v_cvt_pk_bf16_f32 v120, v140, v141
  v_cvt_pk_bf16_f32 v121, v142, v143
  v_cvt_pk_bf16_f32 v122, v144, v145
  v_cvt_pk_bf16_f32 v123, v146, v147
  v_cvt_pk_bf16_f32 v124, v148, v149
  v_cvt_pk_bf16_f32 v125, v150, v151
  v_cvt_pk_bf16_f32 v126, v152, v153
  v_cvt_pk_bf16_f32 v127, v154, v155
  v_cvt_pk_bf16_f32 v128, v156, v157
  v_cvt_pk_bf16_f32 v129, v158, v159
  v_cvt_pk_bf16_f32 v130, v160, v161
  v_cvt_pk_bf16_f32 v131, v162, v163
  s_and_b64 exec, s[56:57], s[72:73]
  v_mfma_f32_32x32x16_bf16 v[100:115], v[36:39], v[116:119], 0
  ds_write_b64 v243, v[116:117] offset:0
  ds_write_b64 v243, v[118:119] offset:16
  v_mfma_f32_32x32x16_bf16 v[100:115], v[40:43], v[120:123], v[100:115]
  ds_write_b64 v243, v[120:121] offset:32
  ds_write_b64 v243, v[122:123] offset:48
  v_mfma_f32_32x32x16_bf16 v[100:115], v[44:47], v[124:127], v[100:115]
  ds_write_b64 v243, v[124:125] offset:64
  ds_write_b64 v243, v[126:127] offset:80
  v_mfma_f32_32x32x16_bf16 v[100:115], v[48:51], v[128:131], v[100:115]
  ds_write_b64 v243, v[128:129] offset:96
  ds_write_b64 v243, v[130:131] offset:112
  s_and_b64 exec, s[54:55], s[72:73]
  s_cbranch_execz K2_fa_15
  s_cmp_lg_u64 s[78:79], 0
  s_cbranch_scc1 K2_fs_16
  ds_pk_add_bf16 v243, v116 offset:0
  ds_pk_add_bf16 v243, v117 offset:4
  ds_pk_add_bf16 v243, v118 offset:16
  ds_pk_add_bf16 v243, v119 offset:20
  ds_pk_add_bf16 v243, v120 offset:32
  ds_pk_add_bf16 v243, v121 offset:36
  ds_pk_add_bf16 v243, v122 offset:48
  ds_pk_add_bf16 v243, v123 offset:52
  ds_pk_add_bf16 v243, v124 offset:64
  ds_pk_add_bf16 v243, v125 offset:68
  ds_pk_add_bf16 v243, v126 offset:80
  ds_pk_add_bf16 v243, v127 offset:84
  ds_pk_add_bf16 v243, v128 offset:96
  ds_pk_add_bf16 v243, v129 offset:100
  ds_pk_add_bf16 v243, v130 offset:112
  ds_pk_add_bf16 v243, v131 offset:116
K2_fa_15:
  s_mov_b64 exec, s[52:53]
  v_mov_b64 v[132:133], 0
  v_mov_b64 v[134:135], 0
  v_mov_b64 v[136:137], 0
  v_mov_b64 v[138:139], 0
  v_mov_b64 v[140:141], 0
  v_mov_b64 v[142:143], 0
  v_mov_b64 v[144:145], 0
  v_mov_b64 v[146:147], 0
  v_mov_b64 v[148:149], 0
  v_mov_b64 v[150:151], 0
  v_mov_b64 v[152:153], 0
  v_mov_b64 v[154:155], 0
  v_mov_b64 v[156:157], 0
  v_mov_b64 v[158:159], 0
  v_mov_b64 v[160:161], 0
  v_mov_b64 v[162:163], 0
  s_and_b64 exec, s[56:57], s[74:75]
  ds_write_b32 v241, v100 offset:41408
  s_and_b64 exec, s[54:55], s[74:75]
  s_cbranch_execz K2_fb_17
  ds_add_f32 v241, v100 offset:41408
K2_fb_17:
  s_mov_b64 exec, -1
  s_mov_b32 s60, s51
  s_branch K2_bkA0
K2_flushG_8:
  s_andn2_b64 s[56:57], s[52:53], s[54:55]
  v_cvt_pk_bf16_f32 v84, v132, v133
  v_cvt_pk_bf16_f32 v85, v134, v135
  v_cvt_pk_bf16_f32 v86, v136, v137
  v_cvt_pk_bf16_f32 v87, v138, v139
  v_cvt_pk_bf16_f32 v88, v140, v141
  v_cvt_pk_bf16_f32 v89, v142, v143
  v_cvt_pk_bf16_f32 v90, v144, v145
  v_cvt_pk_bf16_f32 v91, v146, v147
  v_cvt_pk_bf16_f32 v92, v148, v149
  v_cvt_pk_bf16_f32 v93, v150, v151
  v_cvt_pk_bf16_f32 v94, v152, v153
  v_cvt_pk_bf16_f32 v95, v154, v155
  v_cvt_pk_bf16_f32 v96, v156, v157
  v_cvt_pk_bf16_f32 v97, v158, v159
  v_cvt_pk_bf16_f32 v98, v160, v161
  v_cvt_pk_bf16_f32 v99, v162, v163
  s_and_b64 exec, s[56:57], s[72:73]
  v_mfma_f32_32x32x16_bf16 v[68:83], v[36:39], v[84:87], 0
  ds_write_b64 v243, v[84:85] offset:0
  ds_write_b64 v243, v[86:87] offset:16
  v_mfma_f32_32x32x16_bf16 v[68:83], v[40:43], v[88:91], v[68:83]
  ds_write_b64 v243, v[88:89] offset:32
  ds_write_b64 v243, v[90:91] offset:48
  v_mfma_f32_32x32x16_bf16 v[68:83], v[44:47], v[92:95], v[68:83]
  ds_write_b64 v243, v[92:93] offset:64
  ds_write_b64 v243, v[94:95] offset:80
  v_mfma_f32_32x32x16_bf16 v[68:83], v[48:51], v[96:99], v[68:83]
  ds_write_b64 v243, v[96:97] offset:96
  ds_write_b64 v243, v[98:99] offset:112
  s_and_b64 exec, s[54:55], s[72:73]
  s_cbranch_execz K2_fa_18
  s_cmp_lg_u64 s[78:79], 0
  s_cbranch_scc1 K2_fs_19
  ds_pk_add_bf16 v243, v84 offset:0
  ds_pk_add_bf16 v243, v85 offset:4
  ds_pk_add_bf16 v243, v86 offset:16
  ds_pk_add_bf16 v243, v87 offset:20
  ds_pk_add_bf16 v243, v88 offset:32
  ds_pk_add_bf16 v243, v89 offset:36
  ds_pk_add_bf16 v243, v90 offset:48
  ds_pk_add_bf16 v243, v91 offset:52
  ds_pk_add_bf16 v243, v92 offset:64
  ds_pk_add_bf16 v243, v93 offset:68
  ds_pk_add_bf16 v243, v94 offset:80
  ds_pk_add_bf16 v243, v95 offset:84
  ds_pk_add_bf16 v243, v96 offset:96
  ds_pk_add_bf16 v243, v97 offset:100
  ds_pk_add_bf16 v243, v98 offset:112
  ds_pk_add_bf16 v243, v99 offset:116
K2_fa_18:
  s_mov_b64 exec, s[52:53]
  v_mov_b64 v[132:133], 0
  v_mov_b64 v[134:135], 0
  v_mov_b64 v[136:137], 0
  v_mov_b64 v[138:139], 0
  v_mov_b64 v[140:141], 0
  v_mov_b64 v[142:143], 0
  v_mov_b64 v[144:145], 0
  v_mov_b64 v[146:147], 0
  v_mov_b64 v[148:149], 0
  v_mov_b64 v[150:151], 0
  v_mov_b64 v[152:153], 0
  v_mov_b64 v[154:155], 0
  v_mov_b64 v[156:157], 0
  v_mov_b64 v[158:159], 0
  v_mov_b64 v[160:161], 0
  v_mov_b64 v[162:163], 0
  s_and_b64 exec, s[56:57], s[74:75]
  ds_write_b32 v241, v68 offset:41408
  s_and_b64 exec, s[54:55], s[74:75]
  s_cbranch_execz K2_fb_20
  ds_add_f32 v241, v68 offset:41408
K2_fb_20:
  s_mov_b64 exec, -1
  s_mov_b32 s60, s51
  s_branch K2_bkA1
K2_flushG_9:
  s_andn2_b64 s[56:57], s[52:53], s[54:55]
  v_cvt_pk_bf16_f32 v116, v132, v133
  v_cvt_pk_bf16_f32 v117, v134, v135
  v_cvt_pk_bf16_f32 v118, v136, v137
  v_cvt_pk_bf16_f32 v119, v138, v139
  v_cvt_pk_bf16_f32 v120, v140, v141
  v_cvt_pk_bf16_f32 v121, v142, v143
  v_cvt_pk_bf16_f32 v122, v144, v145
  v_cvt_pk_bf16_f32 v123, v146, v147
  v_cvt_pk_bf16_f32 v124, v148, v149
  v_cvt_pk_bf16_f32 v125, v150, v151
  v_cvt_pk_bf16_f32 v126, v152, v153
  v_cvt_pk_bf16_f32 v127, v154, v155
  v_cvt_pk_bf16_f32 v128, v156, v157
  v_cvt_pk_bf16_f32 v129, v158, v159
  v_cvt_pk_bf16_f32 v130, v160, v161
  v_cvt_pk_bf16_f32 v131, v162, v163
  s_and_b64 exec, s[56:57], s[72:73]
  v_mfma_f32_32x32x16_bf16 v[100:115], v[36:39], v[116:119], 0
  ds_write_b64 v243, v[116:117] offset:0
  ds_write_b64 v243, v[118:119] offset:16
  v_mfma_f32_32x32x16_bf16 v[100:115], v[40:43], v[120:123], v[100:115]
  ds_write_b64 v243, v[120:121] offset:32
  ds_write_b64 v243, v[122:123] offset:48
  v_mfma_f32_32x32x16_bf16 v[100:115], v[44:47], v[124:127], v[100:115]
  ds_write_b64 v243, v[124:125] offset:64
  ds_write_b64 v243, v[126:127] offset:80
  v_mfma_f32_32x32x16_bf16 v[100:115], v[48:51], v[128:131], v[100:115]
  ds_write_b64 v243, v[128:129] offset:96
  ds_write_b64 v243, v[130:131] offset:112
  s_and_b64 exec, s[54:55], s[72:73]
  s_cbranch_execz K2_fa_21
  s_cmp_lg_u64 s[78:79], 0
  s_cbranch_scc1 K2_fs_22
  ds_pk_add_bf16 v243, v116 offset:0
  ds_pk_add_bf16 v243, v117 offset:4
  ds_pk_add_bf16 v243, v118 offset:16
  ds_pk_add_bf16 v243, v119 offset:20
  ds_pk_add_bf16 v243, v120 offset:32
  ds_pk_add_bf16 v243, v121 offset:36
  ds_pk_add_bf16 v243, v122 offset:48
  ds_pk_add_bf16 v243, v123 offset:52
  ds_pk_add_bf16 v243, v124 offset:64
  ds_pk_add_bf16 v243, v125 offset:68
  ds_pk_add_bf16 v243, v126 offset:80
  ds_pk_add_bf16 v243, v127 offset:84
  ds_pk_add_bf16 v243, v128 offset:96
  ds_pk_add_bf16 v243, v129 offset:100
  ds_pk_add_bf16 v243, v130 offset:112
  ds_pk_add_bf16 v243, v131 offset:116
K2_fa_21:
  s_mov_b64 exec, s[52:53]
  v_mov_b64 v[132:133], 0
  v_mov_b64 v[134:135], 0
  v_mov_b64 v[136:137], 0
  v_mov_b64 v[138:139], 0
  v_mov_b64 v[140:141], 0
  v_mov_b64 v[142:143], 0
  v_mov_b64 v[144:145], 0
  v_mov_b64 v[146:147], 0
  v_mov_b64 v[148:149], 0
  v_mov_b64 v[150:151], 0
  v_mov_b64 v[152:153], 0
  v_mov_b64 v[154:155], 0
  v_mov_b64 v[156:157], 0
  v_mov_b64 v[158:159], 0
  v_mov_b64 v[160:161], 0
  v_mov_b64 v[162:163], 0
  s_and_b64 exec, s[56:57], s[74:75]
  ds_write_b32 v241, v100 offset:41408
  s_and_b64 exec, s[54:55], s[74:75]
  s_cbranch_execz K2_fb_23
  ds_add_f32 v241, v100 offset:41408
K2_fb_23:
  s_mov_b64 exec, -1
  s_mov_b32 s60, s51
  s_branch K2_bkA2
K2_flushG_10:
  s_andn2_b64 s[56:57], s[52:53], s[54:55]
  v_cvt_pk_bf16_f32 v84, v132, v133
  v_cvt_pk_bf16_f32 v85, v134, v135
  v_cvt_pk_bf16_f32 v86, v136, v137
  v_cvt_pk_bf16_f32 v87, v138, v139
  v_cvt_pk_bf16_f32 v88, v140, v141
  v_cvt_pk_bf16_f32 v89, v142, v143
  v_cvt_pk_bf16_f32 v90, v144, v145
  v_cvt_pk_bf16_f32 v91, v146, v147
  v_cvt_pk_bf16_f32 v92, v148, v149
  v_cvt_pk_bf16_f32 v93, v150, v151
  v_cvt_pk_bf16_f32 v94, v152, v153
  v_cvt_pk_bf16_f32 v95, v154, v155
  v_cvt_pk_bf16_f32 v96, v156, v157
  v_cvt_pk_bf16_f32 v97, v158, v159
  v_cvt_pk_bf16_f32 v98, v160, v161
  v_cvt_pk_bf16_f32 v99, v162, v163
  s_and_b64 exec, s[56:57], s[72:73]
  v_mfma_f32_32x32x16_bf16 v[68:83], v[36:39], v[84:87], 0
  ds_write_b64 v243, v[84:85] offset:0
  ds_write_b64 v243, v[86:87] offset:16
  v_mfma_f32_32x32x16_bf16 v[68:83], v[40:43], v[88:91], v[68:83]
  ds_write_b64 v243, v[88:89] offset:32
  ds_write_b64 v243, v[90:91] offset:48
  v_mfma_f32_32x32x16_bf16 v[68:83], v[44:47], v[92:95], v[68:83]
  ds_write_b64 v243, v[92:93] offset:64
  ds_write_b64 v243, v[94:95] offset:80
  v_mfma_f32_32x32x16_bf16 v[68:83], v[48:51], v[96:99], v[68:83]
  ds_write_b64 v243, v[96:97] offset:96
  ds_write_b64 v243, v[98:99] offset:112
  s_and_b64 exec, s[54:55], s[72:73]
  s_cbranch_execz K2_fa_24
  s_cmp_lg_u64 s[78:79], 0
  s_cbranch_scc1 K2_fs_25
  ds_pk_add_bf16 v243, v84 offset:0
  ds_pk_add_bf16 v243, v85 offset:4
  ds_pk_add_bf16 v243, v86 offset:16
  ds_pk_add_bf16 v243, v87 offset:20
  ds_pk_add_bf16 v243, v88 offset:32
  ds_pk_add_bf16 v243, v89 offset:36
  ds_pk_add_bf16 v243, v90 offset:48
  ds_pk_add_bf16 v243, v91 offset:52
  ds_pk_add_bf16 v243, v92 offset:64
  ds_pk_add_bf16 v243, v93 offset:68
  ds_pk_add_bf16 v243, v94 offset:80
  ds_pk_add_bf16 v243, v95 offset:84
  ds_pk_add_bf16 v243, v96 offset:96
  ds_pk_add_bf16 v243, v97 offset:100
  ds_pk_add_bf16 v243, v98 offset:112
  ds_pk_add_bf16 v243, v99 offset:116
K2_fa_24:
  s_mov_b64 exec, s[52:53]
  v_mov_b64 v[132:133], 0
  v_mov_b64 v[134:135], 0
  v_mov_b64 v[136:137], 0
  v_mov_b64 v[138:139], 0
  v_mov_b64 v[140:141], 0
  v_mov_b64 v[142:143], 0
  v_mov_b64 v[144:145], 0
  v_mov_b64 v[146:147], 0
  v_mov_b64 v[148:149], 0
  v_mov_b64 v[150:151], 0
  v_mov_b64 v[152:153], 0
  v_mov_b64 v[154:155], 0
  v_mov_b64 v[156:157], 0
  v_mov_b64 v[158:159], 0
  v_mov_b64 v[160:161], 0
  v_mov_b64 v[162:163], 0
  s_and_b64 exec, s[56:57], s[74:75]
  ds_write_b32 v241, v68 offset:41408
  s_and_b64 exec, s[54:55], s[74:75]
  s_cbranch_execz K2_fb_26
  ds_add_f32 v241, v68 offset:41408
K2_fb_26:
  s_mov_b64 exec, -1
  s_mov_b32 s60, s51
  s_branch K2_bkA3
K2_flushG_11:
  s_andn2_b64 s[56:57], s[52:53], s[54:55]
  v_cvt_pk_bf16_f32 v116, v132, v133
  v_cvt_pk_bf16_f32 v117, v134, v135
  v_cvt_pk_bf16_f32 v118, v136, v137
  v_cvt_pk_bf16_f32 v119, v138, v139
  v_cvt_pk_bf16_f32 v120, v140, v141
  v_cvt_pk_bf16_f32 v121, v142, v143
  v_cvt_pk_bf16_f32 v122, v144, v145
  v_cvt_pk_bf16_f32 v123, v146, v147
  v_cvt_pk_bf16_f32 v124, v148, v149
  v_cvt_pk_bf16_f32 v125, v150, v151
  v_cvt_pk_bf16_f32 v126, v152, v153
  v_cvt_pk_bf16_f32 v127, v154, v155
  v_cvt_pk_bf16_f32 v128, v156, v157
  v_cvt_pk_bf16_f32 v129, v158, v159
  v_cvt_pk_bf16_f32 v130, v160, v161
  v_cvt_pk_bf16_f32 v131, v162, v163
  s_and_b64 exec, s[56:57], s[72:73]
  v_mfma_f32_32x32x16_bf16 v[100:115], v[36:39], v[116:119], 0
  ds_write_b64 v243, v[116:117] offset:0
  ds_write_b64 v243, v[118:119] offset:16
  v_mfma_f32_32x32x16_bf16 v[100:115], v[40:43], v[120:123], v[100:115]
  ds_write_b64 v243, v[120:121] offset:32
  ds_write_b64 v243, v[122:123] offset:48
  v_mfma_f32_32x32x16_bf16 v[100:115], v[44:47], v[124:127], v[100:115]
  ds_write_b64 v243, v[124:125] offset:64
  ds_write_b64 v243, v[126:127] offset:80
  v_mfma_f32_32x32x16_bf16 v[100:115], v[48:51], v[128:131], v[100:115]
  ds_write_b64 v243, v[128:129] offset:96
  ds_write_b64 v243, v[130:131] offset:112
  s_and_b64 exec, s[54:55], s[72:73]
  s_cbranch_execz K2_fa_27
  s_cmp_lg_u64 s[78:79], 0
  s_cbranch_scc1 K2_fs_28
  ds_pk_add_bf16 v243, v116 offset:0
  ds_pk_add_bf16 v243, v117 offset:4
  ds_pk_add_bf16 v243, v118 offset:16
  ds_pk_add_bf16 v243, v119 offset:20
  ds_pk_add_bf16 v243, v120 offset:32
  ds_pk_add_bf16 v243, v121 offset:36
  ds_pk_add_bf16 v243, v122 offset:48
  ds_pk_add_bf16 v243, v123 offset:52
  ds_pk_add_bf16 v243, v124 offset:64
  ds_pk_add_bf16 v243, v125 offset:68
  ds_pk_add_bf16 v243, v126 offset:80
  ds_pk_add_bf16 v243, v127 offset:84
  ds_pk_add_bf16 v243, v128 offset:96
  ds_pk_add_bf16 v243, v129 offset:100
  ds_pk_add_bf16 v243, v130 offset:112
  ds_pk_add_bf16 v243, v131 offset:116
K2_fa_27:
  s_mov_b64 exec, s[52:53]
  v_mov_b64 v[132:133], 0
  v_mov_b64 v[134:135], 0
  v_mov_b64 v[136:137], 0
  v_mov_b64 v[138:139], 0
  v_mov_b64 v[140:141], 0
  v_mov_b64 v[142:143], 0
  v_mov_b64 v[144:145], 0
  v_mov_b64 v[146:147], 0
  v_mov_b64 v[148:149], 0
  v_mov_b64 v[150:151], 0
  v_mov_b64 v[152:153], 0
  v_mov_b64 v[154:155], 0
  v_mov_b64 v[156:157], 0
  v_mov_b64 v[158:159], 0
  v_mov_b64 v[160:161], 0
  v_mov_b64 v[162:163], 0
  s_and_b64 exec, s[56:57], s[74:75]
  ds_write_b32 v241, v100 offset:41408
  s_and_b64 exec, s[54:55], s[74:75]
  s_cbranch_execz K2_fb_29
  ds_add_f32 v241, v100 offset:41408
K2_fb_29:
  s_mov_b64 exec, -1
  s_mov_b32 s60, s51
  s_branch K2_bkB0
K2_flushG_12:
  s_andn2_b64 s[56:57], s[52:53], s[54:55]
  v_cvt_pk_bf16_f32 v84, v132, v133
  v_cvt_pk_bf16_f32 v85, v134, v135
  v_cvt_pk_bf16_f32 v86, v136, v137
  v_cvt_pk_bf16_f32 v87, v138, v139
  v_cvt_pk_bf16_f32 v88, v140, v141
  v_cvt_pk_bf16_f32 v89, v142, v143
  v_cvt_pk_bf16_f32 v90, v144, v145
  v_cvt_pk_bf16_f32 v91, v146, v147
  v_cvt_pk_bf16_f32 v92, v148, v149
  v_cvt_pk_bf16_f32 v93, v150, v151
  v_cvt_pk_bf16_f32 v94, v152, v153
  v_cvt_pk_bf16_f32 v95, v154, v155
  v_cvt_pk_bf16_f32 v96, v156, v157
  v_cvt_pk_bf16_f32 v97, v158, v159
  v_cvt_pk_bf16_f32 v98, v160, v161
  v_cvt_pk_bf16_f32 v99, v162, v163
  s_and_b64 exec, s[56:57], s[72:73]
  v_mfma_f32_32x32x16_bf16 v[68:83], v[36:39], v[84:87], 0
  ds_write_b64 v243, v[84:85] offset:0
  ds_write_b64 v243, v[86:87] offset:16
  v_mfma_f32_32x32x16_bf16 v[68:83], v[40:43], v[88:91], v[68:83]
  ds_write_b64 v243, v[88:89] offset:32
  ds_write_b64 v243, v[90:91] offset:48
  v_mfma_f32_32x32x16_bf16 v[68:83], v[44:47], v[92:95], v[68:83]
  ds_write_b64 v243, v[92:93] offset:64
  ds_write_b64 v243, v[94:95] offset:80
  v_mfma_f32_32x32x16_bf16 v[68:83], v[48:51], v[96:99], v[68:83]
  ds_write_b64 v243, v[96:97] offset:96
  ds_write_b64 v243, v[98:99] offset:112
  s_and_b64 exec, s[54:55], s[72:73]
  s_cbranch_execz K2_fa_30
  s_cmp_lg_u64 s[78:79], 0
  s_cbranch_scc1 K2_fs_31
  ds_pk_add_bf16 v243, v84 offset:0
  ds_pk_add_bf16 v243, v85 offset:4
  ds_pk_add_bf16 v243, v86 offset:16
  ds_pk_add_bf16 v243, v87 offset:20
  ds_pk_add_bf16 v243, v88 offset:32
  ds_pk_add_bf16 v243, v89 offset:36
  ds_pk_add_bf16 v243, v90 offset:48
  ds_pk_add_bf16 v243, v91 offset:52
  ds_pk_add_bf16 v243, v92 offset:64
  ds_pk_add_bf16 v243, v93 offset:68
  ds_pk_add_bf16 v243, v94 offset:80
  ds_pk_add_bf16 v243, v95 offset:84
  ds_pk_add_bf16 v243, v96 offset:96
  ds_pk_add_bf16 v243, v97 offset:100
  ds_pk_add_bf16 v243, v98 offset:112
  ds_pk_add_bf16 v243, v99 offset:116
K2_fa_30:
  s_mov_b64 exec, s[52:53]
  v_mov_b64 v[132:133], 0
  v_mov_b64 v[134:135], 0
  v_mov_b64 v[136:137], 0
  v_mov_b64 v[138:139], 0
  v_mov_b64 v[140:141], 0
  v_mov_b64 v[142:143], 0
  v_mov_b64 v[144:145], 0
  v_mov_b64 v[146:147], 0
  v_mov_b64 v[148:149], 0
  v_mov_b64 v[150:151], 0
  v_mov_b64 v[152:153], 0
  v_mov_b64 v[154:155], 0
  v_mov_b64 v[156:157], 0
  v_mov_b64 v[158:159], 0
  v_mov_b64 v[160:161], 0
  v_mov_b64 v[162:163], 0
  s_and_b64 exec, s[56:57], s[74:75]
  ds_write_b32 v241, v68 offset:41408
  s_and_b64 exec, s[54:55], s[74:75]
  s_cbranch_execz K2_fb_32
  ds_add_f32 v241, v68 offset:41408
K2_fb_32:
  s_mov_b64 exec, -1
  s_mov_b32 s60, s51
  s_branch K2_bkB1
K2_flushG_13:
  s_andn2_b64 s[56:57], s[52:53], s[54:55]
  v_cvt_pk_bf16_f32 v116, v132, v133
  v_cvt_pk_bf16_f32 v117, v134, v135
  v_cvt_pk_bf16_f32 v118, v136, v137
  v_cvt_pk_bf16_f32 v119, v138, v139
  v_cvt_pk_bf16_f32 v120, v140, v141
  v_cvt_pk_bf16_f32 v121, v142, v143
  v_cvt_pk_bf16_f32 v122, v144, v145
  v_cvt_pk_bf16_f32 v123, v146, v147
  v_cvt_pk_bf16_f32 v124, v148, v149
  v_cvt_pk_bf16_f32 v125, v150, v151
  v_cvt_pk_bf16_f32 v126, v152, v153
  v_cvt_pk_bf16_f32 v127, v154, v155
  v_cvt_pk_bf16_f32 v128, v156, v157
  v_cvt_pk_bf16_f32 v129, v158, v159
  v_cvt_pk_bf16_f32 v130, v160, v161
  v_cvt_pk_bf16_f32 v131, v162, v163
  s_and_b64 exec, s[56:57], s[72:73]
  v_mfma_f32_32x32x16_bf16 v[100:115], v[36:39], v[116:119], 0
  ds_write_b64 v243, v[116:117] offset:0
  ds_write_b64 v243, v[118:119] offset:16
  v_mfma_f32_32x32x16_bf16 v[100:115], v[40:43], v[120:123], v[100:115]
  ds_write_b64 v243, v[120:121] offset:32
  ds_write_b64 v243, v[122:123] offset:48
  v_mfma_f32_32x32x16_bf16 v[100:115], v[44:47], v[124:127], v[100:115]
  ds_write_b64 v243, v[124:125] offset:64
  ds_write_b64 v243, v[126:127] offset:80
  v_mfma_f32_32x32x16_bf16 v[100:115], v[48:51], v[128:131], v[100:115]
  ds_write_b64 v243, v[128:129] offset:96
  ds_write_b64 v243, v[130:131] offset:112
  s_and_b64 exec, s[54:55], s[72:73]
  s_cbranch_execz K2_fa_33
  s_cmp_lg_u64 s[78:79], 0
  s_cbranch_scc1 K2_fs_34
  ds_pk_add_bf16 v243, v116 offset:0
  ds_pk_add_bf16 v243, v117 offset:4
  ds_pk_add_bf16 v243, v118 offset:16
  ds_pk_add_bf16 v243, v119 offset:20
  ds_pk_add_bf16 v243, v120 offset:32
  ds_pk_add_bf16 v243, v121 offset:36
  ds_pk_add_bf16 v243, v122 offset:48
  ds_pk_add_bf16 v243, v123 offset:52
  ds_pk_add_bf16 v243, v124 offset:64
  ds_pk_add_bf16 v243, v125 offset:68
  ds_pk_add_bf16 v243, v126 offset:80
  ds_pk_add_bf16 v243, v127 offset:84
  ds_pk_add_bf16 v243, v128 offset:96
  ds_pk_add_bf16 v243, v129 offset:100
  ds_pk_add_bf16 v243, v130 offset:112
  ds_pk_add_bf16 v243, v131 offset:116
K2_fa_33:
  s_mov_b64 exec, s[52:53]
  v_mov_b64 v[132:133], 0
  v_mov_b64 v[134:135], 0
  v_mov_b64 v[136:137], 0
  v_mov_b64 v[138:139], 0
  v_mov_b64 v[140:141], 0
  v_mov_b64 v[142:143], 0
  v_mov_b64 v[144:145], 0
  v_mov_b64 v[146:147], 0
  v_mov_b64 v[148:149], 0
  v_mov_b64 v[150:151], 0
  v_mov_b64 v[152:153], 0
  v_mov_b64 v[154:155], 0
  v_mov_b64 v[156:157], 0
  v_mov_b64 v[158:159], 0
  v_mov_b64 v[160:161], 0
  v_mov_b64 v[162:163], 0
  s_and_b64 exec, s[56:57], s[74:75]
  ds_write_b32 v241, v100 offset:41408
  s_and_b64 exec, s[54:55], s[74:75]
  s_cbranch_execz K2_fb_35
  ds_add_f32 v241, v100 offset:41408
K2_fb_35:
  s_mov_b64 exec, -1
  s_mov_b32 s60, s51
  s_branch K2_bkB2
K2_flushG_14:
  s_andn2_b64 s[56:57], s[52:53], s[54:55]
  v_cvt_pk_bf16_f32 v84, v132, v133
  v_cvt_pk_bf16_f32 v85, v134, v135
  v_cvt_pk_bf16_f32 v86, v136, v137
  v_cvt_pk_bf16_f32 v87, v138, v139
  v_cvt_pk_bf16_f32 v88, v140, v141
  v_cvt_pk_bf16_f32 v89, v142, v143
  v_cvt_pk_bf16_f32 v90, v144, v145
  v_cvt_pk_bf16_f32 v91, v146, v147
  v_cvt_pk_bf16_f32 v92, v148, v149
  v_cvt_pk_bf16_f32 v93, v150, v151
  v_cvt_pk_bf16_f32 v94, v152, v153
  v_cvt_pk_bf16_f32 v95, v154, v155
  v_cvt_pk_bf16_f32 v96, v156, v157
  v_cvt_pk_bf16_f32 v97, v158, v159
  v_cvt_pk_bf16_f32 v98, v160, v161
  v_cvt_pk_bf16_f32 v99, v162, v163
  s_and_b64 exec, s[56:57], s[72:73]
  v_mfma_f32_32x32x16_bf16 v[68:83], v[36:39], v[84:87], 0
  ds_write_b64 v243, v[84:85] offset:0
  ds_write_b64 v243, v[86:87] offset:16
  v_mfma_f32_32x32x16_bf16 v[68:83], v[40:43], v[88:91], v[68:83]
  ds_write_b64 v243, v[88:89] offset:32
  ds_write_b64 v243, v[90:91] offset:48
  v_mfma_f32_32x32x16_bf16 v[68:83], v[44:47], v[92:95], v[68:83]
  ds_write_b64 v243, v[92:93] offset:64
  ds_write_b64 v243, v[94:95] offset:80
  v_mfma_f32_32x32x16_bf16 v[68:83], v[48:51], v[96:99], v[68:83]
  ds_write_b64 v243, v[96:97] offset:96
  ds_write_b64 v243, v[98:99] offset:112
  s_and_b64 exec, s[54:55], s[72:73]
  s_cbranch_execz K2_fa_36
  s_cmp_lg_u64 s[78:79], 0
  s_cbranch_scc1 K2_fs_37
  ds_pk_add_bf16 v243, v84 offset:0
  ds_pk_add_bf16 v243, v85 offset:4
  ds_pk_add_bf16 v243, v86 offset:16
  ds_pk_add_bf16 v243, v87 offset:20
  ds_pk_add_bf16 v243, v88 offset:32
  ds_pk_add_bf16 v243, v89 offset:36
  ds_pk_add_bf16 v243, v90 offset:48
  ds_pk_add_bf16 v243, v91 offset:52
  ds_pk_add_bf16 v243, v92 offset:64
  ds_pk_add_bf16 v243, v93 offset:68
  ds_pk_add_bf16 v243, v94 offset:80
  ds_pk_add_bf16 v243, v95 offset:84
  ds_pk_add_bf16 v243, v96 offset:96
  ds_pk_add_bf16 v243, v97 offset:100
  ds_pk_add_bf16 v243, v98 offset:112
  ds_pk_add_bf16 v243, v99 offset:116
K2_fa_36:
  s_mov_b64 exec, s[52:53]
  v_mov_b64 v[132:133], 0
  v_mov_b64 v[134:135], 0
  v_mov_b64 v[136:137], 0
  v_mov_b64 v[138:139], 0
  v_mov_b64 v[140:141], 0
  v_mov_b64 v[142:143], 0
  v_mov_b64 v[144:145], 0
  v_mov_b64 v[146:147], 0
  v_mov_b64 v[148:149], 0
  v_mov_b64 v[150:151], 0
  v_mov_b64 v[152:153], 0
  v_mov_b64 v[154:155], 0
  v_mov_b64 v[156:157], 0
  v_mov_b64 v[158:159], 0
  v_mov_b64 v[160:161], 0
  v_mov_b64 v[162:163], 0
  s_and_b64 exec, s[56:57], s[74:75]
  ds_write_b32 v241, v68 offset:41408
  s_and_b64 exec, s[54:55], s[74:75]
  s_cbranch_execz K2_fb_38
  ds_add_f32 v241, v68 offset:41408
K2_fb_38:
  s_mov_b64 exec, -1
  s_mov_b32 s60, s51
  s_branch K2_bkB3
K2_fs_5:
  v_lshrrev_b32 v242, 5, v0
  v_lshlrev_b32 v242, 4, v242
  v_lshl_add_u32 v242, v241, 4, v242
  buffer_atomic_add_f32 v132, v242, s[32:35], 0 offen offset:0
  buffer_atomic_add_f32 v133, v242, s[32:35], 0 offen offset:4
  buffer_atomic_add_f32 v134, v242, s[32:35], 0 offen offset:8
  buffer_atomic_add_f32 v135, v242, s[32:35], 0 offen offset:12
  buffer_atomic_add_f32 v136, v242, s[32:35], 0 offen offset:32
  buffer_atomic_add_f32 v137, v242, s[32:35], 0 offen offset:36
  buffer_atomic_add_f32 v138, v242, s[32:35], 0 offen offset:40
  buffer_atomic_add_f32 v139, v242, s[32:35], 0 offen offset:44
  buffer_atomic_add_f32 v140, v242, s[32:35], 0 offen offset:64
  buffer_atomic_add_f32 v141, v242, s[32:35], 0 offen offset:68
  buffer_atomic_add_f32 v142, v242, s[32:35], 0 offen offset:72
  buffer_atomic_add_f32 v143, v242, s[32:35], 0 offen offset:76
  buffer_atomic_add_f32 v144, v242, s[32:35], 0 offen offset:96
  buffer_atomic_add_f32 v145, v242, s[32:35], 0 offen offset:100
  buffer_atomic_add_f32 v146, v242, s[32:35], 0 offen offset:104
  buffer_atomic_add_f32 v147, v242, s[32:35], 0 offen offset:108
  buffer_atomic_add_f32 v148, v242, s[32:35], 0 offen offset:128
  buffer_atomic_add_f32 v149, v242, s[32:35], 0 offen offset:132
  buffer_atomic_add_f32 v150, v242, s[32:35], 0 offen offset:136
  buffer_atomic_add_f32 v151, v242, s[32:35], 0 offen offset:140
  buffer_atomic_add_f32 v152, v242, s[32:35], 0 offen offset:160
  buffer_atomic_add_f32 v153, v242, s[32:35], 0 offen offset:164
  buffer_atomic_add_f32 v154, v242, s[32:35], 0 offen offset:168
  buffer_atomic_add_f32 v155, v242, s[32:35], 0 offen offset:172
  buffer_atomic_add_f32 v156, v242, s[32:35], 0 offen offset:192
  buffer_atomic_add_f32 v157, v242, s[32:35], 0 offen offset:196
  buffer_atomic_add_f32 v158, v242, s[32:35], 0 offen offset:200
  buffer_atomic_add_f32 v159, v242, s[32:35], 0 offen offset:204
  buffer_atomic_add_f32 v160, v242, s[32:35], 0 offen offset:224
  buffer_atomic_add_f32 v161, v242, s[32:35], 0 offen offset:228
  buffer_atomic_add_f32 v162, v242, s[32:35], 0 offen offset:232
  buffer_atomic_add_f32 v163, v242, s[32:35], 0 offen offset:236
  s_branch K2_fa_4
K2_fs_16:
  v_lshrrev_b32 v242, 5, v0
  v_lshlrev_b32 v242, 4, v242
  v_lshl_add_u32 v242, v241, 4, v242
  buffer_atomic_add_f32 v132, v242, s[32:35], 0 offen offset:0
  buffer_atomic_add_f32 v133, v242, s[32:35], 0 offen offset:4
  buffer_atomic_add_f32 v134, v242, s[32:35], 0 offen offset:8
  buffer_atomic_add_f32 v135, v242, s[32:35], 0 offen offset:12
  buffer_atomic_add_f32 v136, v242, s[32:35], 0 offen offset:32
  buffer_atomic_add_f32 v137, v242, s[32:35], 0 offen offset:36
  buffer_atomic_add_f32 v138, v242, s[32:35], 0 offen offset:40
  buffer_atomic_add_f32 v139, v242, s[32:35], 0 offen offset:44
  buffer_atomic_add_f32 v140, v242, s[32:35], 0 offen offset:64
  buffer_atomic_add_f32 v141, v242, s[32:35], 0 offen offset:68
  buffer_atomic_add_f32 v142, v242, s[32:35], 0 offen offset:72
  buffer_atomic_add_f32 v143, v242, s[32:35], 0 offen offset:76
  buffer_atomic_add_f32 v144, v242, s[32:35], 0 offen offset:96
  buffer_atomic_add_f32 v145, v242, s[32:35], 0 offen offset:100
  buffer_atomic_add_f32 v146, v242, s[32:35], 0 offen offset:104
  buffer_atomic_add_f32 v147, v242, s[32:35], 0 offen offset:108
  buffer_atomic_add_f32 v148, v242, s[32:35], 0 offen offset:128
  buffer_atomic_add_f32 v149, v242, s[32:35], 0 offen offset:132
  buffer_atomic_add_f32 v150, v242, s[32:35], 0 offen offset:136
  buffer_atomic_add_f32 v151, v242, s[32:35], 0 offen offset:140
  buffer_atomic_add_f32 v152, v242, s[32:35], 0 offen offset:160
  buffer_atomic_add_f32 v153, v242, s[32:35], 0 offen offset:164
  buffer_atomic_add_f32 v154, v242, s[32:35], 0 offen offset:168
  buffer_atomic_add_f32 v155, v242, s[32:35], 0 offen offset:172
  buffer_atomic_add_f32 v156, v242, s[32:35], 0 offen offset:192
  buffer_atomic_add_f32 v157, v242, s[32:35], 0 offen offset:196
  buffer_atomic_add_f32 v158, v242, s[32:35], 0 offen offset:200
  buffer_atomic_add_f32 v159, v242, s[32:35], 0 offen offset:204
  buffer_atomic_add_f32 v160, v242, s[32:35], 0 offen offset:224
  buffer_atomic_add_f32 v161, v242, s[32:35], 0 offen offset:228
  buffer_atomic_add_f32 v162, v242, s[32:35], 0 offen offset:232
  buffer_atomic_add_f32 v163, v242, s[32:35], 0 offen offset:236
  s_branch K2_fa_15
K2_fs_19:
  v_lshrrev_b32 v242, 5, v0
  v_lshlrev_b32 v242, 4, v242
  v_lshl_add_u32 v242, v241, 4, v242
  buffer_atomic_add_f32 v132, v242, s[32:35], 0 offen offset:0
  buffer_atomic_add_f32 v133, v242, s[32:35], 0 offen offset:4
  buffer_atomic_add_f32 v134, v242, s[32:35], 0 offen offset:8
  buffer_atomic_add_f32 v135, v242, s[32:35], 0 offen offset:12
  buffer_atomic_add_f32 v136, v242, s[32:35], 0 offen offset:32
  buffer_atomic_add_f32 v137, v242, s[32:35], 0 offen offset:36
  buffer_atomic_add_f32 v138, v242, s[32:35], 0 offen offset:40
  buffer_atomic_add_f32 v139, v242, s[32:35], 0 offen offset:44
  buffer_atomic_add_f32 v140, v242, s[32:35], 0 offen offset:64
  buffer_atomic_add_f32 v141, v242, s[32:35], 0 offen offset:68
  buffer_atomic_add_f32 v142, v242, s[32:35], 0 offen offset:72
  buffer_atomic_add_f32 v143, v242, s[32:35], 0 offen offset:76
  buffer_atomic_add_f32 v144, v242, s[32:35], 0 offen offset:96
  buffer_atomic_add_f32 v145, v242, s[32:35], 0 offen offset:100
  buffer_atomic_add_f32 v146, v242, s[32:35], 0 offen offset:104
  buffer_atomic_add_f32 v147, v242, s[32:35], 0 offen offset:108
  buffer_atomic_add_f32 v148, v242, s[32:35], 0 offen offset:128
  buffer_atomic_add_f32 v149, v242, s[32:35], 0 offen offset:132
  buffer_atomic_add_f32 v150, v242, s[32:35], 0 offen offset:136
  buffer_atomic_add_f32 v151, v242, s[32:35], 0 offen offset:140
  buffer_atomic_add_f32 v152, v242, s[32:35], 0 offen offset:160
  buffer_atomic_add_f32 v153, v242, s[32:35], 0 offen offset:164
  buffer_atomic_add_f32 v154, v242, s[32:35], 0 offen offset:168
  buffer_atomic_add_f32 v155, v242, s[32:35], 0 offen offset:172
  buffer_atomic_add_f32 v156, v242, s[32:35], 0 offen offset:192
  buffer_atomic_add_f32 v157, v242, s[32:35], 0 offen offset:196
  buffer_atomic_add_f32 v158, v242, s[32:35], 0 offen offset:200
  buffer_atomic_add_f32 v159, v242, s[32:35], 0 offen offset:204
  buffer_atomic_add_f32 v160, v242, s[32:35], 0 offen offset:224
  buffer_atomic_add_f32 v161, v242, s[32:35], 0 offen offset:228
  buffer_atomic_add_f32 v162, v242, s[32:35], 0 offen offset:232
  buffer_atomic_add_f32 v163, v242, s[32:35], 0 offen offset:236
  s_branch K2_fa_18
K2_fs_22:
  v_lshrrev_b32 v242, 5, v0
  v_lshlrev_b32 v242, 4, v242
  v_lshl_add_u32 v242, v241, 4, v242
  buffer_atomic_add_f32 v132, v242, s[32:35], 0 offen offset:0
  buffer_atomic_add_f32 v133, v242, s[32:35], 0 offen offset:4
  buffer_atomic_add_f32 v134, v242, s[32:35], 0 offen offset:8
  buffer_atomic_add_f32 v135, v242, s[32:35], 0 offen offset:12
  buffer_atomic_add_f32 v136, v242, s[32:35], 0 offen offset:32
  buffer_atomic_add_f32 v137, v242, s[32:35], 0 offen offset:36
  buffer_atomic_add_f32 v138, v242, s[32:35], 0 offen offset:40
  buffer_atomic_add_f32 v139, v242, s[32:35], 0 offen offset:44
  buffer_atomic_add_f32 v140, v242, s[32:35], 0 offen offset:64
  buffer_atomic_add_f32 v141, v242, s[32:35], 0 offen offset:68
  buffer_atomic_add_f32 v142, v242, s[32:35], 0 offen offset:72
  buffer_atomic_add_f32 v143, v242, s[32:35], 0 offen offset:76
  buffer_atomic_add_f32 v144, v242, s[32:35], 0 offen offset:96
  buffer_atomic_add_f32 v145, v242, s[32:35], 0 offen offset:100
  buffer_atomic_add_f32 v146, v242, s[32:35], 0 offen offset:104
  buffer_atomic_add_f32 v147, v242, s[32:35], 0 offen offset:108
  buffer_atomic_add_f32 v148, v242, s[32:35], 0 offen offset:128
  buffer_atomic_add_f32 v149, v242, s[32:35], 0 offen offset:132
  buffer_atomic_add_f32 v150, v242, s[32:35], 0 offen offset:136
  buffer_atomic_add_f32 v151, v242, s[32:35], 0 offen offset:140
  buffer_atomic_add_f32 v152, v242, s[32:35], 0 offen offset:160
  buffer_atomic_add_f32 v153, v242, s[32:35], 0 offen offset:164
  buffer_atomic_add_f32 v154, v242, s[32:35], 0 offen offset:168
  buffer_atomic_add_f32 v155, v242, s[32:35], 0 offen offset:172
  buffer_atomic_add_f32 v156, v242, s[32:35], 0 offen offset:192
  buffer_atomic_add_f32 v157, v242, s[32:35], 0 offen offset:196
  buffer_atomic_add_f32 v158, v242, s[32:35], 0 offen offset:200
  buffer_atomic_add_f32 v159, v242, s[32:35], 0 offen offset:204
  buffer_atomic_add_f32 v160, v242, s[32:35], 0 offen offset:224
  buffer_atomic_add_f32 v161, v242, s[32:35], 0 offen offset:228
  buffer_atomic_add_f32 v162, v242, s[32:35], 0 offen offset:232
  buffer_atomic_add_f32 v163, v242, s[32:35], 0 offen offset:236
  s_branch K2_fa_21
K2_fs_25:
  v_lshrrev_b32 v242, 5, v0
  v_lshlrev_b32 v242, 4, v242
  v_lshl_add_u32 v242, v241, 4, v242
  buffer_atomic_add_f32 v132, v242, s[32:35], 0 offen offset:0
  buffer_atomic_add_f32 v133, v242, s[32:35], 0 offen offset:4
  buffer_atomic_add_f32 v134, v242, s[32:35], 0 offen offset:8
  buffer_atomic_add_f32 v135, v242, s[32:35], 0 offen offset:12
  buffer_atomic_add_f32 v136, v242, s[32:35], 0 offen offset:32
  buffer_atomic_add_f32 v137, v242, s[32:35], 0 offen offset:36
  buffer_atomic_add_f32 v138, v242, s[32:35], 0 offen offset:40
  buffer_atomic_add_f32 v139, v242, s[32:35], 0 offen offset:44
  buffer_atomic_add_f32 v140, v242, s[32:35], 0 offen offset:64
  buffer_atomic_add_f32 v141, v242, s[32:35], 0 offen offset:68
  buffer_atomic_add_f32 v142, v242, s[32:35], 0 offen offset:72
  buffer_atomic_add_f32 v143, v242, s[32:35], 0 offen offset:76
  buffer_atomic_add_f32 v144, v242, s[32:35], 0 offen offset:96
  buffer_atomic_add_f32 v145, v242, s[32:35], 0 offen offset:100
  buffer_atomic_add_f32 v146, v242, s[32:35], 0 offen offset:104
  buffer_atomic_add_f32 v147, v242, s[32:35], 0 offen offset:108
  buffer_atomic_add_f32 v148, v242, s[32:35], 0 offen offset:128
  buffer_atomic_add_f32 v149, v242, s[32:35], 0 offen offset:132
  buffer_atomic_add_f32 v150, v242, s[32:35], 0 offen offset:136
  buffer_atomic_add_f32 v151, v242, s[32:35], 0 offen offset:140
  buffer_atomic_add_f32 v152, v242, s[32:35], 0 offen offset:160
  buffer_atomic_add_f32 v153, v242, s[32:35], 0 offen offset:164
  buffer_atomic_add_f32 v154, v242, s[32:35], 0 offen offset:168
  buffer_atomic_add_f32 v155, v242, s[32:35], 0 offen offset:172
  buffer_atomic_add_f32 v156, v242, s[32:35], 0 offen offset:192
  buffer_atomic_add_f32 v157, v242, s[32:35], 0 offen offset:196
  buffer_atomic_add_f32 v158, v242, s[32:35], 0 offen offset:200
  buffer_atomic_add_f32 v159, v242, s[32:35], 0 offen offset:204
  buffer_atomic_add_f32 v160, v242, s[32:35], 0 offen offset:224
  buffer_atomic_add_f32 v161, v242, s[32:35], 0 offen offset:228
  buffer_atomic_add_f32 v162, v242, s[32:35], 0 offen offset:232
  buffer_atomic_add_f32 v163, v242, s[32:35], 0 offen offset:236
  s_branch K2_fa_24
K2_fs_28:
  v_lshrrev_b32 v242, 5, v0
  v_lshlrev_b32 v242, 4, v242
  v_lshl_add_u32 v242, v241, 4, v242
  buffer_atomic_add_f32 v132, v242, s[32:35], 0 offen offset:0
  buffer_atomic_add_f32 v133, v242, s[32:35], 0 offen offset:4
  buffer_atomic_add_f32 v134, v242, s[32:35], 0 offen offset:8
  buffer_atomic_add_f32 v135, v242, s[32:35], 0 offen offset:12
  buffer_atomic_add_f32 v136, v242, s[32:35], 0 offen offset:32
  buffer_atomic_add_f32 v137, v242, s[32:35], 0 offen offset:36
  buffer_atomic_add_f32 v138, v242, s[32:35], 0 offen offset:40
  buffer_atomic_add_f32 v139, v242, s[32:35], 0 offen offset:44
  buffer_atomic_add_f32 v140, v242, s[32:35], 0 offen offset:64
  buffer_atomic_add_f32 v141, v242, s[32:35], 0 offen offset:68
  buffer_atomic_add_f32 v142, v242, s[32:35], 0 offen offset:72
  buffer_atomic_add_f32 v143, v242, s[32:35], 0 offen offset:76
  buffer_atomic_add_f32 v144, v242, s[32:35], 0 offen offset:96
  buffer_atomic_add_f32 v145, v242, s[32:35], 0 offen offset:100
  buffer_atomic_add_f32 v146, v242, s[32:35], 0 offen offset:104
  buffer_atomic_add_f32 v147, v242, s[32:35], 0 offen offset:108
  buffer_atomic_add_f32 v148, v242, s[32:35], 0 offen offset:128
  buffer_atomic_add_f32 v149, v242, s[32:35], 0 offen offset:132
  buffer_atomic_add_f32 v150, v242, s[32:35], 0 offen offset:136
  buffer_atomic_add_f32 v151, v242, s[32:35], 0 offen offset:140
  buffer_atomic_add_f32 v152, v242, s[32:35], 0 offen offset:160
  buffer_atomic_add_f32 v153, v242, s[32:35], 0 offen offset:164
  buffer_atomic_add_f32 v154, v242, s[32:35], 0 offen offset:168
  buffer_atomic_add_f32 v155, v242, s[32:35], 0 offen offset:172
  buffer_atomic_add_f32 v156, v242, s[32:35], 0 offen offset:192
  buffer_atomic_add_f32 v157, v242, s[32:35], 0 offen offset:196
  buffer_atomic_add_f32 v158, v242, s[32:35], 0 offen offset:200
  buffer_atomic_add_f32 v159, v242, s[32:35], 0 offen offset:204
  buffer_atomic_add_f32 v160, v242, s[32:35], 0 offen offset:224
  buffer_atomic_add_f32 v161, v242, s[32:35], 0 offen offset:228
  buffer_atomic_add_f32 v162, v242, s[32:35], 0 offen offset:232
  buffer_atomic_add_f32 v163, v242, s[32:35], 0 offen offset:236
  s_branch K2_fa_27
K2_fs_31:
  v_lshrrev_b32 v242, 5, v0
  v_lshlrev_b32 v242, 4, v242
  v_lshl_add_u32 v242, v241, 4, v242
  buffer_atomic_add_f32 v132, v242, s[32:35], 0 offen offset:0
  buffer_atomic_add_f32 v133, v242, s[32:35], 0 offen offset:4
  buffer_atomic_add_f32 v134, v242, s[32:35], 0 offen offset:8
  buffer_atomic_add_f32 v135, v242, s[32:35], 0 offen offset:12
  buffer_atomic_add_f32 v136, v242, s[32:35], 0 offen offset:32
  buffer_atomic_add_f32 v137, v242, s[32:35], 0 offen offset:36
  buffer_atomic_add_f32 v138, v242, s[32:35], 0 offen offset:40
  buffer_atomic_add_f32 v139, v242, s[32:35], 0 offen offset:44
  buffer_atomic_add_f32 v140, v242, s[32:35], 0 offen offset:64
  buffer_atomic_add_f32 v141, v242, s[32:35], 0 offen offset:68
  buffer_atomic_add_f32 v142, v242, s[32:35], 0 offen offset:72
  buffer_atomic_add_f32 v143, v242, s[32:35], 0 offen offset:76
  buffer_atomic_add_f32 v144, v242, s[32:35], 0 offen offset:96
  buffer_atomic_add_f32 v145, v242, s[32:35], 0 offen offset:100
  buffer_atomic_add_f32 v146, v242, s[32:35], 0 offen offset:104
  buffer_atomic_add_f32 v147, v242, s[32:35], 0 offen offset:108
  buffer_atomic_add_f32 v148, v242, s[32:35], 0 offen offset:128
  buffer_atomic_add_f32 v149, v242, s[32:35], 0 offen offset:132
  buffer_atomic_add_f32 v150, v242, s[32:35], 0 offen offset:136
  buffer_atomic_add_f32 v151, v242, s[32:35], 0 offen offset:140
  buffer_atomic_add_f32 v152, v242, s[32:35], 0 offen offset:160
  buffer_atomic_add_f32 v153, v242, s[32:35], 0 offen offset:164
  buffer_atomic_add_f32 v154, v242, s[32:35], 0 offen offset:168
  buffer_atomic_add_f32 v155, v242, s[32:35], 0 offen offset:172
  buffer_atomic_add_f32 v156, v242, s[32:35], 0 offen offset:192
  buffer_atomic_add_f32 v157, v242, s[32:35], 0 offen offset:196
  buffer_atomic_add_f32 v158, v242, s[32:35], 0 offen offset:200
  buffer_atomic_add_f32 v159, v242, s[32:35], 0 offen offset:204
  buffer_atomic_add_f32 v160, v242, s[32:35], 0 offen offset:224
  buffer_atomic_add_f32 v161, v242, s[32:35], 0 offen offset:228
  buffer_atomic_add_f32 v162, v242, s[32:35], 0 offen offset:232
  buffer_atomic_add_f32 v163, v242, s[32:35], 0 offen offset:236
  s_branch K2_fa_30
K2_fs_34:
  v_lshrrev_b32 v242, 5, v0
  v_lshlrev_b32 v242, 4, v242
  v_lshl_add_u32 v242, v241, 4, v242
  buffer_atomic_add_f32 v132, v242, s[32:35], 0 offen offset:0
  buffer_atomic_add_f32 v133, v242, s[32:35], 0 offen offset:4
  buffer_atomic_add_f32 v134, v242, s[32:35], 0 offen offset:8
  buffer_atomic_add_f32 v135, v242, s[32:35], 0 offen offset:12
  buffer_atomic_add_f32 v136, v242, s[32:35], 0 offen offset:32
  buffer_atomic_add_f32 v137, v242, s[32:35], 0 offen offset:36
  buffer_atomic_add_f32 v138, v242, s[32:35], 0 offen offset:40
  buffer_atomic_add_f32 v139, v242, s[32:35], 0 offen offset:44
  buffer_atomic_add_f32 v140, v242, s[32:35], 0 offen offset:64
  buffer_atomic_add_f32 v141, v242, s[32:35], 0 offen offset:68
  buffer_atomic_add_f32 v142, v242, s[32:35], 0 offen offset:72
  buffer_atomic_add_f32 v143, v242, s[32:35], 0 offen offset:76
  buffer_atomic_add_f32 v144, v242, s[32:35], 0 offen offset:96
  buffer_atomic_add_f32 v145, v242, s[32:35], 0 offen offset:100
  buffer_atomic_add_f32 v146, v242, s[32:35], 0 offen offset:104
  buffer_atomic_add_f32 v147, v242, s[32:35], 0 offen offset:108
  buffer_atomic_add_f32 v148, v242, s[32:35], 0 offen offset:128
  buffer_atomic_add_f32 v149, v242, s[32:35], 0 offen offset:132
  buffer_atomic_add_f32 v150, v242, s[32:35], 0 offen offset:136
  buffer_atomic_add_f32 v151, v242, s[32:35], 0 offen offset:140
  buffer_atomic_add_f32 v152, v242, s[32:35], 0 offen offset:160
  buffer_atomic_add_f32 v153, v242, s[32:35], 0 offen offset:164
  buffer_atomic_add_f32 v154, v242, s[32:35], 0 offen offset:168
  buffer_atomic_add_f32 v155, v242, s[32:35], 0 offen offset:172
  buffer_atomic_add_f32 v156, v242, s[32:35], 0 offen offset:192
  buffer_atomic_add_f32 v157, v242, s[32:35], 0 offen offset:196
  buffer_atomic_add_f32 v158, v242, s[32:35], 0 offen offset:200
  buffer_atomic_add_f32 v159, v242, s[32:35], 0 offen offset:204
  buffer_atomic_add_f32 v160, v242, s[32:35], 0 offen offset:224
  buffer_atomic_add_f32 v161, v242, s[32:35], 0 offen offset:228
  buffer_atomic_add_f32 v162, v242, s[32:35], 0 offen offset:232
  buffer_atomic_add_f32 v163, v242, s[32:35], 0 offen offset:236
  s_branch K2_fa_33
K2_fs_37:
  v_lshrrev_b32 v242, 5, v0
  v_lshlrev_b32 v242, 4, v242
  v_lshl_add_u32 v242, v241, 4, v242
  buffer_atomic_add_f32 v132, v242, s[32:35], 0 offen offset:0
  buffer_atomic_add_f32 v133, v242, s[32:35], 0 offen offset:4
  buffer_atomic_add_f32 v134, v242, s[32:35], 0 offen offset:8
  buffer_atomic_add_f32 v135, v242, s[32:35], 0 offen offset:12
  buffer_atomic_add_f32 v136, v242, s[32:35], 0 offen offset:32
  buffer_atomic_add_f32 v137, v242, s[32:35], 0 offen offset:36
  buffer_atomic_add_f32 v138, v242, s[32:35], 0 offen offset:40
  buffer_atomic_add_f32 v139, v242, s[32:35], 0 offen offset:44
  buffer_atomic_add_f32 v140, v242, s[32:35], 0 offen offset:64
  buffer_atomic_add_f32 v141, v242, s[32:35], 0 offen offset:68
  buffer_atomic_add_f32 v142, v242, s[32:35], 0 offen offset:72
  buffer_atomic_add_f32 v143, v242, s[32:35], 0 offen offset:76
  buffer_atomic_add_f32 v144, v242, s[32:35], 0 offen offset:96
  buffer_atomic_add_f32 v145, v242, s[32:35], 0 offen offset:100
  buffer_atomic_add_f32 v146, v242, s[32:35], 0 offen offset:104
  buffer_atomic_add_f32 v147, v242, s[32:35], 0 offen offset:108
  buffer_atomic_add_f32 v148, v242, s[32:35], 0 offen offset:128
  buffer_atomic_add_f32 v149, v242, s[32:35], 0 offen offset:132
  buffer_atomic_add_f32 v150, v242, s[32:35], 0 offen offset:136
  buffer_atomic_add_f32 v151, v242, s[32:35], 0 offen offset:140
  buffer_atomic_add_f32 v152, v242, s[32:35], 0 offen offset:160
  buffer_atomic_add_f32 v153, v242, s[32:35], 0 offen offset:164
  buffer_atomic_add_f32 v154, v242, s[32:35], 0 offen offset:168
  buffer_atomic_add_f32 v155, v242, s[32:35], 0 offen offset:172
  buffer_atomic_add_f32 v156, v242, s[32:35], 0 offen offset:192
  buffer_atomic_add_f32 v157, v242, s[32:35], 0 offen offset:196
  buffer_atomic_add_f32 v158, v242, s[32:35], 0 offen offset:200
  buffer_atomic_add_f32 v159, v242, s[32:35], 0 offen offset:204
  buffer_atomic_add_f32 v160, v242, s[32:35], 0 offen offset:224
  buffer_atomic_add_f32 v161, v242, s[32:35], 0 offen offset:228
  buffer_atomic_add_f32 v162, v242, s[32:35], 0 offen offset:232
  buffer_atomic_add_f32 v163, v242, s[32:35], 0 offen offset:236
  s_branch K2_fa_36
K2_epi:
  s_and_b32 s92, s84, 15
  s_cmp_ge_u32 s92, 3
  s_cbranch_scc1 K2_epi_issued
  s_waitcnt vmcnt(0) lgkmcnt(0)
  s_mul_i32 s93, s2, 196
  s_lshl_b32 s94, s3, 5
  s_add_u32 s93, s93, s94
  s_lshl_b32 s93, s93, 7
  v_lshrrev_b32 v243, 3, v0
  v_lshlrev_b32 v243, 9, v243
  v_add_u32 v243, s93, v243
  v_add_u32 v216, v243, v57
  v_add_u32 v217, v243, v59
  v_add_u32 v217, 128, v217
  v_add_u32 v218, v243, v61
  v_add_u32 v218, 256, v218
  v_add_u32 v219, v243, v63
  v_add_u32 v219, 384, v219
  s_cmp_ge_u32 s3, 7
  s_cbranch_scc1 K2_epi_w7al
K2_epi_rowsl:
  s_add_u32 m0, s88, 0
  s_nop 0
  buffer_load_dwordx4 v216, s[8:11], 0 offen lds
  s_add_u32 m0, s88, 1024
  s_nop 0
  buffer_load_dwordx4 v217, s[8:11], 0 offen lds
  s_add_u32 m0, s88, 2048
  s_nop 0
  buffer_load_dwordx4 v218, s[8:11], 0 offen lds
  s_add_u32 m0, s88, 3072
  s_nop 0
  buffer_load_dwordx4 v219, s[8:11], 0 offen lds
K2_epi_w7al:
K2_epi_issued:
  s_bitcmp1_b32 s84, 4
  s_cbranch_scc1 K2_epi_whave
  s_waitcnt lgkmcnt(0)
  v_bfe_u32 v164, v0, 2, 2
  v_lshrrev_b32 v165, 5, v0
  v_lshl_add_u32 v165, v165, 3, v164
  v_lshlrev_b32 v165, 7, v165
  v_bfe_u32 v166, v0, 4, 1
  v_bfe_u32 v167, v0, 1, 1
  v_lshl_or_b32 v166, v166, 1, v167
  v_lshlrev_b32 v164, 1, v164
  v_xor_b32 v166, v166, v164
  v_and_b32 v167, 1, v0
  v_lshlrev_b32 v167, 3, v167
  v_add_u32 v165, v165, v167
  v_add_u32 v165, 131072, v165
  v_lshl_add_u32 v230, v166, 4, v165
  v_xor_b32 v166, 4, v166
  v_lshl_add_u32 v231, v166, 4, v165
  s_cmp_ge_u32 s3, 4
  s_cbranch_scc0 K2_epi_wfulll
  s_cmp_eq_u32 s101, 0
  s_cbranch_scc1 K2_epi_whalfl
  s_cmp_ge_u32 s3, 7
  s_cbranch_scc1 K2_epi_wdonel
K2_epi_wfulll:
  ds_read_b64_tr_b16 v[68:69], v230 offset:2048
  ds_read_b64_tr_b16 v[70:71], v230 offset:2560
  ds_read_b64_tr_b16 v[72:73], v231 offset:2048
  ds_read_b64_tr_b16 v[74:75], v231 offset:2560
  ds_read_b64_tr_b16 v[76:77], v230 offset:6144
  ds_read_b64_tr_b16 v[78:79], v230 offset:6656
  ds_read_b64_tr_b16 v[80:81], v231 offset:6144
  ds_read_b64_tr_b16 v[82:83], v231 offset:6656
  ds_read_b64_tr_b16 v[84:85], v230 offset:10240
  ds_read_b64_tr_b16 v[86:87], v230 offset:10752
  ds_read_b64_tr_b16 v[88:89], v231 offset:10240
  ds_read_b64_tr_b16 v[90:91], v231 offset:10752
  ds_read_b64_tr_b16 v[92:93], v230 offset:14336
  ds_read_b64_tr_b16 v[94:95], v230 offset:14848
  ds_read_b64_tr_b16 v[96:97], v231 offset:14336
  ds_read_b64_tr_b16 v[98:99], v231 offset:14848
  ds_read_b64_tr_b16 v[100:101], v230 offset:18432
  ds_read_b64_tr_b16 v[102:103], v230 offset:18944
  ds_read_b64_tr_b16 v[104:105], v231 offset:18432
  ds_read_b64_tr_b16 v[106:107], v231 offset:18944
  ds_read_b64_tr_b16 v[108:109], v230 offset:22528
  ds_read_b64_tr_b16 v[110:111], v230 offset:23040
  ds_read_b64_tr_b16 v[112:113], v231 offset:22528
  ds_read_b64_tr_b16 v[114:115], v231 offset:23040
  ds_read_b64_tr_b16 v[116:117], v230 offset:26624
  ds_read_b64_tr_b16 v[118:119], v230 offset:27136
  ds_read_b64_tr_b16 v[120:121], v231 offset:26624
  ds_read_b64_tr_b16 v[122:123], v231 offset:27136
  ds_read_b64_tr_b16 v[124:125], v230 offset:30720
  ds_read_b64_tr_b16 v[126:127], v230 offset:31232
  ds_read_b64_tr_b16 v[128:129], v231 offset:30720
  ds_read_b64_tr_b16 v[130:131], v231 offset:31232
  s_branch K2_epi_wdonel
K2_epi_whalfl:
  s_bitcmp1_b32 s3, 1
  s_cbranch_scc0 K2_epi_wh0l
  v_mov_b32 v230, v231
K2_epi_wh0l:
  ds_read_b64_tr_b16 v[68:69], v230 offset:2048
  ds_read_b64_tr_b16 v[70:71], v230 offset:2560
  ds_read_b64_tr_b16 v[72:73], v230 offset:6144
  ds_read_b64_tr_b16 v[74:75], v230 offset:6656
  ds_read_b64_tr_b16 v[76:77], v230 offset:10240
  ds_read_b64_tr_b16 v[78:79], v230 offset:10752
  ds_read_b64_tr_b16 v[80:81], v230 offset:14336
  ds_read_b64_tr_b16 v[82:83], v230 offset:14848
  ds_read_b64_tr_b16 v[84:85], v230 offset:18432
  ds_read_b64_tr_b16 v[86:87], v230 offset:18944
  ds_read_b64_tr_b16 v[88:89], v230 offset:22528
  ds_read_b64_tr_b16 v[90:91], v230 offset:23040
  ds_read_b64_tr_b16 v[92:93], v230 offset:26624
  ds_read_b64_tr_b16 v[94:95], v230 offset:27136
  ds_read_b64_tr_b16 v[96:97], v230 offset:30720
  ds_read_b64_tr_b16 v[98:99], v230 offset:31232
K2_epi_wdonel:
K2_epi_whave:
K2_epi_bar:
  s_waitcnt vmcnt(0)
  s_barrier
  v_mov_b32 v241, 0
  ds_read_b32 v243, v241 offset:228
  s_cmp_ge_u32 s3, 4
  s_cbranch_scc0 K2_epi_A
  s_cmp_eq_u32 s101, 0
  s_cbranch_scc1 K2_epi_H
  s_cmp_ge_u32 s3, 7
  s_cbranch_scc1 K2_epi_w7b
K2_epi_A:
  s_setprio 0
  s_mul_i32 s92, s3, 4352
  s_add_u32 s92, s92, 44544
  v_and_b32 v242, 31, v0
  v_mul_u32_u24 v242, 136, v242
  v_lshrrev_b32 v241, 5, v0
  v_lshl_add_u32 v242, v241, 4, v242
  v_add_u32 v242, s92, v242
  ds_read2_b64 v[180:183], v242 offset0:0 offset1:1
  ds_read2_b64 v[184:187], v242 offset0:4 offset1:5
  ds_read2_b64 v[188:191], v242 offset0:8 offset1:9
  ds_read2_b64 v[192:195], v242 offset0:12 offset1:13
  ds_read_b128 v[164:167], v64
  ds_read_b128 v[168:171], v65
  ds_read_b128 v[172:175], v66
  ds_read_b128 v[176:179], v67
  s_waitcnt lgkmcnt(8)
  v_readfirstlane_b32 s92, v243
  s_cmp_lg_u32 s92, 0
  s_cbranch_scc1 K2_redo_w
  s_cmp_eq_u32 s101, 0
  s_cbranch_scc1 K2_epi_fast
  s_mul_i32 s93, s2, 50176
  s_add_u32 s93, s93, 16777216
  s_add_u32 s16, s6, s93
  s_addc_u32 s17, s7, 0
  s_mov_b32 s18, 50176
  s_mov_b32 s19, 0x00020000
  v_and_b32 v242, 31, v0
  s_lshl_b32 s92, s3, 5
  v_add_u32 v242, s92, v242
  v_lshlrev_b32 v242, 8, v242
  v_lshl_add_u32 v242, v241, 5, v242
  buffer_load_dwordx4 v[132:135], v242, s[16:19], 0 offen offset:0 sc1
  buffer_load_dwordx4 v[136:139], v242, s[16:19], 0 offen offset:16 sc1
  buffer_load_dwordx4 v[140:143], v242, s[16:19], 0 offen offset:64 sc1
  buffer_load_dwordx4 v[144:147], v242, s[16:19], 0 offen offset:80 sc1
  buffer_load_dwordx4 v[148:151], v242, s[16:19], 0 offen offset:128 sc1
  buffer_load_dwordx4 v[152:155], v242, s[16:19], 0 offen offset:144 sc1
  buffer_load_dwordx4 v[156:159], v242, s[16:19], 0 offen offset:192 sc1
  buffer_load_dwordx4 v[160:163], v242, s[16:19], 0 offen offset:208 sc1
  s_waitcnt vmcnt(0) lgkmcnt(0)
  v_lshlrev_b32 v204, 16, v180
  v_and_b32 v205, 0xffff0000, v180
  v_add_f32 v204, v204, v132
  v_add_f32 v205, v205, v133
  v_cvt_pk_bf16_f32 v180, v204, v205
  v_lshlrev_b32 v204, 16, v181
  v_and_b32 v205, 0xffff0000, v181
  v_add_f32 v204, v204, v134
  v_add_f32 v205, v205, v135
  v_cvt_pk_bf16_f32 v181, v204, v205
  v_lshlrev_b32 v204, 16, v182
  v_and_b32 v205, 0xffff0000, v182
  v_add_f32 v204, v204, v136
  v_add_f32 v205, v205, v137
  v_cvt_pk_bf16_f32 v182, v204, v205
  v_lshlrev_b32 v204, 16, v183
  v_and_b32 v205, 0xffff0000, v183
  v_add_f32 v204, v204, v138
  v_add_f32 v205, v205, v139
  v_cvt_pk_bf16_f32 v183, v204, v205
  v_lshlrev_b32 v204, 16, v184
  v_and_b32 v205, 0xffff0000, v184
  v_add_f32 v204, v204, v140
  v_add_f32 v205, v205, v141
  v_cvt_pk_bf16_f32 v184, v204, v205
  v_lshlrev_b32 v204, 16, v185
  v_and_b32 v205, 0xffff0000, v185
  v_add_f32 v204, v204, v142
  v_add_f32 v205, v205, v143
  v_cvt_pk_bf16_f32 v185, v204, v205
  v_lshlrev_b32 v204, 16, v186
  v_and_b32 v205, 0xffff0000, v186
  v_add_f32 v204, v204, v144
  v_add_f32 v205, v205, v145
  v_cvt_pk_bf16_f32 v186, v204, v205
  v_lshlrev_b32 v204, 16, v187
  v_and_b32 v205, 0xffff0000, v187
  v_add_f32 v204, v204, v146
  v_add_f32 v205, v205, v147
  v_cvt_pk_bf16_f32 v187, v204, v205
  v_lshlrev_b32 v204, 16, v188
  v_and_b32 v205, 0xffff0000, v188
  v_add_f32 v204, v204, v148
  v_add_f32 v205, v205, v149
  v_cvt_pk_bf16_f32 v188, v204, v205
  v_lshlrev_b32 v204, 16, v189
  v_and_b32 v205, 0xffff0000, v189
  v_add_f32 v204, v204, v150
  v_add_f32 v205, v205, v151
  v_cvt_pk_bf16_f32 v189, v204, v205
  v_lshlrev_b32 v204, 16, v190
  v_and_b32 v205, 0xffff0000, v190
  v_add_f32 v204, v204, v152
  v_add_f32 v205, v205, v153
  v_cvt_pk_bf16_f32 v190, v204, v205
  v_lshlrev_b32 v204, 16, v191
  v_and_b32 v205, 0xffff0000, v191
  v_add_f32 v204, v204, v154
  v_add_f32 v205, v205, v155
  v_cvt_pk_bf16_f32 v191, v204, v205
  v_lshlrev_b32 v204, 16, v192
  v_and_b32 v205, 0xffff0000, v192
  v_add_f32 v204, v204, v156
  v_add_f32 v205, v205, v157
  v_cvt_pk_bf16_f32 v192, v204, v205
  v_lshlrev_b32 v204, 16, v193
  v_and_b32 v205, 0xffff0000, v193
  v_add_f32 v204, v204, v158
  v_add_f32 v205, v205, v159
  v_cvt_pk_bf16_f32 v193, v204, v205
  v_lshlrev_b32 v204, 16, v194
  v_and_b32 v205, 0xffff0000, v194
  v_add_f32 v204, v204, v160
  v_add_f32 v205, v205, v161
  v_cvt_pk_bf16_f32 v194, v204, v205
  v_lshlrev_b32 v204, 16, v195
  v_and_b32 v205, 0xffff0000, v195
  v_add_f32 v204, v204, v162
  v_add_f32 v205, v205, v163
  v_cvt_pk_bf16_f32 v195, v204, v205
  s_nop 1
K2_epi_fast:
  s_setprio 2
  s_waitcnt lgkmcnt(3)
  v_mfma_f32_32x32x16_bf16 v[132:147], v[68:71], v[164:167], 0
  v_mfma_f32_32x32x16_bf16 v[148:163], v[72:75], v[164:167], 0
  v_lshrrev_b32 v241, 5, v0
  v_lshlrev_b32 v228, 4, v241
  v_xor_b32 v229, 16, v228
  v_lshlrev_b32 v241, 3, v241
  v_xad_u32 v196, v64, v228, v241
  v_xad_u32 v197, v64, v229, v241
  v_xad_u32 v198, v65, v228, v241
  v_xad_u32 v199, v65, v229, v241
  v_xad_u32 v200, v66, v228, v241
  v_xad_u32 v201, v66, v229, v241
  v_xad_u32 v202, v67, v228, v241
  v_xad_u32 v203, v67, v229, v241
  s_waitcnt lgkmcnt(2)
  v_mfma_f32_32x32x16_bf16 v[132:147], v[76:79], v[168:171], v[132:147]
  v_mfma_f32_32x32x16_bf16 v[148:163], v[80:83], v[168:171], v[148:163]
  s_waitcnt lgkmcnt(1)
  v_mfma_f32_32x32x16_bf16 v[132:147], v[84:87], v[172:175], v[132:147]
  v_mfma_f32_32x32x16_bf16 v[148:163], v[88:91], v[172:175], v[148:163]
  s_waitcnt lgkmcnt(0)
  v_mfma_f32_32x32x16_bf16 v[132:147], v[92:95], v[176:179], v[132:147]
  v_mfma_f32_32x32x16_bf16 v[148:163], v[96:99], v[176:179], v[148:163]
  s_mov_b32 s94, 0xbfb8aa3b
  s_mov_b32 s95, 0xbfb8aa3b
  s_nop 8
  v_pk_mul_f32 v[132:133], v[132:133], s[94:95]
  v_pk_mul_f32 v[134:135], v[134:135], s[94:95]
  v_pk_mul_f32 v[136:137], v[136:137], s[94:95]
  v_pk_mul_f32 v[138:139], v[138:139], s[94:95]
  v_pk_mul_f32 v[140:141], v[140:141], s[94:95]
  v_pk_mul_f32 v[142:143], v[142:143], s[94:95]
  v_pk_mul_f32 v[144:145], v[144:145], s[94:95]
  v_pk_mul_f32 v[146:147], v[146:147], s[94:95]
  v_pk_mul_f32 v[148:149], v[148:149], s[94:95]
  v_pk_mul_f32 v[150:151], v[150:151], s[94:95]
  v_pk_mul_f32 v[152:153], v[152:153], s[94:95]
  v_pk_mul_f32 v[154:155], v[154:155], s[94:95]
  v_pk_mul_f32 v[156:157], v[156:157], s[94:95]
  v_pk_mul_f32 v[158:159], v[158:159], s[94:95]
  v_pk_mul_f32 v[160:161], v[160:161], s[94:95]
  v_pk_mul_f32 v[162:163], v[162:163], s[94:95]
  s_nop 0
  v_mfma_f32_32x32x16_bf16 v[132:147], v[100:103], v[180:183], v[132:147]
  v_mfma_f32_32x32x16_bf16 v[148:163], v[104:107], v[180:183], v[148:163]
  v_mfma_f32_32x32x16_bf16 v[132:147], v[108:111], v[184:187], v[132:147]
  v_mfma_f32_32x32x16_bf16 v[148:163], v[112:115], v[184:187], v[148:163]
  ds_read_b64 v[4:5], v196
  ds_read_b64 v[6:7], v197
  ds_read_b64 v[8:9], v198
  ds_read_b64 v[10:11], v199
  ds_read_b64 v[12:13], v200
  ds_read_b64 v[14:15], v201
  ds_read_b64 v[16:17], v202
  ds_read_b64 v[18:19], v203
  v_mfma_f32_32x32x16_bf16 v[132:147], v[116:119], v[188:191], v[132:147]
  v_mfma_f32_32x32x16_bf16 v[148:163], v[120:123], v[188:191], v[148:163]
  v_mfma_f32_32x32x16_bf16 v[132:147], v[124:127], v[192:195], v[132:147]
  v_mfma_f32_32x32x16_bf16 v[148:163], v[128:131], v[192:195], v[148:163]
  s_setprio 0
  s_waitcnt lgkmcnt(0)
  v_lshlrev_b32 v20, 16, v4
  v_and_b32 v21, 0xffff0000, v4
  v_lshlrev_b32 v22, 16, v5
  v_and_b32 v23, 0xffff0000, v5
  v_lshlrev_b32 v24, 16, v6
  v_and_b32 v25, 0xffff0000, v6
  v_lshlrev_b32 v26, 16, v7
  v_and_b32 v27, 0xffff0000, v7
  s_nop 5
  v_exp_f32 v204, v132
  v_exp_f32 v205, v133
  v_exp_f32 v206, v134
  v_exp_f32 v207, v135
  v_exp_f32 v208, v136
  v_exp_f32 v209, v137
  v_exp_f32 v210, v138
  v_exp_f32 v211, v139
  v_pk_add_f32 v[204:205], v[204:205], s[38:39]
  v_pk_add_f32 v[206:207], v[206:207], s[38:39]
  v_pk_add_f32 v[208:209], v[208:209], s[38:39]
  v_pk_add_f32 v[210:211], v[210:211], s[38:39]
  v_rcp_f32 v204, v204
  v_rcp_f32 v205, v205
  v_rcp_f32 v206, v206
  v_rcp_f32 v207, v207
  v_rcp_f32 v208, v208
  v_rcp_f32 v209, v209
  v_rcp_f32 v210, v210
  v_rcp_f32 v211, v211
  v_pk_mul_f32 v[204:205], v[204:205], v[132:133]
  v_pk_mul_f32 v[206:207], v[206:207], v[134:135]
  v_pk_mul_f32 v[208:209], v[208:209], v[136:137]
  v_pk_mul_f32 v[210:211], v[210:211], v[138:139]
  v_pk_fma_f32 v[204:205], v[204:205], s[36:37], v[20:21]
  v_pk_fma_f32 v[206:207], v[206:207], s[36:37], v[22:23]
  v_pk_fma_f32 v[208:209], v[208:209], s[36:37], v[24:25]
  v_pk_fma_f32 v[210:211], v[210:211], s[36:37], v[26:27]
  v_cvt_pk_bf16_f32 v4, v204, v205
  v_cvt_pk_bf16_f32 v5, v206, v207
  ds_write_b64 v196, v[4:5]
  v_cvt_pk_bf16_f32 v6, v208, v209
  v_cvt_pk_bf16_f32 v7, v210, v211
  ds_write_b64 v197, v[6:7]
  v_lshlrev_b32 v20, 16, v8
  v_and_b32 v21, 0xffff0000, v8
  v_lshlrev_b32 v22, 16, v9
  v_and_b32 v23, 0xffff0000, v9
  v_lshlrev_b32 v24, 16, v10
  v_and_b32 v25, 0xffff0000, v10
  v_lshlrev_b32 v26, 16, v11
  v_and_b32 v27, 0xffff0000, v11
  v_exp_f32 v204, v140
  v_exp_f32 v205, v141
  v_exp_f32 v206, v142
  v_exp_f32 v207, v143
  v_exp_f32 v208, v144
  v_exp_f32 v209, v145
  v_exp_f32 v210, v146
  v_exp_f32 v211, v147
  v_pk_add_f32 v[204:205], v[204:205], s[38:39]
  v_pk_add_f32 v[206:207], v[206:207], s[38:39]
  v_pk_add_f32 v[208:209], v[208:209], s[38:39]
  v_pk_add_f32 v[210:211], v[210:211], s[38:39]
  v_rcp_f32 v204, v204
  v_rcp_f32 v205, v205
  v_rcp_f32 v206, v206
  v_rcp_f32 v207, v207
  v_rcp_f32 v208, v208
  v_rcp_f32 v209, v209
  v_rcp_f32 v210, v210
  v_rcp_f32 v211, v211
  v_pk_mul_f32 v[204:205], v[204:205], v[140:141]
  v_pk_mul_f32 v[206:207], v[206:207], v[142:143]
  v_pk_mul_f32 v[208:209], v[208:209], v[144:145]
  v_pk_mul_f32 v[210:211], v[210:211], v[146:147]
  v_pk_fma_f32 v[204:205], v[204:205], s[36:37], v[20:21]
  v_pk_fma_f32 v[206:207], v[206:207], s[36:37], v[22:23]
  v_pk_fma_f32 v[208:209], v[208:209], s[36:37], v[24:25]
  v_pk_fma_f32 v[210:211], v[210:211], s[36:37], v[26:27]
  v_cvt_pk_bf16_f32 v8, v204, v205
  v_cvt_pk_bf16_f32 v9, v206, v207
  ds_write_b64 v198, v[8:9]
  v_cvt_pk_bf16_f32 v10, v208, v209
  v_cvt_pk_bf16_f32 v11, v210, v211
  ds_write_b64 v199, v[10:11]
  v_lshlrev_b32 v20, 16, v12
  v_and_b32 v21, 0xffff0000, v12
  v_lshlrev_b32 v22, 16, v13
  v_and_b32 v23, 0xffff0000, v13
  v_lshlrev_b32 v24, 16, v14
  v_and_b32 v25, 0xffff0000, v14
  v_lshlrev_b32 v26, 16, v15
  v_and_b32 v27, 0xffff0000, v15
  v_exp_f32 v204, v148
  v_exp_f32 v205, v149
  v_exp_f32 v206, v150
  v_exp_f32 v207, v151
  v_exp_f32 v208, v152
  v_exp_f32 v209, v153
  v_exp_f32 v210, v154
  v_exp_f32 v211, v155
  v_pk_add_f32 v[204:205], v[204:205], s[38:39]
  v_pk_add_f32 v[206:207], v[206:207], s[38:39]
  v_pk_add_f32 v[208:209], v[208:209], s[38:39]
  v_pk_add_f32 v[210:211], v[210:211], s[38:39]
  v_rcp_f32 v204, v204
  v_rcp_f32 v205, v205
  v_rcp_f32 v206, v206
  v_rcp_f32 v207, v207
  v_rcp_f32 v208, v208
  v_rcp_f32 v209, v209
  v_rcp_f32 v210, v210
  v_rcp_f32 v211, v211
  v_pk_mul_f32 v[204:205], v[204:205], v[148:149]
  v_pk_mul_f32 v[206:207], v[206:207], v[150:151]
  v_pk_mul_f32 v[208:209], v[208:209], v[152:153]
  v_pk_mul_f32 v[210:211], v[210:211], v[154:155]
  v_pk_fma_f32 v[204:205], v[204:205], s[36:37], v[20:21]
  v_pk_fma_f32 v[206:207], v[206:207], s[36:37], v[22:23]
  v_pk_fma_f32 v[208:209], v[208:209], s[36:37], v[24:25]
  v_pk_fma_f32 v[210:211], v[210:211], s[36:37], v[26:27]
  v_cvt_pk_bf16_f32 v12, v204, v205
  v_cvt_pk_bf16_f32 v13, v206, v207
  ds_write_b64 v200, v[12:13]
  v_cvt_pk_bf16_f32 v14, v208, v209
  v_cvt_pk_bf16_f32 v15, v210, v211
  ds_write_b64 v201, v[14:15]
  v_lshlrev_b32 v20, 16, v16
  v_and_b32 v21, 0xffff0000, v16
  v_lshlrev_b32 v22, 16, v17
  v_and_b32 v23, 0xffff0000, v17
  v_lshlrev_b32 v24, 16, v18
  v_and_b32 v25, 0xffff0000, v18
  v_lshlrev_b32 v26, 16, v19
  v_and_b32 v27, 0xffff0000, v19
  v_exp_f32 v204, v156
  v_exp_f32 v205, v157
  v_exp_f32 v206, v158
  v_exp_f32 v207, v159
  v_exp_f32 v208, v160
  v_exp_f32 v209, v161
  v_exp_f32 v210, v162
  v_exp_f32 v211, v163
  v_pk_add_f32 v[204:205], v[204:205], s[38:39]
  v_pk_add_f32 v[206:207], v[206:207], s[38:39]
  v_pk_add_f32 v[208:209], v[208:209], s[38:39]
  v_pk_add_f32 v[210:211], v[210:211], s[38:39]
  v_rcp_f32 v204, v204
  v_rcp_f32 v205, v205
  v_rcp_f32 v206, v206
  v_rcp_f32 v207, v207
  v_rcp_f32 v208, v208
  v_rcp_f32 v209, v209
  v_rcp_f32 v210, v210
  v_rcp_f32 v211, v211
  v_pk_mul_f32 v[204:205], v[204:205], v[156:157]
  v_pk_mul_f32 v[206:207], v[206:207], v[158:159]
  v_pk_mul_f32 v[208:209], v[208:209], v[160:161]
  v_pk_mul_f32 v[210:211], v[210:211], v[162:163]
  v_pk_fma_f32 v[204:205], v[204:205], s[36:37], v[20:21]
  v_pk_fma_f32 v[206:207], v[206:207], s[36:37], v[22:23]
  v_pk_fma_f32 v[208:209], v[208:209], s[36:37], v[24:25]
  v_pk_fma_f32 v[210:211], v[210:211], s[36:37], v[26:27]
  v_cvt_pk_bf16_f32 v16, v204, v205
  v_cvt_pk_bf16_f32 v17, v206, v207
  ds_write_b64 v202, v[16:17]
  v_cvt_pk_bf16_f32 v18, v208, v209
  v_cvt_pk_bf16_f32 v19, v210, v211
  ds_write_b64 v203, v[18:19]
  v_lshlrev_b32 v241, 4, v0
  v_add_u32 v241, s88, v241
  ds_read_b128 v[164:167], v241 offset:0
  ds_read_b128 v[168:171], v241 offset:1024
  ds_read_b128 v[172:175], v241 offset:2048
  ds_read_b128 v[176:179], v241 offset:3072
  s_cmp_eq_u32 s3, 6
  s_cselect_b32 s98, 0xff, -1
  s_cselect_b32 s99, 0, -1
  s_mov_b64 exec, s[98:99]
  s_waitcnt lgkmcnt(3)
  buffer_store_dwordx4 v[164:167], v216, s[24:27], 0 offen sc1
  s_waitcnt lgkmcnt(2)
  buffer_store_dwordx4 v[168:171], v217, s[24:27], 0 offen sc1
  s_waitcnt lgkmcnt(1)
  buffer_store_dwordx4 v[172:175], v218, s[24:27], 0 offen sc1
  s_waitcnt lgkmcnt(0)
  buffer_store_dwordx4 v[176:179], v219, s[24:27], 0 offen sc1
  s_mov_b64 exec, -1
  s_branch K2_fin
K2_redo_w:
  s_waitcnt lgkmcnt(0)
  s_barrier
  s_branch K2_redo
K2_epi_H:
  s_waitcnt lgkmcnt(0)
  v_readfirstlane_b32 s92, v243
  s_cmp_lg_u32 s92, 0
  s_cbranch_scc1 K2_redo_w
  s_cmp_ge_u32 s3, 7
  s_cbranch_scc1 K2_epi_pos
K2_epi_H2:
  s_setprio 0
  s_bfe_u32 s46, s3, 0x10001
  s_mul_i32 s40, s46, -8192
  s_cmp_lg_u32 s46, 0
  s_cselect_b64 s[42:43], -1, 0
  s_xor_b32 s44, s42, 0xf0f00f0f
  v_add_u32 v224, s40, v64
  v_add_u32 v225, s40, v65
  v_add_u32 v226, s40, v66
  v_add_u32 v227, s40, v67
  s_mov_b32 s45, s44
  s_lshl_b32 s93, s46, 1
  s_sub_u32 s93, s3, s93
  s_mul_i32 s92, s93, 4352
  s_add_u32 s92, s92, 44544
  v_and_b32 v242, 31, v0
  v_mul_u32_u24 v242, 136, v242
  v_lshrrev_b32 v241, 5, v0
  v_lshl_add_u32 v242, v241, 4, v242
  v_add_u32 v242, s92, v242
  s_bitcmp1_b32 s3, 0
  s_cbranch_scc1 K2_epi_H3
  v_add_u32 v239, 8704, v242
  ds_read_b128 v[36:39], v224 offset:8192
  ds_read_b128 v[40:43], v225 offset:8192
  ds_read_b128 v[44:47], v226 offset:8192
  ds_read_b128 v[48:51], v227 offset:8192
  ds_read2_b64 v[12:15], v239 offset0:0 offset1:1
  ds_read2_b64 v[16:19], v239 offset0:4 offset1:5
  ds_read2_b64 v[28:31], v239 offset0:8 offset1:9
  ds_read2_b64 v[32:35], v239 offset0:12 offset1:13
  v_bfe_u32 v228, v0, 3, 2
  s_lshl_b32 s93, s46, 2
  v_add_lshl_u32 v228, v228, s93, 4
  v_and_b32 v229, 7, v0
  v_lshlrev_b32 v229, 1, v229
  v_add_u32 v229, 122880, v229
  v_xad_u32 v200, v228, 0, v229
  v_xad_u32 v201, v228, 16, v229
  v_xad_u32 v202, v228, 32, v229
  v_xad_u32 v203, v228, 48, v229
  ds_read_u16 v212, v200 offset:0
  ds_read_u16 v213, v201 offset:1024
  ds_read_u16 v214, v202 offset:2048
  ds_read_u16 v215, v203 offset:3072
K2_epi_H3:
  ds_read_b128 v[164:167], v224
  ds_read_b128 v[168:171], v225
  ds_read_b128 v[172:175], v226
  ds_read_b128 v[176:179], v227
  ds_read2_b64 v[180:183], v242 offset0:0 offset1:1
  ds_read2_b64 v[184:187], v242 offset0:4 offset1:5
  ds_read2_b64 v[188:191], v242 offset0:8 offset1:9
  ds_read2_b64 v[192:195], v242 offset0:12 offset1:13
  v_cndmask_b32 v232, v224, v226, s[42:43]
  v_cndmask_b32 v233, v225, v227, s[42:43]
  v_lshlrev_b32 v228, 4, v241
  v_xor_b32 v229, 16, v228
  v_lshlrev_b32 v241, 3, v241
  v_subrev_u32 v241, 32768, v241
  v_xad_u32 v196, v232, v228, v241
  v_xad_u32 v197, v232, v229, v241
  v_xad_u32 v198, v233, v228, v241
  v_xad_u32 v199, v233, v229, v241
  ds_read_b64 v[4:5], v196 offset:32768
  ds_read_b64 v[6:7], v197 offset:32768
  ds_read_b64 v[8:9], v198 offset:32768
  ds_read_b64 v[10:11], v199 offset:32768
  s_mov_b32 s94, 0xbfb8aa3b
  s_mov_b32 s95, 0xbfb8aa3b
  v_add_u32 v220, s40, v216
  v_add_u32 v221, s40, v217
  v_add_u32 v222, s40, v218
  v_add_u32 v223, s40, v219
  s_waitcnt lgkmcnt(11)
  v_mfma_f32_32x32x16_bf16 v[132:147], v[68:71], v[164:167], 0
  s_waitcnt lgkmcnt(7)
  v_mfma_f32_32x32x16_bf16 v[148:163], v[84:87], v[180:183], 0
  v_mfma_f32_32x32x16_bf16 v[132:147], v[72:75], v[168:171], v[132:147]
  s_waitcnt lgkmcnt(6)
  v_mfma_f32_32x32x16_bf16 v[148:163], v[88:91], v[184:187], v[148:163]
  v_mfma_f32_32x32x16_bf16 v[132:147], v[76:79], v[172:175], v[132:147]
  s_waitcnt lgkmcnt(5)
  v_mfma_f32_32x32x16_bf16 v[148:163], v[92:95], v[188:191], v[148:163]
  v_mfma_f32_32x32x16_bf16 v[132:147], v[80:83], v[176:179], v[132:147]
  s_waitcnt lgkmcnt(4)
  v_mfma_f32_32x32x16_bf16 v[148:163], v[96:99], v[192:195], v[148:163]
  s_waitcnt lgkmcnt(0)
  s_setprio 0
  v_lshlrev_b32 v20, 16, v4
  v_and_b32 v21, 0xffff0000, v4
  v_lshlrev_b32 v22, 16, v5
  v_and_b32 v23, 0xffff0000, v5
  v_lshlrev_b32 v24, 16, v6
  v_and_b32 v25, 0xffff0000, v6
  v_lshlrev_b32 v26, 16, v7
  v_and_b32 v27, 0xffff0000, v7
  s_nop 4
  v_pk_fma_f32 v[132:133], v[132:133], s[94:95], v[148:149]
  v_pk_fma_f32 v[134:135], v[134:135], s[94:95], v[150:151]
  v_pk_fma_f32 v[136:137], v[136:137], s[94:95], v[152:153]
  v_pk_fma_f32 v[138:139], v[138:139], s[94:95], v[154:155]
  v_pk_fma_f32 v[140:141], v[140:141], s[94:95], v[156:157]
  v_pk_fma_f32 v[142:143], v[142:143], s[94:95], v[158:159]
  v_pk_fma_f32 v[144:145], v[144:145], s[94:95], v[160:161]
  v_pk_fma_f32 v[146:147], v[146:147], s[94:95], v[162:163]
  v_mfma_f32_32x32x16_bf16 v[100:115], v[36:39], v[68:71], 0
  v_exp_f32 v204, v132
  v_exp_f32 v205, v133
  v_exp_f32 v206, v134
  v_exp_f32 v207, v135
  v_mfma_f32_32x32x16_bf16 v[116:131], v[12:15], v[84:87], 0
  v_exp_f32 v208, v136
  v_exp_f32 v209, v137
  v_exp_f32 v210, v138
  v_exp_f32 v211, v139
  v_pk_add_f32 v[204:205], v[204:205], s[38:39]
  v_pk_add_f32 v[206:207], v[206:207], s[38:39]
  v_pk_add_f32 v[208:209], v[208:209], s[38:39]
  v_pk_add_f32 v[210:211], v[210:211], s[38:39]
  v_mfma_f32_32x32x16_bf16 v[100:115], v[40:43], v[72:75], v[100:115]
  v_rcp_f32 v204, v204
  v_rcp_f32 v205, v205
  v_rcp_f32 v206, v206
  v_mfma_f32_32x32x16_bf16 v[116:131], v[16:19], v[88:91], v[116:131]
  v_rcp_f32 v207, v207
  v_rcp_f32 v208, v208
  v_rcp_f32 v209, v209
  v_rcp_f32 v210, v210
  v_rcp_f32 v211, v211
  v_pk_mul_f32 v[204:205], v[204:205], v[132:133]
  v_pk_mul_f32 v[206:207], v[206:207], v[134:135]
  v_pk_mul_f32 v[208:209], v[208:209], v[136:137]
  v_pk_mul_f32 v[210:211], v[210:211], v[138:139]
  v_pk_fma_f32 v[204:205], v[204:205], s[36:37], v[20:21]
  v_pk_fma_f32 v[206:207], v[206:207], s[36:37], v[22:23]
  v_pk_fma_f32 v[208:209], v[208:209], s[36:37], v[24:25]
  v_pk_fma_f32 v[210:211], v[210:211], s[36:37], v[26:27]
  v_cvt_pk_bf16_f32 v4, v204, v205
  v_cvt_pk_bf16_f32 v5, v206, v207
  ds_write_b64 v196, v[4:5]
  v_cvt_pk_bf16_f32 v6, v208, v209
  v_cvt_pk_bf16_f32 v7, v210, v211
  ds_write_b64 v197, v[6:7]
  v_mfma_f32_32x32x16_bf16 v[100:115], v[44:47], v[76:79], v[100:115]
  v_lshlrev_b32 v20, 16, v8
  v_and_b32 v21, 0xffff0000, v8
  v_lshlrev_b32 v22, 16, v9
  v_and_b32 v23, 0xffff0000, v9
  v_lshlrev_b32 v24, 16, v10
  v_and_b32 v25, 0xffff0000, v10
  v_lshlrev_b32 v26, 16, v11
  v_and_b32 v27, 0xffff0000, v11
  v_exp_f32 v204, v140
  v_exp_f32 v205, v141
  v_mfma_f32_32x32x16_bf16 v[116:131], v[28:31], v[92:95], v[116:131]
  v_exp_f32 v206, v142
  v_exp_f32 v207, v143
  v_exp_f32 v208, v144
  v_exp_f32 v209, v145
  v_exp_f32 v210, v146
  v_exp_f32 v211, v147
  v_pk_add_f32 v[204:205], v[204:205], s[38:39]
  v_pk_add_f32 v[206:207], v[206:207], s[38:39]
  v_pk_add_f32 v[208:209], v[208:209], s[38:39]
  v_pk_add_f32 v[210:211], v[210:211], s[38:39]
  v_mfma_f32_32x32x16_bf16 v[100:115], v[48:51], v[80:83], v[100:115]
  v_rcp_f32 v204, v204
  v_rcp_f32 v205, v205
  v_rcp_f32 v206, v206
  v_mfma_f32_32x32x16_bf16 v[116:131], v[32:35], v[96:99], v[116:131]
  v_rcp_f32 v207, v207
  v_rcp_f32 v208, v208
  v_rcp_f32 v209, v209
  v_rcp_f32 v210, v210
  v_rcp_f32 v211, v211
  v_pk_mul_f32 v[204:205], v[204:205], v[140:141]
  v_pk_mul_f32 v[206:207], v[206:207], v[142:143]
  v_pk_mul_f32 v[208:209], v[208:209], v[144:145]
  v_pk_mul_f32 v[210:211], v[210:211], v[146:147]
  v_pk_fma_f32 v[204:205], v[204:205], s[36:37], v[20:21]
  v_pk_fma_f32 v[206:207], v[206:207], s[36:37], v[22:23]
  v_pk_fma_f32 v[208:209], v[208:209], s[36:37], v[24:25]
  v_pk_fma_f32 v[210:211], v[210:211], s[36:37], v[26:27]
  v_cvt_pk_bf16_f32 v8, v204, v205
  v_cvt_pk_bf16_f32 v9, v206, v207
  ds_write_b64 v198, v[8:9]
  v_cvt_pk_bf16_f32 v10, v208, v209
  v_cvt_pk_bf16_f32 v11, v210, v211
  ds_write_b64 v199, v[10:11]
  v_lshlrev_b32 v241, 4, v0
  s_add_u32 s92, s88, s40
  s_sub_u32 s92, s92, 32768
  v_add_u32 v241, s92, v241
  ds_read_b128 v[164:167], v241 offset:0
  ds_read_b128 v[168:171], v241 offset:1024
  ds_read_b128 v[172:175], v241 offset:2048
  ds_read_b128 v[176:179], v241 offset:3072
  s_bitcmp1_b32 s3, 0
  s_cbranch_scc1 K2_epi_H5
  v_pk_fma_f32 v[100:101], v[100:101], s[94:95], v[116:117]
  v_pk_fma_f32 v[102:103], v[102:103], s[94:95], v[118:119]
  v_exp_f32 v204, v100
  v_exp_f32 v205, v101
  v_exp_f32 v206, v102
  v_exp_f32 v207, v103
  v_lshlrev_b32 v212, 16, v212
  v_lshlrev_b32 v213, 16, v213
  v_lshlrev_b32 v214, 16, v214
  v_lshlrev_b32 v215, 16, v215
  v_pk_add_f32 v[204:205], v[204:205], s[38:39]
  v_pk_add_f32 v[206:207], v[206:207], s[38:39]
  s_mul_i32 s92, s2, 25088
  s_lshl_b32 s93, s46, 6
  v_rcp_f32 v204, v204
  v_rcp_f32 v205, v205
  v_rcp_f32 v206, v206
  v_rcp_f32 v207, v207
  s_add_u32 s92, s92, s93
  s_add_u32 s92, s92, 24576
  v_lshl_add_u32 v238, v0, 1, s92
  v_pk_mul_f32 v[204:205], v[204:205], v[100:101]
  v_pk_mul_f32 v[206:207], v[206:207], v[102:103]
  v_pk_fma_f32 v[204:205], v[204:205], s[36:37], v[212:213]
  v_pk_fma_f32 v[206:207], v[206:207], s[36:37], v[214:215]
  v_cvt_pk_bf16_f32 v204, v204, v204
  v_cvt_pk_bf16_f32 v205, v205, v205
  v_cvt_pk_bf16_f32 v206, v206, v206
  v_cvt_pk_bf16_f32 v207, v207, v207
  s_mov_b64 exec, s[74:75]
  buffer_store_short v204, v238, s[24:27], 0 offen offset:0 sc1
  buffer_store_short v205, v238, s[24:27], 0 offen offset:128 sc1
  buffer_store_short v206, v238, s[24:27], 0 offen offset:256 sc1
  buffer_store_short v207, v238, s[24:27], 0 offen offset:384 sc1
K2_epi_H5:
  s_mov_b64 exec, s[44:45]
  s_waitcnt lgkmcnt(3)
  buffer_store_dwordx4 v[164:167], v220, s[24:27], 0 offen sc1
  s_waitcnt lgkmcnt(2)
  buffer_store_dwordx4 v[168:171], v221, s[24:27], 0 offen sc1
  s_waitcnt lgkmcnt(1)
  buffer_store_dwordx4 v[172:175], v222, s[24:27], 0 offen sc1
  s_waitcnt lgkmcnt(0)
  buffer_store_dwordx4 v[176:179], v223, s[24:27], 0 offen sc1
  s_mov_b64 exec, -1
  s_branch K2_fin
K2_epi_w7b:
  s_waitcnt lgkmcnt(0)
  v_readfirstlane_b32 s92, v243
  s_cmp_lg_u32 s92, 0
  s_cbranch_scc0 K2_epi_pos
  s_barrier
  s_branch K2_redo
K2_epi_pos:
  s_mul_i32 s93, s2, 1176
  v_add_u32 v242, 0, v0
  v_lshlrev_b32 v241, 4, v242
  v_lshlrev_b32 v243, 5, v242
  ds_read_b128 v[132:135], v241 offset:256
  ds_read_b128 v[136:139], v241 offset:1824
  ds_read_b128 v[140:143], v243 offset:41408
  ds_read_b128 v[144:147], v243 offset:41424
  v_mul_u32_u24 v152, 12, v242
  v_add_u32 v152, s93, v152
  s_waitcnt lgkmcnt(0)
  v_fma_f32 v141, v141, s36, v132
  v_fma_f32 v142, v142, s36, v133
  v_fma_f32 v143, v143, s36, v136
  v_fma_f32 v145, v145, s36, v134
  v_fma_f32 v146, v146, s36, v135
  v_fma_f32 v147, v147, s36, v138
  v_cvt_pk_bf16_f32 v148, v141, v142
  v_cvt_pk_bf16_f32 v149, v143, v145
  v_cvt_pk_bf16_f32 v150, v146, v147
  buffer_store_dwordx3 v[148:150], v152, s[28:31], 0 offen sc1
  v_add_u32 v242, 64, v0
  v_lshlrev_b32 v241, 4, v242
  v_lshlrev_b32 v243, 5, v242
  ds_read_b128 v[100:103], v241 offset:256
  ds_read_b128 v[104:107], v241 offset:1824
  ds_read_b128 v[108:111], v243 offset:41408
  ds_read_b128 v[112:115], v243 offset:41424
  v_mul_u32_u24 v120, 12, v242
  v_add_u32 v120, s93, v120
  s_waitcnt lgkmcnt(0)
  v_fma_f32 v109, v109, s36, v100
  v_fma_f32 v110, v110, s36, v101
  v_fma_f32 v111, v111, s36, v104
  v_fma_f32 v113, v113, s36, v102
  v_fma_f32 v114, v114, s36, v103
  v_fma_f32 v115, v115, s36, v106
  v_cvt_pk_bf16_f32 v116, v109, v110
  v_cvt_pk_bf16_f32 v117, v111, v113
  v_cvt_pk_bf16_f32 v118, v114, v115
  s_bfm_b64 s[98:99], 34, 0
  s_mov_b64 exec, s[98:99]
  buffer_store_dwordx3 v[116:118], v120, s[28:31], 0 offen sc1
  s_mov_b64 exec, -1
  s_cmp_eq_u32 s101, 0
  s_cbranch_scc1 K2_epi_H2
K2_fin:
K2_done:
  s_endpgm
.section .rodata,"a"
.p2align 6
.amdhsa_kernel gather_scatter__cheap_equivariant_egnn__graph_kernel
  .amdhsa_next_free_vgpr 256
  .amdhsa_next_free_sgpr 102
  .amdhsa_accum_offset 256
  .amdhsa_group_segment_fixed_size 0
  .amdhsa_kernarg_size 88
  .amdhsa_user_sgpr_count 2
  .amdhsa_user_sgpr_kernarg_segment_ptr 1
  .amdhsa_system_sgpr_workgroup_id_x 1
.end_amdhsa_kernel
```
